```python
import torch

def _softmax(x, axis=-1):
    return torch.softmax(x, dim=axis)
def _gelu(x):
    return torch.nn.functional.gelu(x, approximate="tanh")
def _silu(x):
    return torch.nn.functional.silu(x)
def _sigmoid(x):
    return torch.sigmoid(x)
def _layernorm(x, axis=-1, eps=1e-5):
    m = x.mean(dim=axis, keepdim=True)
    v = x.var(dim=axis, keepdim=True, unbiased=False)
    return (x - m) / torch.sqrt(v + eps)
def _scatter_add(tgt, idx, src, axis=0):
    return tgt.clone().index_add_(axis, idx, src)
def _segment_sum(src, seg, n):
    out = torch.zeros((n,) + src.shape[1:], dtype=src.dtype)
    return out.index_add_(0, seg, src)
def _pad(x, pw):
    flat = tuple(v for pair in reversed(pw) for v in pair)
    return torch.nn.functional.pad(x, flat)

kernel_name = 'parallel_sum__spectral_gfnet__dense_activation_silu__prompt'

def setup_inputs():

    _w = (lambda a: (lambda t: t.to(torch.bfloat16) if t.is_floating_point() else t)(torch.as_tensor(a)))
    def _A_setup():
        B, S, D = 1, 2048, 576
        Df = D // 2 + 1
        return {
            "x": _w((lambda *s: torch.randn(*s, dtype=torch.bfloat16) * 0.05)(B, S, D)),
            "w_r": _w((lambda *s: torch.randn(*s, dtype=torch.bfloat16) * 0.8)(S, Df) * 0.02),
            "w_i": _w((lambda *s: torch.randn(*s, dtype=torch.bfloat16) * 0.8)(S, Df) * 0.02),
        }
    _A_in = _A_setup()

    def _B_setup():
        B, S, D, F = 1, 2048, 576, 4608
        return {
            "x": _w((lambda *s: torch.randn(*s, dtype=torch.bfloat16) * 0.05)(B, S, D)),
            "w1": _w((lambda *s: torch.randn(*s, dtype=torch.bfloat16) * 0.8)(D, F) * (D ** -0.5)),
            "w2": _w((lambda *s: torch.randn(*s, dtype=torch.bfloat16) * 0.1)(F, D) * (F ** -0.5)),
        }
    _B_in = _B_setup()

    return {
        "A_x": _A_in["x"],
        "A_w_r": _A_in["w_r"],
        "A_w_i": _A_in["w_i"],
        "B_x": _B_in["x"],
        "B_w1": _B_in["w1"],
        "B_w2": _B_in["w2"],
    }

def reference(A_x, A_w_r, A_w_i, B_x, B_w1, B_w2):
    def _A_ref(x, w_r, w_i):
        B, S, D = x.shape
        X = (lambda x, axes=(-2,-1): torch.fft.rfft2(x.float(), dim=axes))(x, axes=(-2, -1))
        W = w_r + 1j * w_i
        X = X * W
        y = (lambda x, s, axes=(-2,-1): torch.fft.irfft2(x, s=s, dim=axes).to(torch.bfloat16))(X, (S, D), axes=(-2, -1))
        return y

    def _B_ref(x, w1, w2):
        h = torch.einsum("bsd,df->bsf", x, w1)
        h = _silu(h)
        out = torch.einsum("bsf,fd->bsd", h, w2)
        return out

    x = A_x
    xn = _layernorm(x, axis=-1)
    return x + _A_ref(xn, A_w_r, A_w_i) + _B_ref(xn, B_w1, B_w2)
```

```asm
; @launch grid=(256,1,1) block=(256,1,1) lds=163840
.amdgcn_target "amdgcn-amd-amdhsa--gfx950"
.text
.globl parallel_sum__spectral_gfnet__dense_activation_silu__prompt_kernel
.p2align 8
.type parallel_sum__spectral_gfnet__dense_activation_silu__prompt_kernel,@function
parallel_sum__spectral_gfnet__dense_activation_silu__prompt_kernel:
  s_cmpk_ge_u32 s2, 0x100
  s_cbranch_scc1 L_exit
  s_load_dwordx2 s[4:5], s[0:1], 0
  s_load_dwordx2 s[94:95], s[0:1], 64
  s_getpc_b64 s[40:41]
L_pc:
  s_lshr_b32 s36, s2, 3
  s_lshl_b32 s36, s36, 7
  v_lshrrev_b32 v17, 4, v0
  v_lshl_add_u32 v17, v17, 12, s36
  v_min_u32 v17, L_end-L_pc-4, v17
  v_mov_b32 v19, s41
  v_add_co_u32 v18, vcc, s40, v17
  v_lshrrev_b32 v8, 6, v0
  v_and_b32 v1, 63, v0
  v_addc_co_u32 v19, vcc, 0, v19, vcc
  global_load_dword a208, v[18:19], off
  s_and_b32 s29, s2, 1
  v_readfirstlane_b32 s28, v8
  s_lshr_b32 s33, s2, 5
  s_lshl3_add_u32 s29, s29, s33
  s_bfe_u32 s30, s2, 0x20003
  s_mul_i32 s35, s30, 5
  s_andn2_b32 s35, s35, 1
  s_lshl2_add_u32 s33, s29, s28
  s_mul_i32 s83, s33, 1152
  s_lshl_b32 s80, s35, 6
  s_add_u32 s80, s80, s83
  s_mul_i32 s82, s28, 36864
  s_addk_i32 s82, 16384
  v_lshrrev_b32 v12, 3, v1
  v_and_b32 v14, 7, v1
  v_lshrrev_b32 v15, 1, v12
  v_xor_b32 v15, v15, v14
  v_mul_u32_u24 v16, 73728, v12
  v_lshl_add_u32 v104, v15, 4, v16
  v_xor_b32 v105, 64, v104
  v_add_u32 v106, 1177600, v104
  v_add_u32 v107, 1766400, v105
  v_add_u32 v105, 588800, v105
  s_mov_b32 s6, 2359296
  s_mov_b32 s7, 0x20000
  s_waitcnt lgkmcnt(0)
  s_add_u32 m0, s82, 0
  s_nop 0
  buffer_load_dwordx4 v104, s[4:7], s80 offen offset:0 lds
  buffer_load_dwordx4 v105, s[4:7], s80 offen offset:1024 lds
  buffer_load_dwordx4 v106, s[4:7], s80 offen offset:2048 lds
  buffer_load_dwordx4 v107, s[4:7], s80 offen offset:3072 lds
  s_mov_b32 s37, s2
  s_load_dwordx2 s[90:91], s[0:1], 8
  s_load_dwordx2 s[86:87], s[0:1], 16
  s_load_dwordx4 s[96:99], s[0:1], 32
  s_load_dwordx2 s[2:3], s[0:1], 48
  s_add_u32 s81, s83, 1152
  s_add_u32 m0, s82, 4096
  s_add_u32 s80, s80, 128
  s_cmp_eq_u32 s80, s81
  s_cselect_b32 s80, s83, s80
  buffer_load_dwordx4 v104, s[4:7], s80 offen offset:0 lds
  buffer_load_dwordx4 v105, s[4:7], s80 offen offset:1024 lds
  buffer_load_dwordx4 v106, s[4:7], s80 offen offset:2048 lds
  buffer_load_dwordx4 v107, s[4:7], s80 offen offset:3072 lds
  s_and_b32 s39, s37, 7
  s_lshr_b32 s38, s37, 3
  s_lshr_b32 s31, s39, 1
  s_lshl2_add_u32 s30, s31, s30
  s_lshr_b32 s31, s30, 1
  s_and_b32 s32, s30, 1
  s_lshl_b32 s36, s28, 10
  v_lshlrev_b32 v2, 4, v1
  v_lshlrev_b32 v3, 3, v1
  s_waitcnt lgkmcnt(0)
  s_mov_b64 s[20:21], s[90:91]
  s_mov_b64 s[22:23], s[86:87]
  s_movk_i32 s24, 18496
  s_mov_b32 s25, 0
  s_mov_b32 s26, 240448
  s_mov_b32 s27, 0
  s_mov_b32 s16, s94
  s_mov_b32 s17, s95
  s_mov_b32 s18, 46137344
  s_mov_b32 s19, 0x20000
  s_mov_b32 s8, s96
  s_mov_b32 s9, s97
  s_mov_b32 s10, 5308416
  s_mov_b32 s11, 0x20000
  s_mov_b32 s12, s98
  s_mov_b32 s13, s99
  s_mov_b32 s14, 5308416
  s_mov_b32 s15, 0x20000
  s_mov_b32 s100, 7456541
  s_add_u32 m0, s82, 8192
  s_add_u32 s80, s80, 128
  s_cmp_eq_u32 s80, s81
  s_cselect_b32 s80, s83, s80
  buffer_load_dwordx4 v104, s[4:7], s80 offen offset:0 lds
  v_lshrrev_b32 v18, 5, v1
  buffer_load_dwordx4 v105, s[4:7], s80 offen offset:1024 lds
  v_and_b32 v19, 1, v1
  v_lshlrev_b32 v19, 4, v19
  v_mov_b32 v20, 0x3f80
  v_lshlrev_b32 v19, v19, v20
  v_bfe_u32 v20, v1, 2, 1
  v_cmp_eq_u32 vcc, v20, v18
  v_bfe_u32 v20, v1, 1, 1
  s_nop 0
  v_cndmask_b32 v19, 0, v19, vcc
  v_bfe_u32 v21, v1, 3, 2
  v_lshl_add_u32 v20, v21, 1, v20
  s_mov_b32 s84, 0x3f803f80
  v_cmp_eq_u32 vcc, 0, v20
  v_mov_b32 v72, 0
  s_nop 0
  v_cndmask_b32 v21, 0, v19, vcc
  v_accvgpr_write_b32 a160, v21
  v_cmp_eq_u32 vcc, 1, v20
  v_mov_b32 v73, 0
  s_nop 0
  v_cndmask_b32 v21, 0, v19, vcc
  v_accvgpr_write_b32 a161, v21
  v_cmp_eq_u32 vcc, 2, v20
  v_mov_b32 v74, 0
  s_nop 0
  v_cndmask_b32 v21, 0, v19, vcc
  v_accvgpr_write_b32 a162, v21
  v_cmp_eq_u32 vcc, 3, v20
  v_mov_b32 v75, 0
  s_nop 0
  v_cndmask_b32 v21, 0, v19, vcc
  v_accvgpr_write_b32 a163, v21
  v_cmp_eq_u32 vcc, 4, v20
  v_mov_b32 v76, 0
  s_nop 0
  v_cndmask_b32 v21, 0, v19, vcc
  v_accvgpr_write_b32 a164, v21
  v_cmp_eq_u32 vcc, 5, v20
  v_mov_b32 v77, 0
  s_nop 0
  v_cndmask_b32 v21, 0, v19, vcc
  v_accvgpr_write_b32 a165, v21
  v_cmp_eq_u32 vcc, 6, v20
  v_mov_b32 v78, 0
  s_nop 0
  v_cndmask_b32 v21, 0, v19, vcc
  v_accvgpr_write_b32 a166, v21
  v_cmp_eq_u32 vcc, 7, v20
  v_mov_b32 v79, 0
  s_nop 0
  v_cndmask_b32 v21, 0, v19, vcc
  v_accvgpr_write_b32 a167, v21
  s_lshl_b32 s91, s28, 3
  v_add_u32 v13, s91, v12
  v_bfe_u32 v15, v12, 1, 1
  v_lshlrev_b32 v16, 2, v15
  v_xor_b32 v16, v16, v14
  v_mul_u32_u24 v4, 9216, v13
  v_lshl_add_u32 v4, v16, 4, v4
  s_mul_i32 s91, s30, 576
  s_lshl_b32 s92, s32, 6
  s_add_u32 s92, s92, s91
  v_add_u32 v4, s92, v4
  v_and_b32 v12, 31, v1
  v_lshrrev_b32 v13, 5, v1
  v_bfe_u32 v14, v12, 1, 3
  v_xor_b32 v14, v14, v13
  v_lshlrev_b32 v15, 7, v12
  v_add_u32 v15, s82, v15
  v_xor_b32 v16, 0, v14
  v_lshl_add_u32 v108, v16, 4, v15
  v_xor_b32 v16, 2, v14
  v_lshl_add_u32 v109, v16, 4, v15
  v_xor_b32 v16, 4, v14
  v_lshl_add_u32 v110, v16, 4, v15
  v_xor_b32 v16, 6, v14
  v_lshl_add_u32 v111, v16, 4, v15
  s_mul_i32 s40, s35, 294912
  s_add_u32 s41, s40, 294912
  s_cmp_eq_u32 s41, 5308416
  s_cselect_b32 s41, 0, s41
  s_add_u32 s42, s41, 294912
  s_cmp_eq_u32 s42, 5308416
  s_cselect_b32 s42, 0, s42
  s_add_u32 s43, s42, 294912
  s_cmp_eq_u32 s43, 5308416
  s_cselect_b32 s43, 0, s43
  s_add_u32 s44, s43, 294912
  s_cmp_eq_u32 s44, 5308416
  s_cselect_b32 s44, 0, s44
  s_add_u32 s45, s44, 294912
  s_cmp_eq_u32 s45, 5308416
  s_cselect_b32 s45, 0, s45
  s_add_u32 s46, s45, 294912
  s_cmp_eq_u32 s46, 5308416
  s_cselect_b32 s46, 0, s46
  s_add_u32 s47, s46, 294912
  s_cmp_eq_u32 s47, 5308416
  s_cselect_b32 s47, 0, s47
  s_add_u32 s48, s47, 294912
  s_cmp_eq_u32 s48, 5308416
  s_cselect_b32 s48, 0, s48
  s_add_u32 s49, s48, 294912
  s_cmp_eq_u32 s49, 5308416
  s_cselect_b32 s49, 0, s49
  s_add_u32 s50, s49, 294912
  s_cmp_eq_u32 s50, 5308416
  s_cselect_b32 s50, 0, s50
  s_add_u32 s51, s50, 294912
  s_cmp_eq_u32 s51, 5308416
  s_cselect_b32 s51, 0, s51
  s_add_u32 s52, s51, 294912
  s_cmp_eq_u32 s52, 5308416
  s_cselect_b32 s52, 0, s52
  s_add_u32 s53, s52, 294912
  s_cmp_eq_u32 s53, 5308416
  s_cselect_b32 s53, 0, s53
  s_add_u32 s54, s53, 294912
  s_cmp_eq_u32 s54, 5308416
  s_cselect_b32 s54, 0, s54
  s_add_u32 s55, s54, 294912
  s_cmp_eq_u32 s55, 5308416
  s_cselect_b32 s55, 0, s55
  s_add_u32 s56, s55, 294912
  s_cmp_eq_u32 s56, 5308416
  s_cselect_b32 s56, 0, s56
  s_add_u32 s57, s56, 294912
  s_cmp_eq_u32 s57, 5308416
  s_cselect_b32 s57, 0, s57
  s_cmp_ge_u32 s30, 8
  s_addc_u32 s76, s30, 0
  s_lshl_b32 s77, s31, 1
  s_cmp_gt_u32 s31, 0
  s_addc_u32 s77, s77, 0
  s_cmp_gt_u32 s31, 2
  s_addc_u32 s77, s77, 0
  s_lshr_b32 s91, s38, 2
  s_sub_u32 s92, s38, s91
  s_sub_u32 s92, s92, 1
  s_max_i32 s92, s92, 0
  s_cmp_ge_u32 s39, 4
  s_cselect_b32 s78, s92, s38
  s_add_u32 s92, s91, 24
  s_lshr_b32 s91, s91, 1
  s_add_u32 s91, s91, 32
  s_bitcmp1_b32 s38, 0
  s_cselect_b32 s79, s91, s92
  s_and_b32 s91, s38, 7
  s_cmp_eq_u32 s91, 3
  s_cselect_b32 s85, 1, 0
  s_and_b32 s91, s30, 11
  s_cmp_eq_u32 s91, 10
  s_cselect_b32 s85, 1, s85
  v_lshrrev_b32 v34, 3, v1
  s_lshl_b32 s94, s28, 3
  v_add_u32 v35, s94, v34
  v_bfe_u32 v34, v34, 1, 1
  v_bfe_u32 v36, v35, 4, 1
  v_lshl_add_u32 v36, v36, 1, v34
  v_lshlrev_b32 v36, 1, v36
  v_and_b32 v34, 7, v1
  v_xor_b32 v36, v36, v34
  v_mul_u32_u24 v6, 1152, v35
  v_lshl_add_u32 v6, v36, 4, v6
  s_mul_i32 s94, s32, 640
  s_lshr_b32 s95, s31, 1
  s_add_u32 s95, s95, 1
  s_and_b32 s95, s95, 3
  s_lshl_b32 s95, s95, 7
  s_add_u32 s94, s94, s95
  v_add_u32 v6, s94, v6
  v_lshrrev_b32 v34, 2, v1
  v_and_b32 v36, 3, v1
  s_and_b32 s99, s28, 1
  s_lshl_b32 s95, s99, 4
  s_lshr_b32 s94, s28, 1
  s_lshl_b32 s94, s94, 5
  s_add_u32 s95, s95, s94
  v_add_u32 v35, s95, v34
  v_mul_u32_u24 v5, 9216, v35
  v_lshl_add_u32 v5, v36, 4, v5
  s_mul_i32 s94, s30, 576
  s_lshl_b32 s95, s32, 9
  s_sub_u32 s94, s94, s95
  s_add_u32 s94, s94, 512
  v_add_u32 v5, s94, v5
  s_lshl_b32 s99, s99, 1
  v_xor_b32 v36, s99, v36
  v_mul_u32_u24 v7, 1152, v35
  v_lshl_add_u32 v7, v36, 4, v7
  s_lshl_b32 s94, s32, 6
  s_add_u32 s94, s94, 512
  v_add_u32 v7, s94, v7
  s_cmp_lt_u32 s76, 9
  s_cselect_b32 s91, 2, -287
  s_lshl_b32 s92, s76, 5
  s_add_i32 s91, s91, s92
  s_lshl_b32 s92, s35, 1
  s_add_u32 s92, s92, s28
  s_lshl_b32 s92, s92, 4
  v_and_b32 v16, 30, v1
  v_add_u32 v16, s91, v16
  v_lshrrev_b32 v17, 5, v1
  v_lshl_add_u32 v17, v17, 3, s92
  v_mul_u32_u24 v17, v16, v17
  v_mul_hi_u32 v19, v17, s100
  v_mul_u32_u24 v19, 576, v19
  v_sub_u32 v17, v17, v19
  v_lshlrev_b32 v18, 6, v16
  v_mul_hi_u32 v19, v18, s100
  v_mul_u32_u24 v19, 576, v19
  v_sub_u32 v18, v18, v19
  v_and_b32 v19, 1, v1
  v_cvt_f32_u32 v19, v19
  v_mul_f32 v19, 0x3e800000, v19
  v_cvt_f32_u32 v16, v16
  v_cvt_f32_u32 v17, v17
  v_cvt_f32_u32 v18, v18
  v_mul_f32 v16, 0x3ae38e39, v16
  v_fmamk_f32 v17, v17, 0x3ae38e39, v19
  v_cos_f32 v19, v16
  v_mul_f32 v18, 0x3ae38e39, v18
  v_add_f32 v19, v19, v19
  v_add_f32 v23, v17, v16
  v_cos_f32 v22, v17
  v_cos_f32 v23, v23
  s_nop 0
  v_fma_f32 v24, v19, v23, -v22
  v_fma_f32 v25, v19, v24, -v23
  v_cvt_pk_bf16_f32 v80, v22, v23
  v_fma_f32 v26, v19, v25, -v24
  v_fma_f32 v27, v19, v26, -v25
  v_cvt_pk_bf16_f32 v81, v24, v25
  v_fma_f32 v28, v19, v27, -v26
  v_fma_f32 v29, v19, v28, -v27
  v_cvt_pk_bf16_f32 v82, v26, v27
  v_cvt_pk_bf16_f32 v83, v28, v29
  v_add_f32 v17, v17, v18
  v_add_f32 v23, v17, v16
  v_cos_f32 v22, v17
  v_cos_f32 v23, v23
  s_nop 0
  v_fma_f32 v24, v19, v23, -v22
  v_fma_f32 v25, v19, v24, -v23
  v_cvt_pk_bf16_f32 v84, v22, v23
  v_fma_f32 v26, v19, v25, -v24
  v_fma_f32 v27, v19, v26, -v25
  v_cvt_pk_bf16_f32 v85, v24, v25
  v_fma_f32 v28, v19, v27, -v26
  v_fma_f32 v29, v19, v28, -v27
  v_cvt_pk_bf16_f32 v86, v26, v27
  v_cvt_pk_bf16_f32 v87, v28, v29
  v_add_f32 v17, v17, v18
  v_add_f32 v23, v17, v16
  v_cos_f32 v22, v17
  v_cos_f32 v23, v23
  s_nop 0
  v_fma_f32 v24, v19, v23, -v22
  v_fma_f32 v25, v19, v24, -v23
  v_cvt_pk_bf16_f32 v88, v22, v23
  v_fma_f32 v26, v19, v25, -v24
  v_fma_f32 v27, v19, v26, -v25
  v_cvt_pk_bf16_f32 v89, v24, v25
  v_fma_f32 v28, v19, v27, -v26
  v_fma_f32 v29, v19, v28, -v27
  v_cvt_pk_bf16_f32 v90, v26, v27
  v_cvt_pk_bf16_f32 v91, v28, v29
  v_add_f32 v17, v17, v18
  v_add_f32 v23, v17, v16
  v_cos_f32 v22, v17
  v_cos_f32 v23, v23
  s_nop 0
  v_fma_f32 v24, v19, v23, -v22
  v_fma_f32 v25, v19, v24, -v23
  v_cvt_pk_bf16_f32 v92, v22, v23
  v_fma_f32 v26, v19, v25, -v24
  v_fma_f32 v27, v19, v26, -v25
  v_cvt_pk_bf16_f32 v93, v24, v25
  v_fma_f32 v28, v19, v27, -v26
  v_fma_f32 v29, v19, v28, -v27
  v_cvt_pk_bf16_f32 v94, v26, v27
  v_cvt_pk_bf16_f32 v95, v28, v29
  v_add_f32 v17, v17, v18
  v_add_f32 v23, v17, v16
  v_cos_f32 v22, v17
  v_cos_f32 v23, v23
  s_nop 0
  v_fma_f32 v24, v19, v23, -v22
  v_fma_f32 v25, v19, v24, -v23
  v_cvt_pk_bf16_f32 v96, v22, v23
  buffer_load_dwordx4 v106, s[4:7], s80 offen offset:2048 lds
  v_fma_f32 v26, v19, v25, -v24
  v_fma_f32 v27, v19, v26, -v25
  v_cvt_pk_bf16_f32 v97, v24, v25
  v_fma_f32 v28, v19, v27, -v26
  v_fma_f32 v29, v19, v28, -v27
  v_cvt_pk_bf16_f32 v98, v26, v27
  v_cvt_pk_bf16_f32 v99, v28, v29
  s_lshr_b32 s92, 0x1100, s30
  s_bitcmp1_b32 s92, 0
  s_cbranch_scc0 L_fd2
  s_cmp_eq_u32 s30, 8
  s_cselect_b32 s98, 8, 17
  s_cmp_lt_u32 s98, 9
  s_cselect_b32 s91, 2, -287
  s_lshl_b32 s92, s98, 5
  s_add_i32 s91, s91, s92
  s_lshl_b32 s92, s35, 1
  s_add_u32 s92, s92, s28
  s_lshl_b32 s92, s92, 4
  v_and_b32 v16, 30, v1
  v_add_u32 v16, s91, v16
  v_lshrrev_b32 v17, 5, v1
  v_lshl_add_u32 v17, v17, 3, s92
  v_mul_u32_u24 v17, v16, v17
  v_mul_hi_u32 v19, v17, s100
  v_mul_u32_u24 v19, 576, v19
  v_sub_u32 v17, v17, v19
  v_lshlrev_b32 v18, 6, v16
  v_mul_hi_u32 v19, v18, s100
  v_mul_u32_u24 v19, 576, v19
  v_sub_u32 v18, v18, v19
  v_and_b32 v19, 1, v1
  v_cvt_f32_u32 v19, v19
  v_mul_f32 v19, 0x3e800000, v19
  v_cvt_f32_u32 v16, v16
  v_cvt_f32_u32 v17, v17
  v_cvt_f32_u32 v18, v18
  v_mul_f32 v16, 0x3ae38e39, v16
  v_fmamk_f32 v17, v17, 0x3ae38e39, v19
  v_cos_f32 v19, v16
  v_mul_f32 v18, 0x3ae38e39, v18
  v_add_f32 v19, v19, v19
  v_add_f32 v23, v17, v16
  v_cos_f32 v22, v17
  v_cos_f32 v23, v23
  s_nop 0
  v_fma_f32 v24, v19, v23, -v22
  v_fma_f32 v25, v19, v24, -v23
  v_cvt_pk_bf16_f32 v56, v22, v23
  v_fma_f32 v26, v19, v25, -v24
  v_fma_f32 v27, v19, v26, -v25
  v_cvt_pk_bf16_f32 v57, v24, v25
  v_fma_f32 v28, v19, v27, -v26
  v_fma_f32 v29, v19, v28, -v27
  v_cvt_pk_bf16_f32 v58, v26, v27
  v_cvt_pk_bf16_f32 v59, v28, v29
  v_add_f32 v17, v17, v18
  v_add_f32 v23, v17, v16
  v_cos_f32 v22, v17
  v_cos_f32 v23, v23
  s_nop 0
  v_fma_f32 v24, v19, v23, -v22
  v_fma_f32 v25, v19, v24, -v23
  v_cvt_pk_bf16_f32 v60, v22, v23
  v_fma_f32 v26, v19, v25, -v24
  v_fma_f32 v27, v19, v26, -v25
  v_cvt_pk_bf16_f32 v61, v24, v25
  v_fma_f32 v28, v19, v27, -v26
  v_fma_f32 v29, v19, v28, -v27
  v_cvt_pk_bf16_f32 v62, v26, v27
  v_cvt_pk_bf16_f32 v63, v28, v29
  v_add_f32 v17, v17, v18
  v_add_f32 v23, v17, v16
  v_cos_f32 v22, v17
  v_cos_f32 v23, v23
  s_nop 0
  v_fma_f32 v24, v19, v23, -v22
  v_fma_f32 v25, v19, v24, -v23
  v_cvt_pk_bf16_f32 v64, v22, v23
  v_fma_f32 v26, v19, v25, -v24
  v_fma_f32 v27, v19, v26, -v25
  v_cvt_pk_bf16_f32 v65, v24, v25
  v_fma_f32 v28, v19, v27, -v26
  v_fma_f32 v29, v19, v28, -v27
  v_cvt_pk_bf16_f32 v66, v26, v27
  v_cvt_pk_bf16_f32 v67, v28, v29
  v_add_f32 v17, v17, v18
  v_add_f32 v23, v17, v16
  v_cos_f32 v22, v17
  v_cos_f32 v23, v23
  s_nop 0
  v_fma_f32 v24, v19, v23, -v22
  v_fma_f32 v25, v19, v24, -v23
  v_cvt_pk_bf16_f32 v68, v22, v23
  v_fma_f32 v26, v19, v25, -v24
  v_fma_f32 v27, v19, v26, -v25
  v_cvt_pk_bf16_f32 v69, v24, v25
  v_fma_f32 v28, v19, v27, -v26
  v_fma_f32 v29, v19, v28, -v27
  v_cvt_pk_bf16_f32 v70, v26, v27
  v_cvt_pk_bf16_f32 v71, v28, v29
  v_add_f32 v17, v17, v18
  v_add_f32 v23, v17, v16
  v_cos_f32 v22, v17
  v_cos_f32 v23, v23
  s_nop 0
  v_fma_f32 v24, v19, v23, -v22
  v_fma_f32 v25, v19, v24, -v23
  v_cvt_pk_bf16_f32 v100, v22, v23
  v_fma_f32 v26, v19, v25, -v24
  v_fma_f32 v27, v19, v26, -v25
  v_cvt_pk_bf16_f32 v101, v24, v25
  v_fma_f32 v28, v19, v27, -v26
  v_fma_f32 v29, v19, v28, -v27
  v_cvt_pk_bf16_f32 v102, v26, v27
  v_cvt_pk_bf16_f32 v103, v28, v29
L_fd2:
  v_and_b32 v12, 15, v1
  v_lshrrev_b32 v13, 4, v1
  v_lshrrev_b32 v17, 5, v1
  v_lshlrev_b32 v17, 8, v17
  v_add_u32 v17, s33, v17
  v_cvt_f32_u32 v17, v17
  v_mul_f32 v17, 0x3a000000, v17
  v_and_b32 v18, 31, v1
  v_cvt_f32_u32 v18, v18
  v_mul_f32 v19, v18, v17
  v_mov_b32 v22, v19
  v_fmamk_f32 v23, v18, 0x3d000000, v19
  v_fmamk_f32 v24, v18, 0x3d800000, v19
  v_fmamk_f32 v25, v18, 0x3dc00000, v19
  v_sin_f32 v26, v22
  v_sin_f32 v27, v23
  v_sin_f32 v28, v24
  v_sin_f32 v29, v25
  v_cos_f32 v22, v22
  v_cos_f32 v23, v23
  v_cos_f32 v24, v24
  v_cos_f32 v25, v25
  buffer_load_dwordx4 v107, s[4:7], s80 offen offset:3072 lds
  v_cvt_pk_bf16_f32 v48, v26, v27
  v_cvt_pk_bf16_f32 v49, v28, v29
  v_cvt_pk_bf16_f32 v40, v22, v23
  v_cvt_pk_bf16_f32 v41, v24, v25
  v_fmamk_f32 v22, v18, 0x3e800000, v19
  v_fmamk_f32 v23, v18, 0x3e900000, v19
  v_fmamk_f32 v24, v18, 0x3ea00000, v19
  v_fmamk_f32 v25, v18, 0x3eb00000, v19
  v_sin_f32 v26, v22
  v_sin_f32 v27, v23
  v_sin_f32 v28, v24
  v_sin_f32 v29, v25
  v_cos_f32 v22, v22
  v_cos_f32 v23, v23
  v_cos_f32 v24, v24
  v_cos_f32 v25, v25
  v_cvt_pk_bf16_f32 v50, v26, v27
  v_cvt_pk_bf16_f32 v51, v28, v29
  v_cvt_pk_bf16_f32 v42, v22, v23
  v_cvt_pk_bf16_f32 v43, v24, v25
  v_fmamk_f32 v22, v18, 0x3f000000, v19
  v_fmamk_f32 v23, v18, 0x3f080000, v19
  v_fmamk_f32 v24, v18, 0x3f100000, v19
  v_fmamk_f32 v25, v18, 0x3f180000, v19
  v_sin_f32 v26, v22
  v_sin_f32 v27, v23
  v_sin_f32 v28, v24
  v_sin_f32 v29, v25
  s_add_u32 m0, s82, 12288
  s_add_u32 s80, s80, 128
  s_cmp_eq_u32 s80, s81
  s_cselect_b32 s80, s83, s80
  buffer_load_dwordx4 v104, s[4:7], s80 offen offset:0 lds
  v_cos_f32 v22, v22
  v_cos_f32 v23, v23
  v_cos_f32 v24, v24
  v_cos_f32 v25, v25
  v_cvt_pk_bf16_f32 v52, v26, v27
  v_cvt_pk_bf16_f32 v53, v28, v29
  v_cvt_pk_bf16_f32 v44, v22, v23
  v_cvt_pk_bf16_f32 v45, v24, v25
  v_fmamk_f32 v22, v18, 0x3f400000, v19
  v_fmamk_f32 v23, v18, 0x3f480000, v19
  v_fmamk_f32 v24, v18, 0x3f500000, v19
  v_fmamk_f32 v25, v18, 0x3f580000, v19
  v_sin_f32 v26, v22
  v_sin_f32 v27, v23
  v_sin_f32 v28, v24
  v_sin_f32 v29, v25
  v_cos_f32 v22, v22
  v_cos_f32 v23, v23
  v_cos_f32 v24, v24
  v_cos_f32 v25, v25
  v_cvt_pk_bf16_f32 v54, v26, v27
  v_cvt_pk_bf16_f32 v55, v28, v29
  v_cvt_pk_bf16_f32 v46, v22, v23
  v_cvt_pk_bf16_f32 v47, v24, v25
  s_cmp_eq_u32 s30, 2
  s_cselect_b32 s91, s33, 0
  s_cmp_ge_u32 s91, 48
  s_cbranch_scc0 L_cs
  s_and_b32 s91, s33, 1
  s_lshl_b32 s91, s91, 5
  s_bfe_u32 s92, s33, 0x20001
  s_lshl_b32 s92, s92, 4
  s_bitcmp1_b32 s33, 3
  s_cselect_b32 s93, 0xbe800000, 0
  v_add_u32 v18, s92, v12
  v_cvt_f32_u32 v18, v18
  v_mul_f32 v18, 0x3c800000, v18
  v_lshl_add_u32 v19, v13, 2, s91
  v_cvt_f32_u32 v19, v19
  v_fma_f32 v19, v19, v18, s93
  v_mov_b32 v22, v19
  v_fmamk_f32 v23, v18, 0x3f800000, v19
  v_fmamk_f32 v24, v18, 0x40000000, v19
  v_fmamk_f32 v25, v18, 0x40400000, v19
  v_cos_f32 v22, v22
  v_cos_f32 v23, v23
  v_cos_f32 v24, v24
  v_cos_f32 v25, v25
  v_cvt_pk_bf16_f32 v30, v22, v23
  v_cvt_pk_bf16_f32 v31, v24, v25
  v_fmamk_f32 v22, v18, 0x41800000, v19
  v_fmamk_f32 v23, v18, 0x41880000, v19
  v_fmamk_f32 v24, v18, 0x41900000, v19
  v_fmamk_f32 v25, v18, 0x41980000, v19
  v_cos_f32 v22, v22
  v_cos_f32 v23, v23
  v_cos_f32 v24, v24
  v_cos_f32 v25, v25
  v_cvt_pk_bf16_f32 v32, v22, v23
  v_cvt_pk_bf16_f32 v33, v24, v25
  s_and_b32 s92, s33, 15
  s_lshl_b32 s92, s92, 10
  s_add_u32 s91, s92, 65536
  buffer_store_dwordx4 v[30:33], v2, s[16:19], s91 offen sc1
L_cs:
  buffer_load_dwordx4 v105, s[4:7], s80 offen offset:1024 lds
  s_lshr_b32 s92, 5, s31
  s_bitcmp1_b32 s92, 0
  s_cselect_b32 s91, 54, 36
  s_cmp_lt_u32 s33, s91
  s_cbranch_scc0 L_gt
  s_mul_i32 s91, s33, 57
  s_lshr_b32 s91, s91, 10
  s_mul_i32 s92, s91, 18
  s_sub_u32 s92, s33, s92
  s_or_b32 s93, s31, 1
  s_add_u32 s93, s93, 1
  s_lshl_b32 s93, s93, 1
  s_add_u32 s93, s93, s92
  s_and_b32 s93, s93, 15
  s_andn2_b32 s94, 1, s31
  s_lshl_b32 s94, s94, 1
  s_xor_b32 s93, s93, s94
  s_lshl_b32 s93, s93, 4
  s_mul_i32 s94, s32, 320
  s_add_u32 s94, s94, s93
  s_lshl_b32 s93, s92, 4
  s_lshl_b32 s95, s32, 5
  s_add_u32 s95, s95, s93
  s_cmp_lt_u32 s92, 16
  s_cselect_b32 s94, s94, s95
  s_add_u32 s91, s91, s77
  s_lshl_b32 s91, s91, 1
  s_cmp_lt_u32 s91, 18
  s_cselect_b32 s95, 2, -287
  s_lshl_b32 s99, s91, 4
  s_add_i32 s95, s95, s99
  v_add_u32 v17, s94, v12
  v_lshl_add_u32 v18, v13, 2, s95
  v_mov_b32 v26, 0x35e38e39
  v_mov_b32 v27, 0x35638e39
  v_add_u32 v19, 0, v18
  v_cmp_eq_u32 vcc, 0x120, v19
  v_mul_u32_u24 v19, v19, v17
  v_mul_hi_u32 v20, v19, s100
  v_mul_u32_u24 v20, 576, v20
  v_sub_u32 v19, v19, v20
  v_cndmask_b32 v20, v26, v27, vcc
  v_cvt_f32_u32 v19, v19
  v_mul_f32 v22, 0x3ae38e39, v19
  v_add_f32 v23, 0x3e800000, v22
  v_cos_f32 v22, v22
  v_cos_f32 v23, v23
  v_mul_f32 v22, v22, v20
  v_mul_f32 v23, v23, v20
  v_cvt_pk_bf16_f32 v34, v22, v23
  v_add_u32 v19, 2, v18
  v_cmp_eq_u32 vcc, 0x120, v19
  v_mul_u32_u24 v19, v19, v17
  v_mul_hi_u32 v20, v19, s100
  v_mul_u32_u24 v20, 576, v20
  v_sub_u32 v19, v19, v20
  v_cndmask_b32 v20, v26, v27, vcc
  v_cvt_f32_u32 v19, v19
  v_mul_f32 v22, 0x3ae38e39, v19
  v_add_f32 v23, 0x3e800000, v22
  v_cos_f32 v22, v22
  v_cos_f32 v23, v23
  v_mul_f32 v22, v22, v20
  v_mul_f32 v23, v23, v20
  v_cvt_pk_bf16_f32 v35, v22, v23
  v_add_u32 v19, 16, v18
  v_cmp_eq_u32 vcc, 0x120, v19
  v_mul_u32_u24 v19, v19, v17
  v_mul_hi_u32 v20, v19, s100
  v_mul_u32_u24 v20, 576, v20
  v_sub_u32 v19, v19, v20
  v_cndmask_b32 v20, v26, v27, vcc
  v_cvt_f32_u32 v19, v19
  v_mul_f32 v22, 0x3ae38e39, v19
  v_add_f32 v23, 0x3e800000, v22
  v_cos_f32 v22, v22
  v_cos_f32 v23, v23
  v_mul_f32 v22, v22, v20
  v_mul_f32 v23, v23, v20
  v_cvt_pk_bf16_f32 v36, v22, v23
  v_add_u32 v19, 18, v18
  v_cmp_eq_u32 vcc, 0x120, v19
  v_mul_u32_u24 v19, v19, v17
  v_mul_hi_u32 v20, v19, s100
  v_mul_u32_u24 v20, 576, v20
  v_sub_u32 v19, v19, v20
  v_cndmask_b32 v20, v26, v27, vcc
  v_cvt_f32_u32 v19, v19
  v_mul_f32 v22, 0x3ae38e39, v19
  v_add_f32 v23, 0x3e800000, v22
  v_cos_f32 v22, v22
  v_cos_f32 v23, v23
  v_mul_f32 v22, v22, v20
  v_mul_f32 v23, v23, v20
  v_cvt_pk_bf16_f32 v37, v22, v23
  s_mul_i32 s91, s30, 55296
  s_lshl_b32 s92, s33, 10
  s_add_u32 s91, s91, s92
  s_add_u32 s91, s91, 327680
  buffer_store_dwordx4 v[34:37], v2, s[16:19], s91 offen sc1
L_gt:
  s_and_b32 s96, s29, 7
  s_lshl_b32 s96, s96, 2
  s_add_u32 s96, s96, s28
  s_mul_i32 s96, s96, 165888
  s_mul_i32 s97, s30, 576
  s_add_u32 s96, s96, s97
  v_min_u32 v8, 17, v1
  v_mul_u32_u24 v8, 9216, v8
  v_add_u32 v8, s96, v8
  s_lshl_b32 s96, s38, 6
  s_lshl_b32 s97, s39, 2
  s_add_u32 s96, s96, s97
  s_mul_i32 s96, s96, 578
  s_mul_i32 s97, s28, 640
  s_add_u32 s97, s96, s97
  v_lshrrev_b32 v20, 1, v1
  v_min_u32 v20, 9, v20
  v_mul_u32_u24 v9, 52, v20
  v_lshrrev_b32 v9, 8, v9
  v_mul_u32_u24 v9, 17856, v9
  v_lshl_add_u32 v20, v20, 7, v9
  v_add_u32 v20, s97, v20
  v_min_u32 v20, 1183742, v20
  v_and_b32 v10, 1, v1
  v_cmp_eq_u32 vcc, 0, v10
  v_mov_b32 v10, s22
  v_mov_b32 v11, s20
  v_cndmask_b32 v10, v10, v11, vcc
  v_add_co_u32 v10, s[98:99], v10, v20
  v_mov_b32 v20, s23
  v_mov_b32 v11, s21
  v_cndmask_b32 v11, v20, v11, vcc
  buffer_load_dwordx4 v106, s[4:7], s80 offen offset:2048 lds
  v_addc_co_u32 v11, vcc, 0, v11, s[98:99]
  s_lshl_b32 s96, s32, 6
  s_mov_b32 s38, s39
  buffer_load_dwordx4 v107, s[4:7], s80 offen offset:3072 lds
  s_add_u32 m0, s82, 16384
  s_add_u32 s80, s80, 128
  s_cmp_eq_u32 s80, s81
  s_cselect_b32 s80, s83, s80
  buffer_load_dwordx4 v104, s[4:7], s80 offen offset:0 lds
  buffer_load_dwordx4 v105, s[4:7], s80 offen offset:1024 lds
  buffer_load_dwordx4 v106, s[4:7], s80 offen offset:2048 lds
  buffer_load_dwordx4 v107, s[4:7], s80 offen offset:3072 lds
  s_waitcnt vmcnt(16)
  ds_read_b128 v[112:115], v108 offset:0
  ds_read_b128 v[116:119], v109 offset:0
  ds_read_b128 v[120:123], v110 offset:0
  ds_read_b128 v[124:127], v111 offset:0
  s_add_u32 m0, s82, 20480
  s_add_u32 s80, s80, 128
  s_cmp_eq_u32 s80, s81
  s_cselect_b32 s80, s83, s80
  buffer_load_dwordx4 v104, s[4:7], s80 offen offset:0 lds
  buffer_load_dwordx4 v105, s[4:7], s80 offen offset:1024 lds
  buffer_load_dwordx4 v106, s[4:7], s80 offen offset:2048 lds
  buffer_load_dwordx4 v107, s[4:7], s80 offen offset:3072 lds
  s_waitcnt vmcnt(16)
  ds_read_b128 v[128:131], v108 offset:4096
  ds_read_b128 v[132:135], v109 offset:4096
  ds_read_b128 v[136:139], v110 offset:4096
  ds_read_b128 v[140:143], v111 offset:4096
  s_waitcnt lgkmcnt(4)
  v_dot2c_f32_bf16 v72, v112, v112
  v_dot2c_f32_bf16 v76, s84, v112
  v_dot2c_f32_bf16 v73, v113, v113
  v_dot2c_f32_bf16 v77, s84, v113
  v_dot2c_f32_bf16 v74, v114, v114
  v_dot2c_f32_bf16 v78, s84, v114
  v_dot2c_f32_bf16 v75, v115, v115
  v_dot2c_f32_bf16 v79, s84, v115
  v_dot2c_f32_bf16 v72, v116, v116
  v_dot2c_f32_bf16 v76, s84, v116
  v_dot2c_f32_bf16 v73, v117, v117
  v_dot2c_f32_bf16 v77, s84, v117
  v_dot2c_f32_bf16 v74, v118, v118
  v_dot2c_f32_bf16 v78, s84, v118
  v_dot2c_f32_bf16 v75, v119, v119
  v_dot2c_f32_bf16 v79, s84, v119
  v_dot2c_f32_bf16 v72, v120, v120
  v_dot2c_f32_bf16 v76, s84, v120
  v_dot2c_f32_bf16 v73, v121, v121
  v_dot2c_f32_bf16 v77, s84, v121
  v_dot2c_f32_bf16 v74, v122, v122
  v_dot2c_f32_bf16 v78, s84, v122
  v_dot2c_f32_bf16 v75, v123, v123
  v_dot2c_f32_bf16 v79, s84, v123
  v_dot2c_f32_bf16 v72, v124, v124
  v_dot2c_f32_bf16 v76, s84, v124
  v_dot2c_f32_bf16 v73, v125, v125
  v_dot2c_f32_bf16 v77, s84, v125
  v_dot2c_f32_bf16 v74, v126, v126
  v_dot2c_f32_bf16 v78, s84, v126
  v_dot2c_f32_bf16 v75, v127, v127
  v_dot2c_f32_bf16 v79, s84, v127
  s_add_u32 m0, s82, 24576
  s_add_u32 s80, s80, 128
  s_cmp_eq_u32 s80, s81
  s_cselect_b32 s80, s83, s80
  buffer_load_dwordx4 v104, s[4:7], s80 offen offset:0 lds
  buffer_load_dwordx4 v105, s[4:7], s80 offen offset:1024 lds
  buffer_load_dwordx4 v106, s[4:7], s80 offen offset:2048 lds
  buffer_load_dwordx4 v107, s[4:7], s80 offen offset:3072 lds
  s_waitcnt vmcnt(16)
  ds_read_b128 v[144:147], v108 offset:8192
  ds_read_b128 v[148:151], v109 offset:8192
  ds_read_b128 v[152:155], v110 offset:8192
  ds_read_b128 v[156:159], v111 offset:8192
  s_waitcnt lgkmcnt(4)
  v_dot2c_f32_bf16 v72, v128, v128
  v_dot2c_f32_bf16 v76, s84, v128
  v_dot2c_f32_bf16 v73, v129, v129
  v_dot2c_f32_bf16 v77, s84, v129
  v_dot2c_f32_bf16 v74, v130, v130
  v_dot2c_f32_bf16 v78, s84, v130
  v_dot2c_f32_bf16 v75, v131, v131
  v_dot2c_f32_bf16 v79, s84, v131
  v_dot2c_f32_bf16 v72, v132, v132
  v_dot2c_f32_bf16 v76, s84, v132
  v_dot2c_f32_bf16 v73, v133, v133
  v_dot2c_f32_bf16 v77, s84, v133
  v_dot2c_f32_bf16 v74, v134, v134
  v_dot2c_f32_bf16 v78, s84, v134
  v_dot2c_f32_bf16 v75, v135, v135
  v_dot2c_f32_bf16 v79, s84, v135
  v_dot2c_f32_bf16 v72, v136, v136
  v_dot2c_f32_bf16 v76, s84, v136
  v_dot2c_f32_bf16 v73, v137, v137
  v_dot2c_f32_bf16 v77, s84, v137
  v_dot2c_f32_bf16 v74, v138, v138
  v_dot2c_f32_bf16 v78, s84, v138
  v_dot2c_f32_bf16 v75, v139, v139
  v_dot2c_f32_bf16 v79, s84, v139
  v_dot2c_f32_bf16 v72, v140, v140
  v_dot2c_f32_bf16 v76, s84, v140
  v_dot2c_f32_bf16 v73, v141, v141
  v_dot2c_f32_bf16 v77, s84, v141
  v_dot2c_f32_bf16 v74, v142, v142
  v_dot2c_f32_bf16 v78, s84, v142
  v_dot2c_f32_bf16 v75, v143, v143
  v_dot2c_f32_bf16 v79, s84, v143
  s_add_u32 m0, s82, 28672
  s_add_u32 s80, s80, 128
  s_cmp_eq_u32 s80, s81
  s_cselect_b32 s80, s83, s80
  buffer_load_dwordx4 v104, s[4:7], s80 offen offset:0 lds
  buffer_load_dwordx4 v105, s[4:7], s80 offen offset:1024 lds
  buffer_load_dwordx4 v106, s[4:7], s80 offen offset:2048 lds
  buffer_load_dwordx4 v107, s[4:7], s80 offen offset:3072 lds
  s_waitcnt vmcnt(16)
  ds_read_b128 v[160:163], v108 offset:12288
  ds_read_b128 v[164:167], v109 offset:12288
  ds_read_b128 v[168:171], v110 offset:12288
  ds_read_b128 v[172:175], v111 offset:12288
  s_waitcnt lgkmcnt(4)
  v_dot2c_f32_bf16 v72, v144, v144
  v_dot2c_f32_bf16 v76, s84, v144
  v_dot2c_f32_bf16 v73, v145, v145
  v_dot2c_f32_bf16 v77, s84, v145
  v_dot2c_f32_bf16 v74, v146, v146
  v_dot2c_f32_bf16 v78, s84, v146
  v_dot2c_f32_bf16 v75, v147, v147
  v_dot2c_f32_bf16 v79, s84, v147
  v_dot2c_f32_bf16 v72, v148, v148
  v_dot2c_f32_bf16 v76, s84, v148
  v_dot2c_f32_bf16 v73, v149, v149
  v_dot2c_f32_bf16 v77, s84, v149
  v_dot2c_f32_bf16 v74, v150, v150
  v_dot2c_f32_bf16 v78, s84, v150
  v_dot2c_f32_bf16 v75, v151, v151
  v_dot2c_f32_bf16 v79, s84, v151
  v_dot2c_f32_bf16 v72, v152, v152
  v_dot2c_f32_bf16 v76, s84, v152
  v_dot2c_f32_bf16 v73, v153, v153
  v_dot2c_f32_bf16 v77, s84, v153
  v_dot2c_f32_bf16 v74, v154, v154
  v_dot2c_f32_bf16 v78, s84, v154
  v_dot2c_f32_bf16 v75, v155, v155
  v_dot2c_f32_bf16 v79, s84, v155
  v_dot2c_f32_bf16 v72, v156, v156
  v_dot2c_f32_bf16 v76, s84, v156
  v_dot2c_f32_bf16 v73, v157, v157
  v_dot2c_f32_bf16 v77, s84, v157
  v_dot2c_f32_bf16 v74, v158, v158
  v_dot2c_f32_bf16 v78, s84, v158
  v_dot2c_f32_bf16 v75, v159, v159
  v_dot2c_f32_bf16 v79, s84, v159
  s_add_u32 m0, s82, 32768
  s_add_u32 s80, s80, 128
  s_cmp_eq_u32 s80, s81
  s_cselect_b32 s80, s83, s80
  buffer_load_dwordx4 v104, s[4:7], s80 offen offset:0 lds
  buffer_load_dwordx4 v105, s[4:7], s80 offen offset:1024 lds
  buffer_load_dwordx4 v106, s[4:7], s80 offen offset:2048 lds
  buffer_load_dwordx4 v107, s[4:7], s80 offen offset:3072 lds
  buffer_load_dword a215, off, s[16:19], 0 sc1
  s_barrier
  buffer_load_dword a209, v8, s[8:11], s96 offen offset:0
  buffer_load_dword a210, v8, s[8:11], s96 offen offset:128
  s_waitcnt vmcnt(19)
  ds_read_b128 v[176:179], v108 offset:16384
  ds_read_b128 v[180:183], v109 offset:16384
  ds_read_b128 v[184:187], v110 offset:16384
  ds_read_b128 v[188:191], v111 offset:16384
  s_waitcnt lgkmcnt(4)
  v_dot2c_f32_bf16 v72, v160, v160
  v_dot2c_f32_bf16 v76, s84, v160
  v_dot2c_f32_bf16 v73, v161, v161
  v_dot2c_f32_bf16 v77, s84, v161
  v_dot2c_f32_bf16 v74, v162, v162
  v_dot2c_f32_bf16 v78, s84, v162
  v_dot2c_f32_bf16 v75, v163, v163
  v_dot2c_f32_bf16 v79, s84, v163
  v_dot2c_f32_bf16 v72, v164, v164
  v_dot2c_f32_bf16 v76, s84, v164
  v_dot2c_f32_bf16 v73, v165, v165
  v_dot2c_f32_bf16 v77, s84, v165
  v_dot2c_f32_bf16 v74, v166, v166
  v_dot2c_f32_bf16 v78, s84, v166
  v_dot2c_f32_bf16 v75, v167, v167
  v_dot2c_f32_bf16 v79, s84, v167
  v_dot2c_f32_bf16 v72, v168, v168
  v_dot2c_f32_bf16 v76, s84, v168
  v_dot2c_f32_bf16 v73, v169, v169
  v_dot2c_f32_bf16 v77, s84, v169
  v_dot2c_f32_bf16 v74, v170, v170
  v_dot2c_f32_bf16 v78, s84, v170
  v_dot2c_f32_bf16 v75, v171, v171
  v_dot2c_f32_bf16 v79, s84, v171
  v_dot2c_f32_bf16 v72, v172, v172
  v_dot2c_f32_bf16 v76, s84, v172
  v_dot2c_f32_bf16 v73, v173, v173
  v_dot2c_f32_bf16 v77, s84, v173
  v_dot2c_f32_bf16 v74, v174, v174
  v_dot2c_f32_bf16 v78, s84, v174
  v_dot2c_f32_bf16 v75, v175, v175
  v_dot2c_f32_bf16 v79, s84, v175
  s_waitcnt vmcnt(15)
  ds_read_b128 v[192:195], v108 offset:20480
  ds_read_b128 v[196:199], v109 offset:20480
  ds_read_b128 v[200:203], v110 offset:20480
  ds_read_b128 v[204:207], v111 offset:20480
  s_waitcnt lgkmcnt(4)
  v_dot2c_f32_bf16 v72, v176, v176
  v_dot2c_f32_bf16 v76, s84, v176
  v_dot2c_f32_bf16 v73, v177, v177
  v_dot2c_f32_bf16 v77, s84, v177
  v_dot2c_f32_bf16 v74, v178, v178
  v_dot2c_f32_bf16 v78, s84, v178
  v_dot2c_f32_bf16 v75, v179, v179
  v_dot2c_f32_bf16 v79, s84, v179
  v_dot2c_f32_bf16 v72, v180, v180
  v_dot2c_f32_bf16 v76, s84, v180
  v_dot2c_f32_bf16 v73, v181, v181
  v_dot2c_f32_bf16 v77, s84, v181
  v_dot2c_f32_bf16 v74, v182, v182
  v_dot2c_f32_bf16 v78, s84, v182
  v_dot2c_f32_bf16 v75, v183, v183
  v_dot2c_f32_bf16 v79, s84, v183
  v_dot2c_f32_bf16 v72, v184, v184
  v_dot2c_f32_bf16 v76, s84, v184
  v_dot2c_f32_bf16 v73, v185, v185
  v_dot2c_f32_bf16 v77, s84, v185
  v_dot2c_f32_bf16 v74, v186, v186
  v_dot2c_f32_bf16 v78, s84, v186
  v_dot2c_f32_bf16 v75, v187, v187
  v_dot2c_f32_bf16 v79, s84, v187
  v_dot2c_f32_bf16 v72, v188, v188
  v_dot2c_f32_bf16 v76, s84, v188
  v_dot2c_f32_bf16 v73, v189, v189
  v_dot2c_f32_bf16 v77, s84, v189
  v_dot2c_f32_bf16 v74, v190, v190
  v_dot2c_f32_bf16 v78, s84, v190
  v_dot2c_f32_bf16 v75, v191, v191
  v_dot2c_f32_bf16 v79, s84, v191
  s_waitcnt vmcnt(11)
  ds_read_b128 v[208:211], v108 offset:24576
  ds_read_b128 v[212:215], v109 offset:24576
  ds_read_b128 v[216:219], v110 offset:24576
  ds_read_b128 v[220:223], v111 offset:24576
  s_waitcnt lgkmcnt(4)
  v_dot2c_f32_bf16 v72, v192, v192
  v_dot2c_f32_bf16 v76, s84, v192
  v_dot2c_f32_bf16 v73, v193, v193
  v_dot2c_f32_bf16 v77, s84, v193
  v_dot2c_f32_bf16 v74, v194, v194
  v_dot2c_f32_bf16 v78, s84, v194
  v_dot2c_f32_bf16 v75, v195, v195
  v_dot2c_f32_bf16 v79, s84, v195
  v_dot2c_f32_bf16 v72, v196, v196
  v_dot2c_f32_bf16 v76, s84, v196
  v_dot2c_f32_bf16 v73, v197, v197
  v_dot2c_f32_bf16 v77, s84, v197
  v_dot2c_f32_bf16 v74, v198, v198
  v_dot2c_f32_bf16 v78, s84, v198
  v_dot2c_f32_bf16 v75, v199, v199
  v_dot2c_f32_bf16 v79, s84, v199
  v_dot2c_f32_bf16 v72, v200, v200
  v_dot2c_f32_bf16 v76, s84, v200
  v_dot2c_f32_bf16 v73, v201, v201
  v_dot2c_f32_bf16 v77, s84, v201
  v_dot2c_f32_bf16 v74, v202, v202
  v_dot2c_f32_bf16 v78, s84, v202
  v_dot2c_f32_bf16 v75, v203, v203
  v_dot2c_f32_bf16 v79, s84, v203
  v_dot2c_f32_bf16 v72, v204, v204
  v_dot2c_f32_bf16 v76, s84, v204
  v_dot2c_f32_bf16 v73, v205, v205
  v_dot2c_f32_bf16 v77, s84, v205
  v_dot2c_f32_bf16 v74, v206, v206
  v_dot2c_f32_bf16 v78, s84, v206
  v_dot2c_f32_bf16 v75, v207, v207
  v_dot2c_f32_bf16 v79, s84, v207
  s_waitcnt vmcnt(7)
  ds_read_b128 v[224:227], v108 offset:28672
  ds_read_b128 v[228:231], v109 offset:28672
  ds_read_b128 v[232:235], v110 offset:28672
  ds_read_b128 v[236:239], v111 offset:28672
  s_waitcnt lgkmcnt(4)
  v_dot2c_f32_bf16 v72, v208, v208
  v_dot2c_f32_bf16 v76, s84, v208
  v_dot2c_f32_bf16 v73, v209, v209
  v_dot2c_f32_bf16 v77, s84, v209
  v_dot2c_f32_bf16 v74, v210, v210
  v_dot2c_f32_bf16 v78, s84, v210
  v_dot2c_f32_bf16 v75, v211, v211
  v_dot2c_f32_bf16 v79, s84, v211
  v_dot2c_f32_bf16 v72, v212, v212
  v_dot2c_f32_bf16 v76, s84, v212
  v_dot2c_f32_bf16 v73, v213, v213
  v_dot2c_f32_bf16 v77, s84, v213
  v_dot2c_f32_bf16 v74, v214, v214
  v_dot2c_f32_bf16 v78, s84, v214
  v_dot2c_f32_bf16 v75, v215, v215
  v_dot2c_f32_bf16 v79, s84, v215
  v_dot2c_f32_bf16 v72, v216, v216
  v_dot2c_f32_bf16 v76, s84, v216
  v_dot2c_f32_bf16 v73, v217, v217
  v_dot2c_f32_bf16 v77, s84, v217
  v_dot2c_f32_bf16 v74, v218, v218
  v_dot2c_f32_bf16 v78, s84, v218
  v_dot2c_f32_bf16 v75, v219, v219
  v_dot2c_f32_bf16 v79, s84, v219
  v_dot2c_f32_bf16 v72, v220, v220
  v_dot2c_f32_bf16 v76, s84, v220
  v_dot2c_f32_bf16 v73, v221, v221
  v_dot2c_f32_bf16 v77, s84, v221
  v_dot2c_f32_bf16 v74, v222, v222
  v_dot2c_f32_bf16 v78, s84, v222
  v_dot2c_f32_bf16 v75, v223, v223
  v_dot2c_f32_bf16 v79, s84, v223
  s_waitcnt vmcnt(3)
  ds_read_b128 v[240:243], v108 offset:32768
  ds_read_b128 v[244:247], v109 offset:32768
  ds_read_b128 v[248:251], v110 offset:32768
  ds_read_b128 v[252:255], v111 offset:32768
  s_waitcnt lgkmcnt(4)
  v_dot2c_f32_bf16 v72, v224, v224
  v_dot2c_f32_bf16 v76, s84, v224
  v_dot2c_f32_bf16 v73, v225, v225
  v_dot2c_f32_bf16 v77, s84, v225
  v_dot2c_f32_bf16 v74, v226, v226
  v_dot2c_f32_bf16 v78, s84, v226
  v_dot2c_f32_bf16 v75, v227, v227
  v_dot2c_f32_bf16 v79, s84, v227
  v_dot2c_f32_bf16 v72, v228, v228
  v_dot2c_f32_bf16 v76, s84, v228
  v_dot2c_f32_bf16 v73, v229, v229
  v_dot2c_f32_bf16 v77, s84, v229
  v_dot2c_f32_bf16 v74, v230, v230
  v_dot2c_f32_bf16 v78, s84, v230
  v_dot2c_f32_bf16 v75, v231, v231
  v_dot2c_f32_bf16 v79, s84, v231
  v_dot2c_f32_bf16 v72, v232, v232
  v_dot2c_f32_bf16 v76, s84, v232
  v_dot2c_f32_bf16 v73, v233, v233
  v_dot2c_f32_bf16 v77, s84, v233
  v_dot2c_f32_bf16 v74, v234, v234
  v_dot2c_f32_bf16 v78, s84, v234
  v_dot2c_f32_bf16 v75, v235, v235
  v_dot2c_f32_bf16 v79, s84, v235
  v_dot2c_f32_bf16 v72, v236, v236
  v_dot2c_f32_bf16 v76, s84, v236
  v_dot2c_f32_bf16 v73, v237, v237
  v_dot2c_f32_bf16 v77, s84, v237
  v_dot2c_f32_bf16 v74, v238, v238
  v_dot2c_f32_bf16 v78, s84, v238
  v_dot2c_f32_bf16 v75, v239, v239
  v_dot2c_f32_bf16 v79, s84, v239
  s_waitcnt lgkmcnt(0)
  v_dot2c_f32_bf16 v72, v240, v240
  v_dot2c_f32_bf16 v76, s84, v240
  v_dot2c_f32_bf16 v73, v241, v241
  v_dot2c_f32_bf16 v77, s84, v241
  v_dot2c_f32_bf16 v74, v242, v242
  v_dot2c_f32_bf16 v78, s84, v242
  v_dot2c_f32_bf16 v75, v243, v243
  v_dot2c_f32_bf16 v79, s84, v243
  v_dot2c_f32_bf16 v72, v244, v244
  v_dot2c_f32_bf16 v76, s84, v244
  v_dot2c_f32_bf16 v73, v245, v245
  v_dot2c_f32_bf16 v77, s84, v245
  v_dot2c_f32_bf16 v74, v246, v246
  v_dot2c_f32_bf16 v78, s84, v246
  v_dot2c_f32_bf16 v75, v247, v247
  v_dot2c_f32_bf16 v79, s84, v247
  v_dot2c_f32_bf16 v72, v248, v248
  v_dot2c_f32_bf16 v76, s84, v248
  v_dot2c_f32_bf16 v73, v249, v249
  v_dot2c_f32_bf16 v77, s84, v249
  v_dot2c_f32_bf16 v74, v250, v250
  v_dot2c_f32_bf16 v78, s84, v250
  v_dot2c_f32_bf16 v75, v251, v251
  v_dot2c_f32_bf16 v79, s84, v251
  v_dot2c_f32_bf16 v72, v252, v252
  v_dot2c_f32_bf16 v76, s84, v252
  v_dot2c_f32_bf16 v73, v253, v253
  v_dot2c_f32_bf16 v77, s84, v253
  v_dot2c_f32_bf16 v74, v254, v254
  v_dot2c_f32_bf16 v78, s84, v254
  v_dot2c_f32_bf16 v75, v255, v255
  v_dot2c_f32_bf16 v79, s84, v255
  s_waitcnt lgkmcnt(0)
  s_barrier
  v_add_f32 v72, v72, v73
  v_mov_b32 v73, v8
  v_mov_b32 v106, v10
  v_mov_b32 v107, v11
  v_add_f32 v76, v76, v77
  v_add_f32 v74, v74, v75
  v_add_f32 v78, v78, v79
  v_add_f32 v74, v72, v74
  v_add_f32 v78, v76, v78
  v_mov_b32 v72, v74
  v_mov_b32 v76, v78
  s_nop 0
  v_permlane32_swap_b32 v72, v74
  v_permlane32_swap_b32 v76, v78
  v_add_f32 v74, v74, v72
  v_add_f32 v78, v78, v76
  v_mul_f32 v78, 0x3ae38e39, v78
  v_mul_f32 v74, 0x3ae38e39, v74
  v_fma_f32 v74, -v78, v78, v74
  v_max_f32 v74, 0, v74
  v_cvt_pk_bf16_f32 v78, v78, v78
  v_lshlrev_b32 v78, 16, v78
  v_xor_b32 v8, 0x80000000, v78
  v_cvt_pk_bf16_f32 v74, v74, v74
  v_xor_b32 v9, 0x80000000, v78
  v_lshlrev_b32 v74, 16, v74
  v_xor_b32 v10, 0x80000000, v78
  v_add_f32 v74, 0x3727c5ac, v74
  v_xor_b32 v11, 0x80000000, v78
  v_cvt_pk_bf16_f32 v74, v74, v74
  v_xor_b32 v12, 0x80000000, v78
  v_lshlrev_b32 v74, 16, v74
  v_xor_b32 v13, 0x80000000, v78
  v_sqrt_f32 v74, v74
  v_xor_b32 v14, 0x80000000, v78
  v_cvt_pk_bf16_f32 v74, v74, v74
  v_xor_b32 v15, 0x80000000, v78
  v_lshlrev_b32 v74, 16, v74
  v_xor_b32 v16, 0x80000000, v78
  v_rcp_f32 v74, v74
  v_xor_b32 v17, 0x80000000, v78
  v_mul_f32 v72, 0xbfb8aa3b, v74
  v_xor_b32 v18, 0x80000000, v78
  v_xor_b32 v19, 0x80000000, v78
  v_xor_b32 v20, 0x80000000, v78
  v_xor_b32 v21, 0x80000000, v78
  v_xor_b32 v22, 0x80000000, v78
  v_xor_b32 v23, 0x80000000, v78
  s_nop 1
  v_mfma_f32_32x32x16_bf16 v[24:39], a[160:163], v[112:115], v[8:23]
  s_lshr_b32 s92, 0x1100, s30
  s_bitcmp1_b32 s92, 0
  s_cbranch_scc0 L_fdw2
  s_add_u32 s91, s36, 108544
  v_add_u32 v0, s91, v2
  s_cmp_ge_u32 s28, 2
  s_cselect_b32 s92, 18432, 0
  v_add_u32 v75, s92, v0
  ds_write_b128 v0, v[56:59] offset:0
  ds_write_b128 v0, v[60:63] offset:4096
  ds_write_b128 v0, v[64:67] offset:8192
  ds_write_b128 v0, v[68:71] offset:12288
  ds_write_b128 v75, v[100:103] offset:16384
  s_waitcnt lgkmcnt(0)
L_fdw2:
  s_add_u32 s91, s36, 90112
  v_add_u32 v0, s91, v2
  s_cmp_ge_u32 s28, 2
  s_cselect_b32 s92, 36864, 0
  v_add_u32 v75, s92, v0
  v_add_u32 v74, 90112, v2
  v_mfma_f32_32x32x16_bf16 v[24:39], a[164:167], v[116:119], v[24:39]
  s_lshl_b32 s94, s29, 4
  s_add_u32 s95, s94, s30
  s_xor_b32 s95, s95, 1
  s_lshl_b32 s95, s95, 2
  s_add_u32 s95, s95, s28
  s_mul_i32 s95, s95, 18432
  s_add_u32 s81, s95, 8388608
  s_lshl_b32 s83, s29, 3
  s_add_u32 s83, s83, s31
  s_lshl_b32 s83, s83, 7
  s_nop 1
  v_pk_mul_f32 v[24:25], v[24:25], v[72:73] op_sel_hi:[1,0]
  v_pk_mul_f32 v[26:27], v[26:27], v[72:73] op_sel_hi:[1,0]
  v_pk_mul_f32 v[28:29], v[28:29], v[72:73] op_sel_hi:[1,0]
  v_pk_mul_f32 v[30:31], v[30:31], v[72:73] op_sel_hi:[1,0]
  v_pk_mul_f32 v[32:33], v[32:33], v[72:73] op_sel_hi:[1,0]
  v_pk_mul_f32 v[34:35], v[34:35], v[72:73] op_sel_hi:[1,0]
  v_pk_mul_f32 v[36:37], v[36:37], v[72:73] op_sel_hi:[1,0]
  v_pk_mul_f32 v[38:39], v[38:39], v[72:73] op_sel_hi:[1,0]
  s_add_u32 m0, s36, 16384
  v_mfma_f32_32x32x16_bf16 v[56:71], a[160:163], v[120:123], v[8:23]
  s_lshl_b32 s94, s32, 2
  ds_write_b128 v0, v[80:83] offset:0
  buffer_load_dwordx4 v4, s[8:11], s40 offen offset:0 lds
  v_cvt_pk_bf16_f32 v24, v24, v25
  v_cvt_pk_bf16_f32 v25, v26, v27
  v_cvt_pk_bf16_f32 v26, v28, v29
  v_cvt_pk_bf16_f32 v27, v30, v31
  v_cvt_pk_bf16_f32 v28, v32, v33
  v_cvt_pk_bf16_f32 v29, v34, v35
  s_add_u32 m0, s36, 20480
  v_mfma_f32_32x32x16_bf16 v[56:71], a[164:167], v[124:127], v[56:71]
  buffer_load_dwordx4 v4, s[8:11], s41 offen offset:0 lds
  v_cvt_pk_bf16_f32 v30, v36, v37
  v_cvt_pk_bf16_f32 v31, v38, v39
  v_accvgpr_write_b32 a0, v24
  v_accvgpr_write_b32 a1, v25
  v_accvgpr_write_b32 a2, v26
  v_accvgpr_write_b32 a3, v27
  v_accvgpr_write_b32 a4, v28
  v_accvgpr_write_b32 a5, v29
  v_accvgpr_write_b32 a6, v30
  v_accvgpr_write_b32 a7, v31
  s_nop 0
  v_pk_mul_f32 v[56:57], v[56:57], v[72:73] op_sel_hi:[1,0]
  v_pk_mul_f32 v[58:59], v[58:59], v[72:73] op_sel_hi:[1,0]
  v_pk_mul_f32 v[60:61], v[60:61], v[72:73] op_sel_hi:[1,0]
  v_pk_mul_f32 v[62:63], v[62:63], v[72:73] op_sel_hi:[1,0]
  v_pk_mul_f32 v[64:65], v[64:65], v[72:73] op_sel_hi:[1,0]
  v_pk_mul_f32 v[66:67], v[66:67], v[72:73] op_sel_hi:[1,0]
  v_pk_mul_f32 v[68:69], v[68:69], v[72:73] op_sel_hi:[1,0]
  v_pk_mul_f32 v[70:71], v[70:71], v[72:73] op_sel_hi:[1,0]
  s_add_u32 m0, s36, 24576
  v_mfma_f32_32x32x16_bf16 v[24:39], a[160:163], v[128:131], v[8:23]
  s_add_u32 s83, s83, s94
  ds_write_b128 v0, v[84:87] offset:4096
  buffer_load_dwordx4 v4, s[8:11], s42 offen offset:0 lds
  v_cvt_pk_bf16_f32 v56, v56, v57
  v_cvt_pk_bf16_f32 v57, v58, v59
  v_cvt_pk_bf16_f32 v58, v60, v61
  v_cvt_pk_bf16_f32 v59, v62, v63
  v_cvt_pk_bf16_f32 v60, v64, v65
  v_cvt_pk_bf16_f32 v61, v66, v67
  s_add_u32 m0, s36, 28672
  v_mfma_f32_32x32x16_bf16 v[24:39], a[164:167], v[132:135], v[24:39]
  buffer_load_dwordx4 v4, s[8:11], s43 offen offset:0 lds
  v_cvt_pk_bf16_f32 v62, v68, v69
  v_cvt_pk_bf16_f32 v63, v70, v71
  v_accvgpr_write_b32 a8, v56
  v_accvgpr_write_b32 a9, v57
  v_accvgpr_write_b32 a10, v58
  v_accvgpr_write_b32 a11, v59
  v_accvgpr_write_b32 a12, v60
  v_accvgpr_write_b32 a13, v61
  v_accvgpr_write_b32 a14, v62
  v_accvgpr_write_b32 a15, v63
  s_nop 0
  v_pk_mul_f32 v[24:25], v[24:25], v[72:73] op_sel_hi:[1,0]
  v_pk_mul_f32 v[26:27], v[26:27], v[72:73] op_sel_hi:[1,0]
  v_pk_mul_f32 v[28:29], v[28:29], v[72:73] op_sel_hi:[1,0]
  v_pk_mul_f32 v[30:31], v[30:31], v[72:73] op_sel_hi:[1,0]
  v_pk_mul_f32 v[32:33], v[32:33], v[72:73] op_sel_hi:[1,0]
  v_pk_mul_f32 v[34:35], v[34:35], v[72:73] op_sel_hi:[1,0]
  v_pk_mul_f32 v[36:37], v[36:37], v[72:73] op_sel_hi:[1,0]
  v_pk_mul_f32 v[38:39], v[38:39], v[72:73] op_sel_hi:[1,0]
  s_add_u32 m0, s36, 32768
  v_mfma_f32_32x32x16_bf16 v[56:71], a[160:163], v[136:139], v[8:23]
  s_add_u32 s83, s83, 12288
  ds_write_b128 v0, v[88:91] offset:8192
  buffer_load_dwordx4 v4, s[8:11], s44 offen offset:0 lds
  v_cvt_pk_bf16_f32 v24, v24, v25
  v_cvt_pk_bf16_f32 v25, v26, v27
  v_cvt_pk_bf16_f32 v26, v28, v29
  v_cvt_pk_bf16_f32 v27, v30, v31
  v_cvt_pk_bf16_f32 v28, v32, v33
  v_cvt_pk_bf16_f32 v29, v34, v35
  s_add_u32 m0, s36, 36864
  v_mfma_f32_32x32x16_bf16 v[56:71], a[164:167], v[140:143], v[56:71]
  buffer_load_dwordx4 v4, s[8:11], s45 offen offset:0 lds
  v_cvt_pk_bf16_f32 v30, v36, v37
  v_cvt_pk_bf16_f32 v31, v38, v39
  v_accvgpr_write_b32 a16, v24
  v_accvgpr_write_b32 a17, v25
  v_accvgpr_write_b32 a18, v26
  v_accvgpr_write_b32 a19, v27
  v_accvgpr_write_b32 a20, v28
  v_accvgpr_write_b32 a21, v29
  v_accvgpr_write_b32 a22, v30
  v_accvgpr_write_b32 a23, v31
  s_nop 0
  v_pk_mul_f32 v[56:57], v[56:57], v[72:73] op_sel_hi:[1,0]
  v_pk_mul_f32 v[58:59], v[58:59], v[72:73] op_sel_hi:[1,0]
  v_pk_mul_f32 v[60:61], v[60:61], v[72:73] op_sel_hi:[1,0]
  v_pk_mul_f32 v[62:63], v[62:63], v[72:73] op_sel_hi:[1,0]
  v_pk_mul_f32 v[64:65], v[64:65], v[72:73] op_sel_hi:[1,0]
  v_pk_mul_f32 v[66:67], v[66:67], v[72:73] op_sel_hi:[1,0]
  v_pk_mul_f32 v[68:69], v[68:69], v[72:73] op_sel_hi:[1,0]
  v_pk_mul_f32 v[70:71], v[70:71], v[72:73] op_sel_hi:[1,0]
  s_add_u32 m0, s36, 40960
  v_mfma_f32_32x32x16_bf16 v[24:39], a[160:163], v[144:147], v[8:23]
  s_lshl_b32 s80, s29, 4
  ds_write_b128 v0, v[92:95] offset:12288
  buffer_load_dwordx4 v4, s[8:11], s46 offen offset:0 lds
  v_cvt_pk_bf16_f32 v56, v56, v57
  v_cvt_pk_bf16_f32 v57, v58, v59
  v_cvt_pk_bf16_f32 v58, v60, v61
  v_cvt_pk_bf16_f32 v59, v62, v63
  v_cvt_pk_bf16_f32 v60, v64, v65
  v_cvt_pk_bf16_f32 v61, v66, v67
  s_add_u32 m0, s36, 45056
  v_mfma_f32_32x32x16_bf16 v[24:39], a[164:167], v[148:151], v[24:39]
  buffer_load_dwordx4 v4, s[8:11], s47 offen offset:0 lds
  v_cvt_pk_bf16_f32 v62, v68, v69
  v_cvt_pk_bf16_f32 v63, v70, v71
  v_accvgpr_write_b32 a24, v56
  v_accvgpr_write_b32 a25, v57
  v_accvgpr_write_b32 a26, v58
  v_accvgpr_write_b32 a27, v59
  v_accvgpr_write_b32 a28, v60
  v_accvgpr_write_b32 a29, v61
  v_accvgpr_write_b32 a30, v62
  v_accvgpr_write_b32 a31, v63
  s_nop 0
  v_pk_mul_f32 v[24:25], v[24:25], v[72:73] op_sel_hi:[1,0]
  v_pk_mul_f32 v[26:27], v[26:27], v[72:73] op_sel_hi:[1,0]
  v_pk_mul_f32 v[28:29], v[28:29], v[72:73] op_sel_hi:[1,0]
  v_pk_mul_f32 v[30:31], v[30:31], v[72:73] op_sel_hi:[1,0]
  v_pk_mul_f32 v[32:33], v[32:33], v[72:73] op_sel_hi:[1,0]
  v_pk_mul_f32 v[34:35], v[34:35], v[72:73] op_sel_hi:[1,0]
  v_pk_mul_f32 v[36:37], v[36:37], v[72:73] op_sel_hi:[1,0]
  v_pk_mul_f32 v[38:39], v[38:39], v[72:73] op_sel_hi:[1,0]
  s_add_u32 m0, s36, 49152
  v_mfma_f32_32x32x16_bf16 v[56:71], a[160:163], v[152:155], v[8:23]
  s_add_u32 s80, s80, s30
  ds_write_b128 v75, v[96:99] offset:16384
  buffer_load_dwordx4 v4, s[8:11], s48 offen offset:0 lds
  v_cvt_pk_bf16_f32 v24, v24, v25
  v_cvt_pk_bf16_f32 v25, v26, v27
  v_cvt_pk_bf16_f32 v26, v28, v29
  v_cvt_pk_bf16_f32 v27, v30, v31
  v_cvt_pk_bf16_f32 v28, v32, v33
  v_cvt_pk_bf16_f32 v29, v34, v35
  s_add_u32 m0, s36, 53248
  v_mfma_f32_32x32x16_bf16 v[56:71], a[164:167], v[156:159], v[56:71]
  buffer_load_dwordx4 v4, s[8:11], s49 offen offset:0 lds
  v_cvt_pk_bf16_f32 v30, v36, v37
  v_cvt_pk_bf16_f32 v31, v38, v39
  v_accvgpr_write_b32 a32, v24
  v_accvgpr_write_b32 a33, v25
  v_accvgpr_write_b32 a34, v26
  v_accvgpr_write_b32 a35, v27
  v_accvgpr_write_b32 a36, v28
  v_accvgpr_write_b32 a37, v29
  v_accvgpr_write_b32 a38, v30
  v_accvgpr_write_b32 a39, v31
  s_nop 0
  v_pk_mul_f32 v[56:57], v[56:57], v[72:73] op_sel_hi:[1,0]
  v_pk_mul_f32 v[58:59], v[58:59], v[72:73] op_sel_hi:[1,0]
  v_pk_mul_f32 v[60:61], v[60:61], v[72:73] op_sel_hi:[1,0]
  v_pk_mul_f32 v[62:63], v[62:63], v[72:73] op_sel_hi:[1,0]
  v_pk_mul_f32 v[64:65], v[64:65], v[72:73] op_sel_hi:[1,0]
  v_pk_mul_f32 v[66:67], v[66:67], v[72:73] op_sel_hi:[1,0]
  v_pk_mul_f32 v[68:69], v[68:69], v[72:73] op_sel_hi:[1,0]
  v_pk_mul_f32 v[70:71], v[70:71], v[72:73] op_sel_hi:[1,0]
  s_add_u32 m0, s36, 57344
  v_mfma_f32_32x32x16_bf16 v[24:39], a[160:163], v[160:163], v[8:23]
  s_lshl_b32 s80, s80, 2
  buffer_load_dwordx4 v4, s[8:11], s50 offen offset:0 lds
  v_cvt_pk_bf16_f32 v56, v56, v57
  v_cvt_pk_bf16_f32 v57, v58, v59
  v_cvt_pk_bf16_f32 v58, v60, v61
  v_cvt_pk_bf16_f32 v59, v62, v63
  v_cvt_pk_bf16_f32 v60, v64, v65
  v_cvt_pk_bf16_f32 v61, v66, v67
  s_add_u32 m0, s36, 61440
  v_mfma_f32_32x32x16_bf16 v[24:39], a[164:167], v[164:167], v[24:39]
  buffer_load_dwordx4 v4, s[8:11], s51 offen offset:0 lds
  v_cvt_pk_bf16_f32 v62, v68, v69
  v_cvt_pk_bf16_f32 v63, v70, v71
  v_accvgpr_write_b32 a40, v56
  v_accvgpr_write_b32 a41, v57
  v_accvgpr_write_b32 a42, v58
  v_accvgpr_write_b32 a43, v59
  v_accvgpr_write_b32 a44, v60
  v_accvgpr_write_b32 a45, v61
  v_accvgpr_write_b32 a46, v62
  v_accvgpr_write_b32 a47, v63
  s_nop 0
  v_pk_mul_f32 v[24:25], v[24:25], v[72:73] op_sel_hi:[1,0]
  v_pk_mul_f32 v[26:27], v[26:27], v[72:73] op_sel_hi:[1,0]
  v_pk_mul_f32 v[28:29], v[28:29], v[72:73] op_sel_hi:[1,0]
  v_pk_mul_f32 v[30:31], v[30:31], v[72:73] op_sel_hi:[1,0]
  v_pk_mul_f32 v[32:33], v[32:33], v[72:73] op_sel_hi:[1,0]
  v_pk_mul_f32 v[34:35], v[34:35], v[72:73] op_sel_hi:[1,0]
  v_pk_mul_f32 v[36:37], v[36:37], v[72:73] op_sel_hi:[1,0]
  v_pk_mul_f32 v[38:39], v[38:39], v[72:73] op_sel_hi:[1,0]
  s_add_u32 m0, s36, 65536
  v_mfma_f32_32x32x16_bf16 v[56:71], a[160:163], v[168:171], v[8:23]
  s_add_u32 s80, s80, s28
  buffer_load_dwordx4 v4, s[8:11], s52 offen offset:0 lds
  v_cvt_pk_bf16_f32 v24, v24, v25
  v_cvt_pk_bf16_f32 v25, v26, v27
  v_cvt_pk_bf16_f32 v26, v28, v29
  v_cvt_pk_bf16_f32 v27, v30, v31
  v_cvt_pk_bf16_f32 v28, v32, v33
  v_cvt_pk_bf16_f32 v29, v34, v35
  s_add_u32 m0, s36, 69632
  v_mfma_f32_32x32x16_bf16 v[56:71], a[164:167], v[172:175], v[56:71]
  buffer_load_dwordx4 v4, s[8:11], s53 offen offset:0 lds
  v_cvt_pk_bf16_f32 v30, v36, v37
  v_cvt_pk_bf16_f32 v31, v38, v39
  v_accvgpr_write_b32 a48, v24
  v_accvgpr_write_b32 a49, v25
  v_accvgpr_write_b32 a50, v26
  v_accvgpr_write_b32 a51, v27
  v_accvgpr_write_b32 a52, v28
  v_accvgpr_write_b32 a53, v29
  v_accvgpr_write_b32 a54, v30
  v_accvgpr_write_b32 a55, v31
  s_nop 0
  v_pk_mul_f32 v[56:57], v[56:57], v[72:73] op_sel_hi:[1,0]
  v_pk_mul_f32 v[58:59], v[58:59], v[72:73] op_sel_hi:[1,0]
  v_pk_mul_f32 v[60:61], v[60:61], v[72:73] op_sel_hi:[1,0]
  v_pk_mul_f32 v[62:63], v[62:63], v[72:73] op_sel_hi:[1,0]
  v_pk_mul_f32 v[64:65], v[64:65], v[72:73] op_sel_hi:[1,0]
  v_pk_mul_f32 v[66:67], v[66:67], v[72:73] op_sel_hi:[1,0]
  v_pk_mul_f32 v[68:69], v[68:69], v[72:73] op_sel_hi:[1,0]
  v_pk_mul_f32 v[70:71], v[70:71], v[72:73] op_sel_hi:[1,0]
  s_add_u32 m0, s36, 73728
  v_mfma_f32_32x32x16_bf16 v[24:39], a[160:163], v[176:179], v[8:23]
  s_mul_i32 s80, s80, 18432
  buffer_load_dwordx4 v4, s[8:11], s54 offen offset:0 lds
  v_cvt_pk_bf16_f32 v56, v56, v57
  v_cvt_pk_bf16_f32 v57, v58, v59
  v_cvt_pk_bf16_f32 v58, v60, v61
  v_cvt_pk_bf16_f32 v59, v62, v63
  v_cvt_pk_bf16_f32 v60, v64, v65
  v_cvt_pk_bf16_f32 v61, v66, v67
  v_mfma_f32_32x32x16_bf16 v[24:39], a[164:167], v[180:183], v[24:39]
  v_cvt_pk_bf16_f32 v62, v68, v69
  v_cvt_pk_bf16_f32 v63, v70, v71
  v_accvgpr_write_b32 a56, v56
  v_accvgpr_write_b32 a57, v57
  v_accvgpr_write_b32 a58, v58
  v_accvgpr_write_b32 a59, v59
  v_accvgpr_write_b32 a60, v60
  v_accvgpr_write_b32 a61, v61
  v_accvgpr_write_b32 a62, v62
  v_accvgpr_write_b32 a63, v63
  s_nop 1
  v_pk_mul_f32 v[24:25], v[24:25], v[72:73] op_sel_hi:[1,0]
  v_pk_mul_f32 v[26:27], v[26:27], v[72:73] op_sel_hi:[1,0]
  v_pk_mul_f32 v[28:29], v[28:29], v[72:73] op_sel_hi:[1,0]
  v_pk_mul_f32 v[30:31], v[30:31], v[72:73] op_sel_hi:[1,0]
  v_pk_mul_f32 v[32:33], v[32:33], v[72:73] op_sel_hi:[1,0]
  v_pk_mul_f32 v[34:35], v[34:35], v[72:73] op_sel_hi:[1,0]
  v_pk_mul_f32 v[36:37], v[36:37], v[72:73] op_sel_hi:[1,0]
  v_pk_mul_f32 v[38:39], v[38:39], v[72:73] op_sel_hi:[1,0]
  s_add_u32 m0, s36, 77824
  v_mfma_f32_32x32x16_bf16 v[56:71], a[160:163], v[184:187], v[8:23]
  s_add_u32 s80, s80, 8388608
  buffer_load_dwordx4 v4, s[8:11], s55 offen offset:0 lds
  v_cvt_pk_bf16_f32 v24, v24, v25
  v_cvt_pk_bf16_f32 v25, v26, v27
  v_cvt_pk_bf16_f32 v26, v28, v29
  v_cvt_pk_bf16_f32 v27, v30, v31
  v_cvt_pk_bf16_f32 v28, v32, v33
  v_cvt_pk_bf16_f32 v29, v34, v35
  v_mfma_f32_32x32x16_bf16 v[56:71], a[164:167], v[188:191], v[56:71]
  v_cvt_pk_bf16_f32 v30, v36, v37
  v_cvt_pk_bf16_f32 v31, v38, v39
  v_accvgpr_write_b32 a64, v24
  v_accvgpr_write_b32 a65, v25
  v_accvgpr_write_b32 a66, v26
  v_accvgpr_write_b32 a67, v27
  v_accvgpr_write_b32 a68, v28
  v_accvgpr_write_b32 a69, v29
  v_accvgpr_write_b32 a70, v30
  v_accvgpr_write_b32 a71, v31
  s_nop 1
  v_pk_mul_f32 v[56:57], v[56:57], v[72:73] op_sel_hi:[1,0]
  v_pk_mul_f32 v[58:59], v[58:59], v[72:73] op_sel_hi:[1,0]
  v_pk_mul_f32 v[60:61], v[60:61], v[72:73] op_sel_hi:[1,0]
  v_pk_mul_f32 v[62:63], v[62:63], v[72:73] op_sel_hi:[1,0]
  v_pk_mul_f32 v[64:65], v[64:65], v[72:73] op_sel_hi:[1,0]
  v_pk_mul_f32 v[66:67], v[66:67], v[72:73] op_sel_hi:[1,0]
  v_pk_mul_f32 v[68:69], v[68:69], v[72:73] op_sel_hi:[1,0]
  v_pk_mul_f32 v[70:71], v[70:71], v[72:73] op_sel_hi:[1,0]
  s_add_u32 m0, s36, 81920
  v_mfma_f32_32x32x16_bf16 v[24:39], a[160:163], v[192:195], v[8:23]
  buffer_load_dwordx4 v4, s[8:11], s56 offen offset:0 lds
  v_cvt_pk_bf16_f32 v56, v56, v57
  v_cvt_pk_bf16_f32 v57, v58, v59
  v_cvt_pk_bf16_f32 v58, v60, v61
  v_cvt_pk_bf16_f32 v59, v62, v63
  v_cvt_pk_bf16_f32 v60, v64, v65
  v_cvt_pk_bf16_f32 v61, v66, v67
  v_mfma_f32_32x32x16_bf16 v[24:39], a[164:167], v[196:199], v[24:39]
  v_cvt_pk_bf16_f32 v62, v68, v69
  v_cvt_pk_bf16_f32 v63, v70, v71
  v_accvgpr_write_b32 a72, v56
  v_accvgpr_write_b32 a73, v57
  v_accvgpr_write_b32 a74, v58
  v_accvgpr_write_b32 a75, v59
  v_accvgpr_write_b32 a76, v60
  v_accvgpr_write_b32 a77, v61
  v_accvgpr_write_b32 a78, v62
  v_accvgpr_write_b32 a79, v63
  s_nop 1
  v_pk_mul_f32 v[24:25], v[24:25], v[72:73] op_sel_hi:[1,0]
  v_pk_mul_f32 v[26:27], v[26:27], v[72:73] op_sel_hi:[1,0]
  v_pk_mul_f32 v[28:29], v[28:29], v[72:73] op_sel_hi:[1,0]
  v_pk_mul_f32 v[30:31], v[30:31], v[72:73] op_sel_hi:[1,0]
  v_pk_mul_f32 v[32:33], v[32:33], v[72:73] op_sel_hi:[1,0]
  v_pk_mul_f32 v[34:35], v[34:35], v[72:73] op_sel_hi:[1,0]
  v_pk_mul_f32 v[36:37], v[36:37], v[72:73] op_sel_hi:[1,0]
  v_pk_mul_f32 v[38:39], v[38:39], v[72:73] op_sel_hi:[1,0]
  s_add_u32 m0, s36, 86016
  v_mfma_f32_32x32x16_bf16 v[56:71], a[160:163], v[200:203], v[8:23]
  buffer_load_dwordx4 v4, s[8:11], s57 offen offset:0 lds
  v_cvt_pk_bf16_f32 v24, v24, v25
  v_cvt_pk_bf16_f32 v25, v26, v27
  v_cvt_pk_bf16_f32 v26, v28, v29
  v_cvt_pk_bf16_f32 v27, v30, v31
  v_cvt_pk_bf16_f32 v28, v32, v33
  v_cvt_pk_bf16_f32 v29, v34, v35
  v_mfma_f32_32x32x16_bf16 v[56:71], a[164:167], v[204:207], v[56:71]
  v_cvt_pk_bf16_f32 v30, v36, v37
  v_cvt_pk_bf16_f32 v31, v38, v39
  v_accvgpr_write_b32 a80, v24
  v_accvgpr_write_b32 a81, v25
  v_accvgpr_write_b32 a82, v26
  v_accvgpr_write_b32 a83, v27
  v_accvgpr_write_b32 a84, v28
  v_accvgpr_write_b32 a85, v29
  v_accvgpr_write_b32 a86, v30
  v_accvgpr_write_b32 a87, v31
  s_nop 1
  v_pk_mul_f32 v[56:57], v[56:57], v[72:73] op_sel_hi:[1,0]
  v_pk_mul_f32 v[58:59], v[58:59], v[72:73] op_sel_hi:[1,0]
  v_pk_mul_f32 v[60:61], v[60:61], v[72:73] op_sel_hi:[1,0]
  v_pk_mul_f32 v[62:63], v[62:63], v[72:73] op_sel_hi:[1,0]
  v_pk_mul_f32 v[64:65], v[64:65], v[72:73] op_sel_hi:[1,0]
  v_pk_mul_f32 v[66:67], v[66:67], v[72:73] op_sel_hi:[1,0]
  v_pk_mul_f32 v[68:69], v[68:69], v[72:73] op_sel_hi:[1,0]
  v_pk_mul_f32 v[70:71], v[70:71], v[72:73] op_sel_hi:[1,0]
  v_mfma_f32_32x32x16_bf16 v[24:39], a[160:163], v[208:211], v[8:23]
  v_cvt_pk_bf16_f32 v56, v56, v57
  v_cvt_pk_bf16_f32 v57, v58, v59
  v_cvt_pk_bf16_f32 v58, v60, v61
  v_cvt_pk_bf16_f32 v59, v62, v63
  v_cvt_pk_bf16_f32 v60, v64, v65
  v_cvt_pk_bf16_f32 v61, v66, v67
  v_mfma_f32_32x32x16_bf16 v[24:39], a[164:167], v[212:215], v[24:39]
  v_cvt_pk_bf16_f32 v62, v68, v69
  v_cvt_pk_bf16_f32 v63, v70, v71
  v_accvgpr_write_b32 a88, v56
  v_accvgpr_write_b32 a89, v57
  v_accvgpr_write_b32 a90, v58
  v_accvgpr_write_b32 a91, v59
  v_accvgpr_write_b32 a92, v60
  v_accvgpr_write_b32 a93, v61
  v_accvgpr_write_b32 a94, v62
  v_accvgpr_write_b32 a95, v63
  s_nop 1
  v_pk_mul_f32 v[24:25], v[24:25], v[72:73] op_sel_hi:[1,0]
  v_pk_mul_f32 v[26:27], v[26:27], v[72:73] op_sel_hi:[1,0]
  v_pk_mul_f32 v[28:29], v[28:29], v[72:73] op_sel_hi:[1,0]
  v_pk_mul_f32 v[30:31], v[30:31], v[72:73] op_sel_hi:[1,0]
  v_pk_mul_f32 v[32:33], v[32:33], v[72:73] op_sel_hi:[1,0]
  v_pk_mul_f32 v[34:35], v[34:35], v[72:73] op_sel_hi:[1,0]
  v_pk_mul_f32 v[36:37], v[36:37], v[72:73] op_sel_hi:[1,0]
  v_pk_mul_f32 v[38:39], v[38:39], v[72:73] op_sel_hi:[1,0]
  v_mfma_f32_32x32x16_bf16 v[56:71], a[160:163], v[216:219], v[8:23]
  v_cvt_pk_bf16_f32 v24, v24, v25
  v_cvt_pk_bf16_f32 v25, v26, v27
  v_cvt_pk_bf16_f32 v26, v28, v29
  v_cvt_pk_bf16_f32 v27, v30, v31
  v_cvt_pk_bf16_f32 v28, v32, v33
  v_cvt_pk_bf16_f32 v29, v34, v35
  v_mfma_f32_32x32x16_bf16 v[56:71], a[164:167], v[220:223], v[56:71]
  v_cvt_pk_bf16_f32 v30, v36, v37
  v_cvt_pk_bf16_f32 v31, v38, v39
  v_accvgpr_write_b32 a96, v24
  v_accvgpr_write_b32 a97, v25
  v_accvgpr_write_b32 a98, v26
  v_accvgpr_write_b32 a99, v27
  v_accvgpr_write_b32 a100, v28
  v_accvgpr_write_b32 a101, v29
  v_accvgpr_write_b32 a102, v30
  v_accvgpr_write_b32 a103, v31
  s_nop 1
  v_pk_mul_f32 v[56:57], v[56:57], v[72:73] op_sel_hi:[1,0]
  v_pk_mul_f32 v[58:59], v[58:59], v[72:73] op_sel_hi:[1,0]
  v_pk_mul_f32 v[60:61], v[60:61], v[72:73] op_sel_hi:[1,0]
  v_pk_mul_f32 v[62:63], v[62:63], v[72:73] op_sel_hi:[1,0]
  v_pk_mul_f32 v[64:65], v[64:65], v[72:73] op_sel_hi:[1,0]
  v_pk_mul_f32 v[66:67], v[66:67], v[72:73] op_sel_hi:[1,0]
  v_pk_mul_f32 v[68:69], v[68:69], v[72:73] op_sel_hi:[1,0]
  v_pk_mul_f32 v[70:71], v[70:71], v[72:73] op_sel_hi:[1,0]
  global_load_ushort a216, v[106:107], off
  buffer_load_dword a211, v73, s[8:11], s96 offen offset:256
  v_mfma_f32_32x32x16_bf16 v[24:39], a[160:163], v[224:227], v[8:23]
  v_cvt_pk_bf16_f32 v56, v56, v57
  v_cvt_pk_bf16_f32 v57, v58, v59
  v_cvt_pk_bf16_f32 v58, v60, v61
  v_cvt_pk_bf16_f32 v59, v62, v63
  v_cvt_pk_bf16_f32 v60, v64, v65
  v_cvt_pk_bf16_f32 v61, v66, v67
  v_mfma_f32_32x32x16_bf16 v[24:39], a[164:167], v[228:231], v[24:39]
  v_cvt_pk_bf16_f32 v62, v68, v69
  v_cvt_pk_bf16_f32 v63, v70, v71
  v_accvgpr_write_b32 a104, v56
  v_accvgpr_write_b32 a105, v57
  v_accvgpr_write_b32 a106, v58
  v_accvgpr_write_b32 a107, v59
  v_accvgpr_write_b32 a108, v60
  v_accvgpr_write_b32 a109, v61
  v_accvgpr_write_b32 a110, v62
  v_accvgpr_write_b32 a111, v63
  s_nop 1
  v_pk_mul_f32 v[24:25], v[24:25], v[72:73] op_sel_hi:[1,0]
  v_pk_mul_f32 v[26:27], v[26:27], v[72:73] op_sel_hi:[1,0]
  v_pk_mul_f32 v[28:29], v[28:29], v[72:73] op_sel_hi:[1,0]
  v_pk_mul_f32 v[30:31], v[30:31], v[72:73] op_sel_hi:[1,0]
  v_pk_mul_f32 v[32:33], v[32:33], v[72:73] op_sel_hi:[1,0]
  v_pk_mul_f32 v[34:35], v[34:35], v[72:73] op_sel_hi:[1,0]
  v_pk_mul_f32 v[36:37], v[36:37], v[72:73] op_sel_hi:[1,0]
  v_pk_mul_f32 v[38:39], v[38:39], v[72:73] op_sel_hi:[1,0]
  v_mfma_f32_32x32x16_bf16 v[56:71], a[160:163], v[232:235], v[8:23]
  v_cvt_pk_bf16_f32 v24, v24, v25
  v_cvt_pk_bf16_f32 v25, v26, v27
  v_cvt_pk_bf16_f32 v26, v28, v29
  v_cvt_pk_bf16_f32 v27, v30, v31
  v_cvt_pk_bf16_f32 v28, v32, v33
  v_cvt_pk_bf16_f32 v29, v34, v35
  v_mfma_f32_32x32x16_bf16 v[56:71], a[164:167], v[236:239], v[56:71]
  v_cvt_pk_bf16_f32 v30, v36, v37
  v_cvt_pk_bf16_f32 v31, v38, v39
  v_accvgpr_write_b32 a112, v24
  v_accvgpr_write_b32 a113, v25
  v_accvgpr_write_b32 a114, v26
  v_accvgpr_write_b32 a115, v27
  v_accvgpr_write_b32 a116, v28
  v_accvgpr_write_b32 a117, v29
  v_accvgpr_write_b32 a118, v30
  v_accvgpr_write_b32 a119, v31
  s_nop 1
  v_pk_mul_f32 v[56:57], v[56:57], v[72:73] op_sel_hi:[1,0]
  v_pk_mul_f32 v[58:59], v[58:59], v[72:73] op_sel_hi:[1,0]
  v_pk_mul_f32 v[60:61], v[60:61], v[72:73] op_sel_hi:[1,0]
  v_pk_mul_f32 v[62:63], v[62:63], v[72:73] op_sel_hi:[1,0]
  v_pk_mul_f32 v[64:65], v[64:65], v[72:73] op_sel_hi:[1,0]
  v_pk_mul_f32 v[66:67], v[66:67], v[72:73] op_sel_hi:[1,0]
  v_pk_mul_f32 v[68:69], v[68:69], v[72:73] op_sel_hi:[1,0]
  v_pk_mul_f32 v[70:71], v[70:71], v[72:73] op_sel_hi:[1,0]
  v_mfma_f32_32x32x16_bf16 v[24:39], a[160:163], v[240:243], v[8:23]
  v_cvt_pk_bf16_f32 v56, v56, v57
  v_cvt_pk_bf16_f32 v57, v58, v59
  v_cvt_pk_bf16_f32 v58, v60, v61
  v_cvt_pk_bf16_f32 v59, v62, v63
  v_cvt_pk_bf16_f32 v60, v64, v65
  v_cvt_pk_bf16_f32 v61, v66, v67
  v_mfma_f32_32x32x16_bf16 v[24:39], a[164:167], v[244:247], v[24:39]
  v_cvt_pk_bf16_f32 v62, v68, v69
  v_cvt_pk_bf16_f32 v63, v70, v71
  v_accvgpr_write_b32 a120, v56
  v_accvgpr_write_b32 a121, v57
  v_accvgpr_write_b32 a122, v58
  v_accvgpr_write_b32 a123, v59
  v_accvgpr_write_b32 a124, v60
  v_accvgpr_write_b32 a125, v61
  v_accvgpr_write_b32 a126, v62
  v_accvgpr_write_b32 a127, v63
  s_nop 1
  v_pk_mul_f32 v[24:25], v[24:25], v[72:73] op_sel_hi:[1,0]
  v_pk_mul_f32 v[26:27], v[26:27], v[72:73] op_sel_hi:[1,0]
  v_pk_mul_f32 v[28:29], v[28:29], v[72:73] op_sel_hi:[1,0]
  v_pk_mul_f32 v[30:31], v[30:31], v[72:73] op_sel_hi:[1,0]
  v_pk_mul_f32 v[32:33], v[32:33], v[72:73] op_sel_hi:[1,0]
  v_pk_mul_f32 v[34:35], v[34:35], v[72:73] op_sel_hi:[1,0]
  v_pk_mul_f32 v[36:37], v[36:37], v[72:73] op_sel_hi:[1,0]
  v_pk_mul_f32 v[38:39], v[38:39], v[72:73] op_sel_hi:[1,0]
  v_mfma_f32_32x32x16_bf16 v[56:71], a[160:163], v[248:251], v[8:23]
  v_cvt_pk_bf16_f32 v24, v24, v25
  v_cvt_pk_bf16_f32 v25, v26, v27
  v_cvt_pk_bf16_f32 v26, v28, v29
  v_cvt_pk_bf16_f32 v27, v30, v31
  v_cvt_pk_bf16_f32 v28, v32, v33
  v_cvt_pk_bf16_f32 v29, v34, v35
  v_mfma_f32_32x32x16_bf16 v[56:71], a[164:167], v[252:255], v[56:71]
  v_cvt_pk_bf16_f32 v30, v36, v37
  v_cvt_pk_bf16_f32 v31, v38, v39
  v_accvgpr_write_b32 a128, v24
  v_accvgpr_write_b32 a129, v25
  v_accvgpr_write_b32 a130, v26
  v_accvgpr_write_b32 a131, v27
  v_accvgpr_write_b32 a132, v28
  v_accvgpr_write_b32 a133, v29
  v_accvgpr_write_b32 a134, v30
  v_accvgpr_write_b32 a135, v31
  s_nop 1
  v_pk_mul_f32 v[56:57], v[56:57], v[72:73] op_sel_hi:[1,0]
  v_pk_mul_f32 v[58:59], v[58:59], v[72:73] op_sel_hi:[1,0]
  v_pk_mul_f32 v[60:61], v[60:61], v[72:73] op_sel_hi:[1,0]
  v_pk_mul_f32 v[62:63], v[62:63], v[72:73] op_sel_hi:[1,0]
  v_pk_mul_f32 v[64:65], v[64:65], v[72:73] op_sel_hi:[1,0]
  v_pk_mul_f32 v[66:67], v[66:67], v[72:73] op_sel_hi:[1,0]
  v_pk_mul_f32 v[68:69], v[68:69], v[72:73] op_sel_hi:[1,0]
  v_pk_mul_f32 v[70:71], v[70:71], v[72:73] op_sel_hi:[1,0]
  v_cvt_pk_bf16_f32 v56, v56, v57
  v_cvt_pk_bf16_f32 v57, v58, v59
  v_cvt_pk_bf16_f32 v58, v60, v61
  v_cvt_pk_bf16_f32 v59, v62, v63
  v_cvt_pk_bf16_f32 v60, v64, v65
  v_cvt_pk_bf16_f32 v61, v66, v67
  v_cvt_pk_bf16_f32 v62, v68, v69
  v_cvt_pk_bf16_f32 v63, v70, v71
  v_accvgpr_write_b32 a136, v56
  v_accvgpr_write_b32 a137, v57
  v_accvgpr_write_b32 a138, v58
  v_accvgpr_write_b32 a139, v59
  v_accvgpr_write_b32 a140, v60
  v_accvgpr_write_b32 a141, v61
  v_accvgpr_write_b32 a142, v62
  v_accvgpr_write_b32 a143, v63
  s_waitcnt lgkmcnt(0)
  s_barrier
  s_lshr_b32 s92, 0x1100, s30
  s_bitcmp1_b32 s92, 0
  s_cbranch_scc0 L_p1c
  s_cmp_eq_u32 s30, 8
  s_cselect_b32 s98, 8, 17
  ds_read_b128 a[176:179], v74 offset:18432
  ds_read_b128 a[180:183], v74 offset:19456
  ds_read_b128 a[184:187], v74 offset:20480
  ds_read_b128 a[188:191], v74 offset:21504
  ds_read_b128 a[192:195], v74 offset:22528
  ds_read_b128 a[196:199], v74 offset:23552
  ds_read_b128 a[200:203], v74 offset:24576
  v_lshrrev_b32 v75, 5, v1
  s_lshl_b32 s91, s28, 2
  v_add_u32 v75, s91, v75
  v_and_b32 v76, 15, v1
  v_xor_b32 v75, v75, v76
  v_xor_b32 v76, 2, v75
  v_lshlrev_b32 v75, 3, v75
  v_lshlrev_b32 v76, 3, v76
  v_and_b32 v72, 31, v1
  v_lshl_add_u32 v75, v72, 7, v75
  v_lshl_add_u32 v76, v72, 7, v76
  s_waitcnt lgkmcnt(6)
  v_mfma_f32_32x32x16_bf16 v[80:95], a[0:3], a[176:179], 0
  ds_read_b128 a[204:207], v74 offset:25600
  s_waitcnt lgkmcnt(6)
  v_mfma_f32_32x32x16_bf16 v[80:95], a[4:7], a[180:183], v[80:95]
  ds_read_b128 a[176:179], v74 offset:26624
  s_waitcnt lgkmcnt(6)
  v_mfma_f32_32x32x16_bf16 v[80:95], a[8:11], a[184:187], v[80:95]
  ds_read_b128 a[180:183], v74 offset:27648
  s_waitcnt lgkmcnt(6)
  v_mfma_f32_32x32x16_bf16 v[80:95], a[12:15], a[188:191], v[80:95]
  ds_read_b128 a[184:187], v74 offset:28672
  s_waitcnt lgkmcnt(6)
  v_mfma_f32_32x32x16_bf16 v[80:95], a[16:19], a[192:195], v[80:95]
  ds_read_b128 a[188:191], v74 offset:29696
  s_waitcnt lgkmcnt(6)
  v_mfma_f32_32x32x16_bf16 v[80:95], a[20:23], a[196:199], v[80:95]
  ds_read_b128 a[192:195], v74 offset:30720
  s_waitcnt lgkmcnt(6)
  v_mfma_f32_32x32x16_bf16 v[80:95], a[24:27], a[200:203], v[80:95]
  ds_read_b128 a[196:199], v74 offset:31744
  s_waitcnt lgkmcnt(6)
  v_mfma_f32_32x32x16_bf16 v[80:95], a[28:31], a[204:207], v[80:95]
  ds_read_b128 a[200:203], v74 offset:32768
  s_waitcnt lgkmcnt(6)
  v_mfma_f32_32x32x16_bf16 v[80:95], a[32:35], a[176:179], v[80:95]
  ds_read_b128 a[204:207], v74 offset:33792
  s_waitcnt lgkmcnt(6)
  v_mfma_f32_32x32x16_bf16 v[80:95], a[36:39], a[180:183], v[80:95]
  ds_read_b128 a[176:179], v74 offset:34816
  s_waitcnt lgkmcnt(6)
  v_mfma_f32_32x32x16_bf16 v[80:95], a[40:43], a[184:187], v[80:95]
  ds_read_b128 a[180:183], v74 offset:35840
  s_waitcnt lgkmcnt(6)
  v_mfma_f32_32x32x16_bf16 v[80:95], a[44:47], a[188:191], v[80:95]
  ds_read_b128 a[184:187], v74 offset:18432
  s_waitcnt lgkmcnt(6)
  v_mfma_f32_32x32x16_bf16 v[80:95], a[48:51], a[192:195], v[80:95]
  ds_read_b128 a[188:191], v74 offset:19456
  s_waitcnt lgkmcnt(6)
  v_mfma_f32_32x32x16_bf16 v[80:95], a[52:55], a[196:199], v[80:95]
  ds_read_b128 a[192:195], v74 offset:20480
  s_waitcnt lgkmcnt(6)
  v_mfma_f32_32x32x16_bf16 v[80:95], a[56:59], a[200:203], v[80:95]
  ds_read_b128 a[196:199], v74 offset:21504
  s_waitcnt lgkmcnt(6)
  v_mfma_f32_32x32x16_bf16 v[80:95], a[60:63], a[204:207], v[80:95]
  ds_read_b128 a[200:203], v74 offset:22528
  s_waitcnt lgkmcnt(6)
  v_mfma_f32_32x32x16_bf16 v[80:95], a[64:67], a[176:179], v[80:95]
  ds_read_b128 a[204:207], v74 offset:23552
  s_waitcnt lgkmcnt(6)
  v_mfma_f32_32x32x16_bf16 v[80:95], a[68:71], a[180:183], v[80:95]
  ds_read_b128 a[176:179], v74 offset:24576
  s_waitcnt lgkmcnt(6)
  v_mfma_f32_32x32x16_bf16 v[96:111], a[72:75], a[184:187], 0
  ds_read_b128 a[180:183], v74 offset:25600
  s_waitcnt lgkmcnt(6)
  v_mfma_f32_32x32x16_bf16 v[96:111], a[76:79], a[188:191], v[96:111]
  ds_read_b128 a[184:187], v74 offset:26624
  s_waitcnt lgkmcnt(6)
  v_mfma_f32_32x32x16_bf16 v[96:111], a[80:83], a[192:195], v[96:111]
  ds_read_b128 a[188:191], v74 offset:27648
  s_waitcnt lgkmcnt(6)
  v_mfma_f32_32x32x16_bf16 v[96:111], a[84:87], a[196:199], v[96:111]
  ds_read_b128 a[192:195], v74 offset:28672
  s_waitcnt lgkmcnt(6)
  v_mfma_f32_32x32x16_bf16 v[96:111], a[88:91], a[200:203], v[96:111]
  ds_read_b128 a[196:199], v74 offset:29696
  s_waitcnt lgkmcnt(6)
  v_mfma_f32_32x32x16_bf16 v[96:111], a[92:95], a[204:207], v[96:111]
  ds_read_b128 a[200:203], v74 offset:30720
  s_waitcnt lgkmcnt(6)
  v_mfma_f32_32x32x16_bf16 v[96:111], a[96:99], a[176:179], v[96:111]
  ds_read_b128 a[204:207], v74 offset:31744
  s_waitcnt lgkmcnt(6)
  v_mfma_f32_32x32x16_bf16 v[96:111], a[100:103], a[180:183], v[96:111]
  ds_read_b128 a[176:179], v74 offset:32768
  s_waitcnt lgkmcnt(6)
  v_mfma_f32_32x32x16_bf16 v[96:111], a[104:107], a[184:187], v[96:111]
  ds_read_b128 a[180:183], v74 offset:33792
  s_waitcnt lgkmcnt(6)
  v_mfma_f32_32x32x16_bf16 v[96:111], a[108:111], a[188:191], v[96:111]
  ds_read_b128 a[184:187], v74 offset:34816
  s_waitcnt lgkmcnt(6)
  v_mfma_f32_32x32x16_bf16 v[96:111], a[112:115], a[192:195], v[96:111]
  ds_read_b128 a[188:191], v74 offset:35840
  s_waitcnt lgkmcnt(6)
  v_mfma_f32_32x32x16_bf16 v[96:111], a[116:119], a[196:199], v[96:111]
  s_waitcnt lgkmcnt(5)
  v_mfma_f32_32x32x16_bf16 v[96:111], a[120:123], a[200:203], v[96:111]
  s_waitcnt lgkmcnt(4)
  v_mfma_f32_32x32x16_bf16 v[96:111], a[124:127], a[204:207], v[96:111]
  s_waitcnt lgkmcnt(3)
  v_mfma_f32_32x32x16_bf16 v[96:111], a[128:131], a[176:179], v[96:111]
  s_waitcnt lgkmcnt(2)
  v_mfma_f32_32x32x16_bf16 v[96:111], a[132:135], a[180:183], v[96:111]
  s_waitcnt lgkmcnt(1)
  v_mfma_f32_32x32x16_bf16 v[96:111], a[136:139], a[184:187], v[96:111]
  s_waitcnt lgkmcnt(0)
  v_mfma_f32_32x32x16_bf16 v[96:111], a[140:143], a[188:191], v[96:111]
  s_cmp_lt_u32 s98, 9
  s_cselect_b32 s84, 1.0, -1.0
  s_nop 9
  v_fma_f32 v80, v96, s84, v80
  v_fma_f32 v81, v97, s84, v81
  v_fma_f32 v82, v98, s84, v82
  v_fma_f32 v83, v99, s84, v83
  v_fma_f32 v84, v100, s84, v84
  v_fma_f32 v85, v101, s84, v85
  v_fma_f32 v86, v102, s84, v86
  v_fma_f32 v87, v103, s84, v87
  v_fma_f32 v88, v104, s84, v88
  v_fma_f32 v89, v105, s84, v89
  v_fma_f32 v90, v106, s84, v90
  v_fma_f32 v91, v107, s84, v91
  v_fma_f32 v92, v108, s84, v92
  v_fma_f32 v93, v109, s84, v93
  v_fma_f32 v94, v110, s84, v94
  v_fma_f32 v95, v111, s84, v95
  v_cvt_pk_bf16_f32 v80, v80, v81
  v_cvt_pk_bf16_f32 v81, v82, v83
  v_cvt_pk_bf16_f32 v82, v84, v85
  v_cvt_pk_bf16_f32 v83, v86, v87
  v_cvt_pk_bf16_f32 v84, v88, v89
  v_cvt_pk_bf16_f32 v85, v90, v91
  v_cvt_pk_bf16_f32 v86, v92, v93
  v_cvt_pk_bf16_f32 v87, v94, v95
  v_mfma_f32_32x32x16_bf16 v[112:127], v[80:83], v[40:43], 0
  v_mfma_f32_32x32x16_bf16 v[160:175], v[80:83], v[48:51], 0
  v_mfma_f32_32x32x16_bf16 v[112:127], v[84:87], v[44:47], v[112:127]
  v_mfma_f32_32x32x16_bf16 v[160:175], v[84:87], v[52:55], v[160:175]
  s_nop 11
  v_add_f32 v112, v112, v161
  v_sub_f32 v113, v113, v160
  v_add_f32 v114, v114, v163
  v_sub_f32 v115, v115, v162
  v_cvt_pk_bf16_f32 v112, v112, v113
  v_cvt_pk_bf16_f32 v113, v114, v115
  v_add_f32 v116, v116, v165
  v_sub_f32 v117, v117, v164
  v_add_f32 v118, v118, v167
  v_sub_f32 v119, v119, v166
  v_cvt_pk_bf16_f32 v116, v116, v117
  v_cvt_pk_bf16_f32 v117, v118, v119
  v_add_f32 v120, v120, v169
  v_sub_f32 v121, v121, v168
  v_add_f32 v122, v122, v171
  v_sub_f32 v123, v123, v170
  v_cvt_pk_bf16_f32 v120, v120, v121
  v_cvt_pk_bf16_f32 v121, v122, v123
  v_add_f32 v124, v124, v173
  v_sub_f32 v125, v125, v172
  v_add_f32 v126, v126, v175
  v_sub_f32 v127, v127, v174
  v_cvt_pk_bf16_f32 v124, v124, v125
  v_cvt_pk_bf16_f32 v125, v126, v127
  ds_write_b64 v75, v[112:113] offset:8192
  ds_write_b64 v76, v[116:117] offset:8192
  ds_write_b64 v75, v[120:121] offset:12288
  ds_write_b64 v76, v[124:125] offset:12288
L_p1c:
  ds_read_b128 a[144:147], v74 offset:0
  ds_read_b128 a[148:151], v74 offset:1024
  ds_read_b128 a[152:155], v74 offset:2048
  ds_read_b128 a[156:159], v74 offset:3072
  ds_read_b128 a[160:163], v74 offset:4096
  ds_read_b128 a[164:167], v74 offset:5120
  ds_read_b128 a[168:171], v74 offset:6144
  s_waitcnt lgkmcnt(6)
  v_mfma_f32_32x32x16_bf16 v[80:95], a[0:3], a[144:147], 0
  s_waitcnt lgkmcnt(5)
  ds_read_b128 a[172:175], v74 offset:7168
  v_lshrrev_b32 v79, 4, v1
  v_mul_u32_u24 v79, 73984, v79
  v_and_b32 v78, 14, v1
  v_lshl_add_u32 v79, v78, 1, v79
  v_mfma_f32_32x32x16_bf16 v[80:95], a[4:7], a[148:151], v[80:95]
  s_waitcnt lgkmcnt(5)
  s_lshl_b32 s88, s39, 2
  ds_read_b128 a[144:147], v74 offset:8192
  s_add_u32 s88, s88, s28
  s_mul_i32 s88, s88, 578
  s_cmp_lt_u32 s78, 18
  s_cselect_b32 s87, 2, -287
  s_lshl_b32 s99, s78, 4
  v_mfma_f32_32x32x16_bf16 v[80:95], a[8:11], a[152:155], v[80:95]
  s_waitcnt lgkmcnt(2)
  s_add_i32 s87, s87, s99
  ds_read_b128 a[148:151], v74 offset:9216
  s_lshl_b32 s87, s87, 1
  s_add_u32 s88, s88, s87
  v_add_u32 v79, s88, v79
  v_and_b32 v240, 1, v1
  v_mfma_f32_32x32x16_bf16 v[80:95], a[12:15], a[156:159], v[80:95]
  ds_read_b128 a[152:155], v74 offset:10240
  v_cmp_eq_u32 vcc, 0, v240
  v_mov_b32 v240, s22
  v_mov_b32 v241, s20
  v_cndmask_b32 v240, v240, v241, vcc
  v_add_co_u32 v240, s[98:99], v240, v79
  v_mov_b32 v79, s23
  v_mov_b32 v241, s21
  v_cndmask_b32 v241, v79, v241, vcc
  v_mfma_f32_32x32x16_bf16 v[80:95], a[16:19], a[160:163], v[80:95]
  ds_read_b128 a[156:159], v74 offset:11264
  v_addc_co_u32 v241, vcc, 0, v241, s[98:99]
  v_bfe_u32 v15, v1, 2, 2
  v_lshrrev_b32 v16, 5, v1
  v_lshl_add_u32 v16, v16, 3, v15
  v_mfma_f32_32x32x16_bf16 v[80:95], a[20:23], a[164:167], v[80:95]
  ds_read_b128 a[160:163], v74 offset:12288
  v_bfe_u32 v17, v1, 4, 1
  v_and_b32 v18, 3, v1
  v_lshlrev_b32 v18, 3, v18
  v_lshl_add_u32 v17, v17, 5, v18
  v_mfma_f32_32x32x16_bf16 v[80:95], a[24:27], a[168:171], v[80:95]
  s_waitcnt lgkmcnt(2)
  ds_read_b128 a[164:167], v74 offset:13312
  v_lshl_add_u32 v14, v16, 6, v17
  v_add_u32 v14, 16384, v14
  v_lshl_add_u32 v16, v16, 7, v17
  v_lshrrev_b32 v15, 1, v15
  v_mfma_f32_32x32x16_bf16 v[80:95], a[28:31], a[172:175], v[80:95]
  ds_read_b128 a[168:171], v74 offset:14336
  v_lshl_add_u32 v17, v15, 6, v16
  v_xor_b32 v15, 1, v15
  v_lshl_add_u32 v18, v15, 6, v16
  v_add_u32 v8, 16384, v17
  v_mfma_f32_32x32x16_bf16 v[80:95], a[32:35], a[144:147], v[80:95]
  ds_read_b128 a[172:175], v74 offset:15360
  v_add_u32 v9, 65536, v17
  v_add_u32 v10, 114688, v17
  v_add_u32 v11, 16384, v18
  v_add_u32 v12, 65536, v18
  v_mfma_f32_32x32x16_bf16 v[80:95], a[36:39], a[148:151], v[80:95]
  ds_read_b128 a[144:147], v74 offset:16384
  v_add_u32 v13, 114688, v18
  s_lshl_b32 s91, s28, 12
  s_add_u32 s91, s91, 108544
  v_and_b32 v245, 31, v1
  v_mfma_f32_32x32x16_bf16 v[80:95], a[40:43], a[152:155], v[80:95]
  s_waitcnt lgkmcnt(2)
  ds_read_b128 a[148:151], v74 offset:17408
  v_lshlrev_b32 v245, 6, v245
  v_lshrrev_b32 v246, 5, v1
  v_lshl_add_u32 v245, v246, 4, v245
  v_add_u32 v245, s91, v245
  v_mfma_f32_32x32x16_bf16 v[80:95], a[44:47], a[156:159], v[80:95]
  ds_read_b128 a[152:155], v74 offset:0
  v_lshrrev_b32 v246, 2, v1
  v_lshlrev_b32 v246, 6, v246
  v_and_b32 v247, 1, v1
  v_lshl_add_u32 v246, v247, 4, v246
  v_mfma_f32_32x32x16_bf16 v[80:95], a[48:51], a[160:163], v[80:95]
  ds_read_b128 a[156:159], v74 offset:1024
  v_bfe_u32 v247, v1, 1, 1
  v_lshl_add_u32 v246, v247, 3, v246
  v_add_u32 v246, s91, v246
  v_lshrrev_b32 v75, 5, v1
  v_mfma_f32_32x32x16_bf16 v[80:95], a[52:55], a[164:167], v[80:95]
  s_lshl_b32 s91, s28, 2
  ds_read_b128 a[160:163], v74 offset:2048
  v_add_u32 v75, s91, v75
  v_and_b32 v76, 15, v1
  v_xor_b32 v75, v75, v76
  v_xor_b32 v76, 2, v75
  v_mfma_f32_32x32x16_bf16 v[80:95], a[56:59], a[168:171], v[80:95]
  s_waitcnt lgkmcnt(2)
  s_add_u32 m0, s36, 126848
  ds_read_b128 a[164:167], v74 offset:3072
  buffer_load_dwordx4 v4, s[8:11], s49 offen offset:128 lds
  v_lshlrev_b32 v75, 3, v75
  v_lshlrev_b32 v76, 3, v76
  v_and_b32 v72, 31, v1
  v_mfma_f32_32x32x16_bf16 v[80:95], a[60:63], a[172:175], v[80:95]
  ds_read_b128 a[168:171], v74 offset:4096
  v_lshl_add_u32 v75, v72, 7, v75
  v_lshl_add_u32 v76, v72, 7, v76
  v_lshrrev_b32 v177, 4, v1
  s_mul_i32 s93, s28, 8
  v_mfma_f32_32x32x16_bf16 v[80:95], a[64:67], a[144:147], v[80:95]
  ds_read_b128 a[172:175], v74 offset:5120
  v_add_u32 v177, s93, v177
  v_and_b32 v178, 15, v1
  v_lshlrev_b32 v176, 11, v177
  v_lshl_add_u32 v176, v178, 3, v176
  v_mfma_f32_32x32x16_bf16 v[80:95], a[68:71], a[148:151], v[80:95]
  s_add_u32 m0, s36, 130944
  ds_read_b128 a[144:147], v74 offset:6144
  buffer_load_dwordx4 v4, s[8:11], s50 offen offset:128 lds
  v_xor_b32 v178, v178, v177
  v_and_b32 v178, 15, v178
  v_lshlrev_b32 v178, 3, v178
  v_mfma_f32_32x32x16_bf16 v[96:111], a[72:75], a[152:155], 0
  s_waitcnt lgkmcnt(2)
  ds_read_b128 a[148:151], v74 offset:7168
  v_lshl_add_u32 v177, v177, 7, v178
  v_xor_b32 v178, 32, v177
  s_waitcnt vmcnt(24)
  v_accvgpr_read_b32 v19, a215
  s_nop 0
  v_mfma_f32_32x32x16_bf16 v[96:111], a[76:79], a[156:159], v[96:111]
  ds_read_b128 a[152:155], v74 offset:8192
  v_readfirstlane_b32 s34, v19
  s_nop 0
  s_mul_i32 s34, s34, 0x9e3779b1
  s_add_u32 s34, s34, 0x7f4a7c15
  v_mfma_f32_32x32x16_bf16 v[96:111], a[80:83], a[160:163], v[96:111]
  ds_read_b128 a[156:159], v74 offset:9216
  global_load_ushort v184, v[240:241], off
  s_lshr_b32 s89, s78, 1
  s_cmp_ge_u32 s78, 18
  s_subb_u32 s89, s89, 0
  v_mfma_f32_32x32x16_bf16 v[96:111], a[84:87], a[164:167], v[96:111]
  s_waitcnt lgkmcnt(2)
  ds_read_b128 a[160:163], v74 offset:10240
  s_lshr_b32 s92, 4352, s30
  s_bitcmp0_b32 s92, 0
  s_cselect_b32 s89, s89, s30
  s_lshr_b32 s90, s79, 1
  v_mfma_f32_32x32x16_bf16 v[96:111], a[88:91], a[168:171], v[96:111]
  s_add_u32 m0, s36, 135040
  ds_read_b128 a[164:167], v74 offset:11264
  buffer_load_dwordx4 v4, s[8:11], s51 offen offset:128 lds
  s_cmp_ge_u32 s79, 18
  s_subb_u32 s90, s90, 0
  v_lshl_add_u64 v[240:241], v[240:241], 0, s[24:25]
  v_mfma_f32_32x32x16_bf16 v[96:111], a[92:95], a[172:175], v[96:111]
  ds_read_b128 a[168:171], v74 offset:12288
  global_load_ushort v185, v[240:241], off
  s_cmp_eq_u32 s90, 16
  s_cselect_b32 s90, 12, s90
  v_mfma_f32_32x32x16_bf16 v[96:111], a[96:99], a[144:147], v[96:111]
  s_waitcnt vmcnt(16)
  s_barrier
  ds_read_b128 a[172:175], v74 offset:13312
  ds_write_b128 v245, v[40:43] offset:0
  s_cmp_eq_u32 s85, 1
  s_cselect_b32 s90, s90, s89
  s_lshl_b32 s90, s90, 16
  s_or_b32 s90, s90, 0x2000000
  v_mfma_f32_32x32x16_bf16 v[96:111], a[100:103], a[148:151], v[96:111]
  s_waitcnt lgkmcnt(3)
  s_add_u32 m0, s36, 139136
  ds_read_b128 a[144:147], v74 offset:14336
  ds_write_b128 v245, v[44:47] offset:32
  buffer_load_dwordx4 v4, s[8:11], s52 offen offset:128 lds
  s_lshl_b32 s95, s89, 8
  s_or_b32 s90, s90, s95
  v_lshl_add_u64 v[240:241], v[240:241], 0, s[24:25]
  v_mfma_f32_32x32x16_bf16 v[96:111], a[104:107], a[152:155], v[96:111]
  ds_read_b128 a[148:151], v74 offset:15360
  ds_write_b128 v245, v[48:51] offset:2048
  global_load_ushort v186, v[240:241], off
  s_or_b32 s90, s90, s30
  v_lshrrev_b32 v181, 4, v1
  v_mfma_f32_32x32x16_bf16 v[96:111], a[108:111], a[156:159], v[96:111]
  ds_read_b128 a[152:155], v74 offset:16384
  ds_write_b128 v245, v[52:55] offset:2080
  v_lshlrev_b32 v181, 3, v181
  v_bfe_u32 v181, s90, v181, 8
  v_and_b32 v182, 15, v1
  v_mfma_f32_32x32x16_bf16 v[96:111], a[112:115], a[160:163], v[96:111]
  s_add_u32 m0, s36, 143232
  ds_read_b128 a[156:159], v74 offset:17408
  ds_read_b64_tr_b16 a[240:241], v246 offset:0
  buffer_load_dwordx4 v4, s[8:11], s53 offen offset:128 lds
  v_lshlrev_b32 v182, 2, v182
  v_lshl_add_u32 v181, v181, 7, v182
  v_lshl_add_u64 v[240:241], v[240:241], 0, s[24:25]
  v_mfma_f32_32x32x16_bf16 v[96:111], a[116:119], a[164:167], v[96:111]
  s_waitcnt lgkmcnt(5)
  ds_read_b64_tr_b16 a[160:161], v8 offset:0
  ds_read_b64_tr_b16 a[162:163], v8 offset:512
  ds_read_b64_tr_b16 a[242:243], v246 offset:1024
  global_load_ushort v187, v[240:241], off
  s_add_u32 s89, s36, 65536
  v_mfma_f32_32x32x16_bf16 v[96:111], a[120:123], a[168:171], v[96:111]
  ds_read_b64_tr_b16 a[164:165], v8 offset:2048
  ds_read_b64_tr_b16 a[166:167], v8 offset:2560
  ds_read_b64_tr_b16 a[244:245], v246 offset:32
  s_cmp_ge_u32 s28, 2
  s_cselect_b32 s82, 3, 4
  s_lshl_b32 s82, s82, 12
  v_mfma_f32_32x32x16_bf16 v[96:111], a[124:127], a[172:175], v[96:111]
  s_add_u32 m0, s36, 147328
  ds_read_b64_tr_b16 a[168:169], v8 offset:4096
  ds_read_b64_tr_b16 a[170:171], v8 offset:4608
  ds_read_b64_tr_b16 a[246:247], v246 offset:1056
  buffer_load_dwordx4 v4, s[8:11], s54 offen offset:128 lds
  s_add_u32 s82, s82, s36
  v_lshl_add_u64 v[240:241], v[240:241], 0, s[26:27]
  v_mfma_f32_32x32x16_bf16 v[96:111], a[128:131], a[144:147], v[96:111]
  ds_read_b64_tr_b16 a[172:173], v8 offset:6144
  ds_read_b64_tr_b16 a[174:175], v8 offset:6656
  ds_read_b64_tr_b16 a[248:249], v246 offset:2048
  global_load_ushort v188, v[240:241], off
  v_bfe_u32 v34, v1, 2, 2
  v_lshl_add_u64 v[240:241], v[240:241], 0, s[24:25]
  v_mfma_f32_32x32x16_bf16 v[96:111], a[132:135], a[148:151], v[96:111]
  s_waitcnt lgkmcnt(7)
  ds_read_b64_tr_b16 a[144:145], v8 offset:8192
  ds_read_b64_tr_b16 a[146:147], v8 offset:8704
  ds_read_b64_tr_b16 a[250:251], v246 offset:3072
  global_load_ushort v189, v[240:241], off
  v_bfe_u32 v35, v1, 4, 1
  v_mfma_f32_32x32x16_bf16 v[96:111], a[136:139], a[152:155], v[96:111]
  ds_read_b64_tr_b16 a[148:149], v8 offset:10240
  ds_read_b64_tr_b16 a[150:151], v8 offset:10752
  ds_read_b64_tr_b16 a[252:253], v246 offset:2080
  v_lshrrev_b32 v36, 5, v1
  v_lshl_add_u32 v36, v36, 2, v34
  v_lshl_add_u32 v36, v35, 4, v36
  v_mfma_f32_32x32x16_bf16 v[96:111], a[140:143], a[156:159], v[96:111]
  s_add_u32 m0, s36, 151424
  ds_read_b64_tr_b16 a[152:153], v8 offset:12288
  ds_read_b64_tr_b16 a[154:155], v8 offset:12800
  ds_read_b64_tr_b16 a[254:255], v246 offset:3104
  buffer_load_dwordx4 v4, s[8:11], s55 offen offset:128 lds
  v_lshrrev_b32 v34, 1, v34
  v_lshl_add_u64 v[240:241], v[240:241], 0, s[24:25]
  v_mfma_f32_32x32x16_bf16 v[128:143], a[160:163], a[0:3], 0
  s_waitcnt lgkmcnt(7)
  ds_read_b64_tr_b16 a[156:157], v8 offset:14336
  ds_read_b64_tr_b16 a[158:159], v8 offset:14848
  global_load_ushort v190, v[240:241], off
  v_lshl_add_u32 v34, v35, 1, v34
  s_andn2_b32 s99, 1, s31
  v_mfma_f32_32x32x16_bf16 v[128:143], a[164:167], a[4:7], v[128:143]
  s_lshl_b32 s99, s99, 1
  ds_read_b64_tr_b16 a[160:161], v8 offset:16384
  ds_read_b64_tr_b16 a[162:163], v8 offset:16896
  v_xor_b32 v34, s99, v34
  v_and_b32 v37, 3, v1
  v_lshlrev_b32 v37, 3, v37
  v_mfma_f32_32x32x16_bf16 v[128:143], a[168:171], a[8:11], v[128:143]
  s_add_u32 m0, s36, 155520
  ds_read_b64_tr_b16 a[164:165], v8 offset:18432
  ds_read_b64_tr_b16 a[166:167], v8 offset:18944
  buffer_load_dwordx4 v4, s[8:11], s56 offen offset:128 lds
  v_lshl_add_u32 v38, v36, 6, v37
  v_lshl_add_u32 v39, v36, 7, v37
  v_lshl_add_u64 v[240:241], v[240:241], 0, s[24:25]
  v_mfma_f32_32x32x16_bf16 v[128:143], a[172:175], a[12:15], v[128:143]
  ds_read_b64_tr_b16 a[168:169], v8 offset:20480
  ds_read_b64_tr_b16 a[170:171], v8 offset:20992
  global_load_ushort v191, v[240:241], off
  s_cmp_lt_u32 s76, 9
  s_cselect_b32 s84, 1.0, -1.0
  v_mfma_f32_32x32x16_bf16 v[128:143], a[144:147], a[16:19], v[128:143]
  s_waitcnt lgkmcnt(4)
  ds_read_b64_tr_b16 a[172:173], v8 offset:22528
  ds_read_b64_tr_b16 a[174:175], v8 offset:23040
  v_fma_f32 v80, v96, s84, v80
  v_fma_f32 v81, v97, s84, v81
  v_fma_f32 v82, v98, s84, v82
  v_mfma_f32_32x32x16_bf16 v[128:143], a[148:151], a[20:23], v[128:143]
  s_waitcnt vmcnt(18)
  s_barrier
  ds_read_b64_tr_b16 a[144:145], v8 offset:24576
  ds_read_b64_tr_b16 a[146:147], v8 offset:25088
  v_fma_f32 v83, v99, s84, v83
  v_fma_f32 v84, v100, s84, v84
  v_fma_f32 v85, v101, s84, v85
  v_mfma_f32_32x32x16_bf16 v[128:143], a[152:155], a[24:27], v[128:143]
  s_add_u32 m0, s36, 159616
  ds_read_b64_tr_b16 a[148:149], v8 offset:26624
  ds_read_b64_tr_b16 a[150:151], v8 offset:27136
  buffer_load_dwordx4 v4, s[8:11], s57 offen offset:128 lds
  v_fma_f32 v86, v102, s84, v86
  v_fma_f32 v87, v103, s84, v87
  v_mfma_f32_32x32x16_bf16 v[128:143], a[156:159], a[28:31], v[128:143]
  s_waitcnt lgkmcnt(4)
  ds_read_b64_tr_b16 a[152:153], v8 offset:28672
  ds_read_b64_tr_b16 a[154:155], v8 offset:29184
  v_fma_f32 v88, v104, s84, v88
  v_fma_f32 v89, v105, s84, v89
  v_fma_f32 v90, v106, s84, v90
  v_mfma_f32_32x32x16_bf16 v[128:143], a[160:163], a[32:35], v[128:143]
  s_add_u32 m0, s36, 89984
  ds_read_b64_tr_b16 a[156:157], v8 offset:30720
  ds_read_b64_tr_b16 a[158:159], v8 offset:31232
  buffer_load_dwordx4 v4, s[8:11], s40 offen offset:128 lds
  v_fma_f32 v91, v107, s84, v91
  v_fma_f32 v92, v108, s84, v92
  v_mfma_f32_32x32x16_bf16 v[128:143], a[164:167], a[36:39], v[128:143]
  ds_read_b64_tr_b16 a[160:161], v8 offset:32768
  ds_read_b64_tr_b16 a[162:163], v8 offset:33280
  v_fma_f32 v93, v109, s84, v93
  v_fma_f32 v94, v110, s84, v94
  v_fma_f32 v95, v111, s84, v95
  v_mfma_f32_32x32x16_bf16 v[128:143], a[168:171], a[40:43], v[128:143]
  s_add_u32 m0, s36, 94080
  ds_read_b64_tr_b16 a[164:165], v8 offset:34816
  ds_read_b64_tr_b16 a[166:167], v8 offset:35328
  buffer_load_dwordx4 v4, s[8:11], s41 offen offset:128 lds
  v_cvt_pk_bf16_f32 v80, v80, v81
  v_cvt_pk_bf16_f32 v81, v82, v83
  v_mfma_f32_32x32x16_bf16 v[128:143], a[172:175], a[44:47], v[128:143]
  s_waitcnt lgkmcnt(4)
  ds_read_b64_tr_b16 a[168:169], v8 offset:36864
  ds_read_b64_tr_b16 a[170:171], v8 offset:37376
  v_cvt_pk_bf16_f32 v82, v84, v85
  v_cvt_pk_bf16_f32 v83, v86, v87
  v_cvt_pk_bf16_f32 v84, v88, v89
  v_mfma_f32_32x32x16_bf16 v[128:143], a[144:147], a[48:51], v[128:143]
  s_add_u32 m0, s36, 98176
  ds_read_b64_tr_b16 a[172:173], v8 offset:38912
  ds_read_b64_tr_b16 a[174:175], v8 offset:39424
  buffer_load_dwordx4 v4, s[8:11], s42 offen offset:128 lds
  v_cvt_pk_bf16_f32 v85, v90, v91
  v_cvt_pk_bf16_f32 v86, v92, v93
  v_mfma_f32_32x32x16_bf16 v[128:143], a[148:151], a[52:55], v[128:143]
  ds_read_b64_tr_b16 a[144:145], v8 offset:40960
  ds_read_b64_tr_b16 a[146:147], v8 offset:41472
  v_cvt_pk_bf16_f32 v87, v94, v95
  v_xor_b32 v36, 0, v34
  v_lshl_add_u32 v36, v36, 5, v39
  v_mfma_f32_32x32x16_bf16 v[128:143], a[152:155], a[56:59], v[128:143]
  s_add_u32 m0, s36, 102272
  ds_read_b64_tr_b16 a[148:149], v8 offset:43008
  ds_read_b64_tr_b16 a[150:151], v8 offset:43520
  buffer_load_dwordx4 v4, s[8:11], s43 offen offset:128 lds
  v_add_u32 v15, 16384, v36
  v_add_u32 v16, 65536, v36
  v_mfma_f32_32x32x16_bf16 v[112:127], v[80:83], v[40:43], 0
  v_mfma_f32_32x32x16_bf16 v[160:175], v[80:83], v[48:51], 0
  v_mfma_f32_32x32x16_bf16 v[112:127], v[84:87], v[44:47], v[112:127]
  v_mfma_f32_32x32x16_bf16 v[160:175], v[84:87], v[52:55], v[160:175]
  v_mfma_f32_32x32x16_bf16 v[128:143], a[156:159], a[60:63], v[128:143]
  s_waitcnt lgkmcnt(4)
  ds_read_b64_tr_b16 a[152:153], v8 offset:45056
  ds_read_b64_tr_b16 a[154:155], v8 offset:45568
  v_add_u32 v17, 114688, v36
  v_xor_b32 v36, 1, v34
  v_lshl_add_u32 v36, v36, 5, v39
  v_mfma_f32_32x32x16_bf16 v[128:143], a[160:163], a[64:67], v[128:143]
  s_add_u32 m0, s36, 106368
  ds_read_b64_tr_b16 a[156:157], v8 offset:47104
  ds_read_b64_tr_b16 a[158:159], v8 offset:47616
  buffer_load_dwordx4 v4, s[8:11], s44 offen offset:128 lds
  v_add_u32 v18, 16384, v36
  v_add_u32 v19, 65536, v36
  v_mfma_f32_32x32x16_bf16 v[128:143], a[164:167], a[68:71], v[128:143]
  ds_read_b64_tr_b16 a[160:161], v9 offset:0
  ds_read_b64_tr_b16 a[162:163], v9 offset:512
  v_add_f32 v112, v112, v161
  v_sub_f32 v113, v113, v160
  v_add_f32 v114, v114, v163
  v_mfma_f32_32x32x16_bf16 v[128:143], a[168:171], a[72:75], v[128:143]
  s_add_u32 m0, s36, 110464
  ds_read_b64_tr_b16 a[164:165], v9 offset:2048
  ds_read_b64_tr_b16 a[166:167], v9 offset:2560
  buffer_load_dwordx4 v4, s[8:11], s45 offen offset:128 lds
  v_sub_f32 v115, v115, v162
  v_cvt_pk_bf16_f32 v112, v112, v113
  v_mfma_f32_32x32x16_bf16 v[128:143], a[172:175], a[76:79], v[128:143]
  s_waitcnt lgkmcnt(4)
  ds_read_b64_tr_b16 a[168:169], v9 offset:4096
  ds_read_b64_tr_b16 a[170:171], v9 offset:4608
  v_cvt_pk_bf16_f32 v113, v114, v115
  v_add_f32 v116, v116, v165
  v_sub_f32 v117, v117, v164
  v_mfma_f32_32x32x16_bf16 v[128:143], a[144:147], a[80:83], v[128:143]
  s_add_u32 m0, s36, 114560
  ds_read_b64_tr_b16 a[172:173], v9 offset:6144
  ds_read_b64_tr_b16 a[174:175], v9 offset:6656
  buffer_load_dwordx4 v4, s[8:11], s46 offen offset:128 lds
  v_add_f32 v118, v118, v167
  v_sub_f32 v119, v119, v166
  v_mfma_f32_32x32x16_bf16 v[128:143], a[148:151], a[84:87], v[128:143]
  ds_read_b64_tr_b16 a[144:145], v9 offset:8192
  ds_read_b64_tr_b16 a[146:147], v9 offset:8704
  v_cvt_pk_bf16_f32 v116, v116, v117
  v_cvt_pk_bf16_f32 v117, v118, v119
  v_add_f32 v120, v120, v169
  v_mfma_f32_32x32x16_bf16 v[128:143], a[152:155], a[88:91], v[128:143]
  s_add_u32 m0, s36, 118656
  ds_read_b64_tr_b16 a[148:149], v9 offset:10240
  ds_read_b64_tr_b16 a[150:151], v9 offset:10752
  buffer_load_dwordx4 v4, s[8:11], s47 offen offset:128 lds
  v_sub_f32 v121, v121, v168
  v_add_f32 v122, v122, v171
  v_mfma_f32_32x32x16_bf16 v[128:143], a[156:159], a[92:95], v[128:143]
  s_waitcnt lgkmcnt(4)
  ds_read_b64_tr_b16 a[152:153], v9 offset:12288
  ds_read_b64_tr_b16 a[154:155], v9 offset:12800
  v_sub_f32 v123, v123, v170
  v_cvt_pk_bf16_f32 v120, v120, v121
  v_cvt_pk_bf16_f32 v121, v122, v123
  v_mfma_f32_32x32x16_bf16 v[128:143], a[160:163], a[96:99], v[128:143]
  s_add_u32 m0, s36, 122752
  ds_read_b64_tr_b16 a[156:157], v9 offset:14336
  ds_read_b64_tr_b16 a[158:159], v9 offset:14848
  buffer_load_dwordx4 v4, s[8:11], s48 offen offset:128 lds
  v_add_f32 v124, v124, v173
  v_sub_f32 v125, v125, v172
  v_lshl_add_u64 v[240:241], v[240:241], 0, s[26:27]
  v_mfma_f32_32x32x16_bf16 v[128:143], a[164:167], a[100:103], v[128:143]
  ds_read_b64_tr_b16 a[160:161], v9 offset:16384
  ds_read_b64_tr_b16 a[162:163], v9 offset:16896
  global_load_ushort v192, v[240:241], off
  v_add_f32 v126, v126, v175
  v_sub_f32 v127, v127, v174
  v_lshl_add_u64 v[240:241], v[240:241], 0, s[24:25]
  v_mfma_f32_32x32x16_bf16 v[128:143], a[168:171], a[104:107], v[128:143]
  ds_read_b64_tr_b16 a[164:165], v9 offset:18432
  ds_read_b64_tr_b16 a[166:167], v9 offset:18944
  global_load_ushort v193, v[240:241], off
  v_cvt_pk_bf16_f32 v124, v124, v125
  v_cvt_pk_bf16_f32 v125, v126, v127
  v_lshl_add_u64 v[240:241], v[240:241], 0, s[24:25]
  v_mfma_f32_32x32x16_bf16 v[128:143], a[172:175], a[108:111], v[128:143]
  s_waitcnt lgkmcnt(4)
  ds_read_b64_tr_b16 a[168:169], v9 offset:20480
  ds_read_b64_tr_b16 a[170:171], v9 offset:20992
  ds_write_b64 v75, v[112:113] offset:0
  global_load_ushort v194, v[240:241], off
  v_add_u32 v20, 114688, v36
  v_lshl_add_u64 v[240:241], v[240:241], 0, s[24:25]
  v_mfma_f32_32x32x16_bf16 v[128:143], a[144:147], a[112:115], v[128:143]
  ds_read_b64_tr_b16 a[172:173], v9 offset:22528
  ds_read_b64_tr_b16 a[174:175], v9 offset:23040
  ds_write_b64 v76, v[116:117] offset:0
  global_load_ushort v195, v[240:241], off
  v_xor_b32 v36, 2, v34
  v_lshl_add_u64 v[240:241], v[240:241], 0, s[26:27]
  v_mfma_f32_32x32x16_bf16 v[128:143], a[148:151], a[116:119], v[128:143]
  ds_read_b64_tr_b16 a[144:145], v11 offset:0
  ds_read_b64_tr_b16 a[146:147], v11 offset:512
  ds_write_b64 v75, v[120:121] offset:4096
  global_load_ushort v196, v[240:241], off
  v_lshl_add_u32 v36, v36, 5, v39
  v_lshl_add_u64 v[240:241], v[240:241], 0, s[24:25]
  v_mfma_f32_32x32x16_bf16 v[128:143], a[152:155], a[120:123], v[128:143]
  ds_read_b64_tr_b16 a[148:149], v11 offset:2048
  ds_read_b64_tr_b16 a[150:151], v11 offset:2560
  ds_write_b64 v76, v[124:125] offset:4096
  global_load_ushort v197, v[240:241], off
  v_add_u32 v21, 16384, v36
  v_lshl_add_u64 v[240:241], v[240:241], 0, s[24:25]
  v_mfma_f32_32x32x16_bf16 v[128:143], a[156:159], a[124:127], v[128:143]
  s_waitcnt lgkmcnt(7)
  ds_read_b64_tr_b16 a[152:153], v11 offset:4096
  ds_read_b64_tr_b16 a[154:155], v11 offset:4608
  global_load_ushort v198, v[240:241], off
  v_add_u32 v22, 65536, v36
  v_add_u32 v23, 114688, v36
  v_lshl_add_u64 v[240:241], v[240:241], 0, s[24:25]
  v_mfma_f32_32x32x16_bf16 v[128:143], a[160:163], a[128:131], v[128:143]
  ds_read_b64_tr_b16 a[156:157], v11 offset:6144
  ds_read_b64_tr_b16 a[158:159], v11 offset:6656
  global_load_ushort v199, v[240:241], off
  v_xor_b32 v36, 3, v34
  v_lshl_add_u32 v36, v36, 5, v39
  s_lshl_b32 s87, s76, 17
  s_lshl_b32 s88, s29, 7
  s_add_u32 s87, s87, s88
  s_add_u32 s87, s87, 2097152
  s_waitcnt lgkmcnt(4)
  s_barrier
  v_mfma_f32_32x32x16_bf16 v[128:143], a[164:167], a[132:135], v[128:143]
  ds_read_b64_tr_b16 a[160:161], v11 offset:8192
  ds_read_b64_tr_b16 a[162:163], v11 offset:8704
  ds_read_b64_tr_b16 v[168:169], v177 offset:0
  v_add_u32 v24, 16384, v36
  v_add_u32 v25, 65536, v36
  v_add_u32 v26, 114688, v36
  v_mfma_f32_32x32x16_bf16 v[128:143], a[168:171], a[136:139], v[128:143]
  ds_read_b64_tr_b16 a[164:165], v11 offset:10240
  ds_read_b64_tr_b16 a[166:167], v11 offset:10752
  ds_read_b64_tr_b16 v[170:171], v178 offset:512
  buffer_load_dword a212, v73, s[8:11], s96 offen offset:384
  v_xor_b32 v36, 0, v35
  v_mfma_f32_32x32x16_bf16 v[128:143], a[172:175], a[140:143], v[128:143]
  s_waitcnt lgkmcnt(6)
  ds_read_b64_tr_b16 a[168:169], v11 offset:12288
  ds_read_b64_tr_b16 a[170:171], v11 offset:12800
  ds_read_b64_tr_b16 v[172:173], v177 offset:4096
  v_lshl_add_u32 v36, v36, 5, v38
  v_add_u32 v27, 16384, v36
  v_add_u32 v28, 65536, v36
  v_mfma_f32_32x32x16_bf16 v[144:159], a[144:147], a[0:3], 0
  ds_read_b64_tr_b16 a[172:173], v11 offset:14336
  ds_read_b64_tr_b16 a[174:175], v11 offset:14848
  ds_read_b64_tr_b16 v[174:175], v178 offset:4608
  v_xor_b32 v36, 1, v35
  v_lshl_add_u32 v36, v36, 5, v38
  v_add_u32 v29, 16384, v36
  v_mfma_f32_32x32x16_bf16 v[144:159], a[148:151], a[4:7], v[144:159]
  s_add_u32 s88, s87, 0
  ds_read_b64_tr_b16 a[144:145], v11 offset:16384
  ds_read_b64_tr_b16 a[146:147], v11 offset:16896
  s_waitcnt lgkmcnt(11)
  buffer_store_dwordx2 v[168:169], v176, s[16:19], s88 offen sc1
  v_add_u32 v30, 65536, v36
  v_add_u32 v31, 114688, v2
  v_add_u32 v32, 65536, v2
  s_and_b32 s94, s29, 7
  s_lshl_b32 s94, s94, 2
  s_add_u32 s94, s94, s28
  s_mul_i32 s94, s94, 10368
  s_lshl_b32 s95, s32, 9
  s_add_u32 s94, s94, s95
  v_min_u32 v33, 44, v1
  v_add_u32 v33, 0, v33
  v_mul_u32_u24 v74, 57, v33
  v_lshrrev_b32 v74, 9, v74
  v_mul_u32_u24 v72, 9, v74
  v_sub_u32 v33, v33, v72
  v_mul_u32_u24 v33, 1152, v33
  v_add_u32 v74, s32, v74
  v_cmp_ne_u32 vcc, 5, v74
  s_nop 1
  v_cndmask_b32 v74, 0, v74, vcc
  v_lshl_add_u32 v33, v74, 7, v33
  v_add_u32 v33, s94, v33
  s_nop 0
  v_readlane_b32 s95, v33, 17
  s_nop 1
  v_mov_b32 v77, s95
  v_cmp_gt_u32 vcc, 18, v1
  s_nop 1
  v_cndmask_b32 v78, v33, v77, vcc
  v_cndmask_b32 v77, v77, v33, vcc
  v_mfma_f32_32x32x16_bf16 v[144:159], a[152:155], a[8:11], v[144:159]
  s_xor_b32 s97, s30, 0
  s_mul_i32 s97, s97, 331776
  ds_read_b64_tr_b16 a[148:149], v11 offset:18432
  ds_read_b64_tr_b16 a[150:151], v11 offset:18944
  buffer_load_dword a218, v77, s[12:15], s97 offen
  v_mfma_f32_32x32x16_bf16 v[144:159], a[156:159], a[12:15], v[144:159]
  s_waitcnt lgkmcnt(5)
  ds_read_b64_tr_b16 a[152:153], v11 offset:20480
  ds_read_b64_tr_b16 a[154:155], v11 offset:20992
  v_exp_f32 v34, v128
  v_exp_f32 v35, v129
  v_mfma_f32_32x32x16_bf16 v[144:159], a[160:163], a[16:19], v[144:159]
  s_add_u32 s88, s87, 8192
  ds_read_b64_tr_b16 a[156:157], v11 offset:22528
  ds_read_b64_tr_b16 a[158:159], v11 offset:23040
  buffer_store_dwordx2 v[170:171], v176, s[16:19], s88 offen sc1
  v_exp_f32 v36, v130
  v_mfma_f32_32x32x16_bf16 v[144:159], a[164:167], a[20:23], v[144:159]
  ds_read_b64_tr_b16 a[160:161], v11 offset:24576
  ds_read_b64_tr_b16 a[162:163], v11 offset:25088
  v_add_f32 v34, 1.0, v34
  v_add_f32 v35, 1.0, v35
  v_mfma_f32_32x32x16_bf16 v[144:159], a[168:171], a[24:27], v[144:159]
  s_add_u32 s88, s87, 65536
  ds_read_b64_tr_b16 a[164:165], v11 offset:26624
  ds_read_b64_tr_b16 a[166:167], v11 offset:27136
  buffer_store_dwordx2 v[172:173], v176, s[16:19], s88 offen sc1
  v_exp_f32 v37, v131
  v_mfma_f32_32x32x16_bf16 v[144:159], a[172:175], a[28:31], v[144:159]
  s_waitcnt lgkmcnt(4)
  ds_read_b64_tr_b16 a[168:169], v11 offset:28672
  ds_read_b64_tr_b16 a[170:171], v11 offset:29184
  v_rcp_f32 v34, v34
  v_rcp_f32 v35, v35
  v_mfma_f32_32x32x16_bf16 v[144:159], a[144:147], a[32:35], v[144:159]
  s_add_u32 s88, s87, 73728
  ds_read_b64_tr_b16 a[172:173], v11 offset:30720
  ds_read_b64_tr_b16 a[174:175], v11 offset:31232
  buffer_store_dwordx2 v[174:175], v176, s[16:19], s88 offen sc1
  v_exp_f32 v38, v132
  v_mfma_f32_32x32x16_bf16 v[144:159], a[148:151], a[36:39], v[144:159]
  ds_read_b64_tr_b16 a[144:145], v11 offset:32768
  ds_read_b64_tr_b16 a[146:147], v11 offset:33280
  v_add_f32 v36, 1.0, v36
  v_add_f32 v37, 1.0, v37
  v_mfma_f32_32x32x16_bf16 v[144:159], a[152:155], a[40:43], v[144:159]
  ds_read_b64_tr_b16 a[148:149], v11 offset:34816
  ds_read_b64_tr_b16 a[150:151], v11 offset:35328
  v_exp_f32 v39, v133
  v_mul_f32 v128, v128, v34
  v_mul_f32 v129, v129, v35
  v_mfma_f32_32x32x16_bf16 v[144:159], a[156:159], a[44:47], v[144:159]
  s_waitcnt lgkmcnt(4)
  ds_read_b64_tr_b16 a[152:153], v11 offset:36864
  ds_read_b64_tr_b16 a[154:155], v11 offset:37376
  v_rcp_f32 v36, v36
  v_rcp_f32 v37, v37
  v_mfma_f32_32x32x16_bf16 v[144:159], a[160:163], a[48:51], v[144:159]
  ds_read_b64_tr_b16 a[156:157], v11 offset:38912
  ds_read_b64_tr_b16 a[158:159], v11 offset:39424
  v_exp_f32 v34, v134
  v_add_f32 v38, 1.0, v38
  v_add_f32 v39, 1.0, v39
  s_lshr_b32 s92, 0x1100, s30
  s_bitcmp1_b32 s92, 0
  s_cbranch_scc0 L_t1c
  s_cmp_eq_u32 s30, 8
  s_cselect_b32 s98, 8, 17
  ds_read_b64_tr_b16 v[160:161], v177 offset:8192
  ds_read_b64_tr_b16 v[162:163], v178 offset:8704
  ds_read_b64_tr_b16 v[164:165], v177 offset:12288
  ds_read_b64_tr_b16 v[166:167], v178 offset:12800
  s_lshl_b32 s87, s98, 17
  s_lshl_b32 s88, s29, 7
  s_add_u32 s87, s87, s88
  s_add_u32 s87, s87, 2097152
  s_add_u32 s88, s87, 0
  s_waitcnt lgkmcnt(3)
  buffer_store_dwordx2 v[160:161], v176, s[16:19], s88 offen sc1
  s_add_u32 s88, s87, 8192
  s_waitcnt lgkmcnt(2)
  buffer_store_dwordx2 v[162:163], v176, s[16:19], s88 offen sc1
  s_add_u32 s88, s87, 65536
  s_waitcnt lgkmcnt(1)
  buffer_store_dwordx2 v[164:165], v176, s[16:19], s88 offen sc1
  s_add_u32 s88, s87, 73728
  s_waitcnt lgkmcnt(0)
  buffer_store_dwordx2 v[166:167], v176, s[16:19], s88 offen sc1
L_t1c:
  v_mfma_f32_32x32x16_bf16 v[144:159], a[164:167], a[52:55], v[144:159]
  ds_read_b64_tr_b16 a[160:161], v11 offset:40960
  ds_read_b64_tr_b16 a[162:163], v11 offset:41472
  v_exp_f32 v35, v135
  v_mul_f32 v130, v130, v36
  v_mul_f32 v131, v131, v37
  v_mfma_f32_32x32x16_bf16 v[144:159], a[168:171], a[56:59], v[144:159]
  ds_read_b64_tr_b16 a[164:165], v11 offset:43008
  ds_read_b64_tr_b16 a[166:167], v11 offset:43520
  v_rcp_f32 v38, v38
  v_rcp_f32 v39, v39
  v_mfma_f32_32x32x16_bf16 v[144:159], a[172:175], a[60:63], v[144:159]
  s_waitcnt lgkmcnt(4)
  ds_read_b64_tr_b16 a[168:169], v11 offset:45056
  ds_read_b64_tr_b16 a[170:171], v11 offset:45568
  v_exp_f32 v36, v136
  v_add_f32 v34, 1.0, v34
  v_add_f32 v35, 1.0, v35
  v_mfma_f32_32x32x16_bf16 v[144:159], a[144:147], a[64:67], v[144:159]
  ds_read_b64_tr_b16 a[172:173], v11 offset:47104
  ds_read_b64_tr_b16 a[174:175], v11 offset:47616
  v_exp_f32 v37, v137
  v_mul_f32 v132, v132, v38
  v_mul_f32 v133, v133, v39
  v_mfma_f32_32x32x16_bf16 v[144:159], a[148:151], a[68:71], v[144:159]
  ds_read_b64_tr_b16 a[144:145], v12 offset:0
  ds_read_b64_tr_b16 a[146:147], v12 offset:512
  v_cvt_pk_bf16_f32 v40, v128, v129
  v_cvt_pk_bf16_f32 v41, v130, v131
  v_cvt_pk_bf16_f32 v42, v132, v133
  v_mfma_f32_32x32x16_bf16 v[144:159], a[152:155], a[72:75], v[144:159]
  ds_read_b64_tr_b16 a[148:149], v12 offset:2048
  ds_read_b64_tr_b16 a[150:151], v12 offset:2560
  v_rcp_f32 v34, v34
  v_rcp_f32 v35, v35
  v_mfma_f32_32x32x16_bf16 v[144:159], a[156:159], a[76:79], v[144:159]
  s_waitcnt lgkmcnt(4)
  ds_read_b64_tr_b16 a[152:153], v12 offset:4096
  ds_read_b64_tr_b16 a[154:155], v12 offset:4608
  v_exp_f32 v38, v138
  v_add_f32 v36, 1.0, v36
  v_add_f32 v37, 1.0, v37
  v_mfma_f32_32x32x16_bf16 v[144:159], a[160:163], a[80:83], v[144:159]
  ds_read_b64_tr_b16 a[156:157], v12 offset:6144
  ds_read_b64_tr_b16 a[158:159], v12 offset:6656
  v_exp_f32 v39, v139
  v_mul_f32 v134, v134, v34
  v_mul_f32 v135, v135, v35
  v_mfma_f32_32x32x16_bf16 v[144:159], a[164:167], a[84:87], v[144:159]
  ds_read_b64_tr_b16 a[160:161], v12 offset:8192
  ds_read_b64_tr_b16 a[162:163], v12 offset:8704
  v_rcp_f32 v36, v36
  v_rcp_f32 v37, v37
  v_mfma_f32_32x32x16_bf16 v[144:159], a[168:171], a[88:91], v[144:159]
  ds_read_b64_tr_b16 a[164:165], v12 offset:10240
  ds_read_b64_tr_b16 a[166:167], v12 offset:10752
  v_exp_f32 v34, v140
  v_add_f32 v38, 1.0, v38
  v_add_f32 v39, 1.0, v39
  v_mfma_f32_32x32x16_bf16 v[144:159], a[172:175], a[92:95], v[144:159]
  s_waitcnt lgkmcnt(4)
  ds_read_b64_tr_b16 a[168:169], v12 offset:12288
  ds_read_b64_tr_b16 a[170:171], v12 offset:12800
  v_exp_f32 v35, v141
  v_mul_f32 v136, v136, v36
  v_mul_f32 v137, v137, v37
  v_mfma_f32_32x32x16_bf16 v[144:159], a[144:147], a[96:99], v[144:159]
  s_waitcnt vmcnt(14)
  s_barrier
  ds_read_b64_tr_b16 a[172:173], v12 offset:14336
  ds_read_b64_tr_b16 a[174:175], v12 offset:14848
  v_rcp_f32 v38, v38
  v_rcp_f32 v39, v39
  v_mfma_f32_32x32x16_bf16 v[144:159], a[148:151], a[100:103], v[144:159]
  s_add_u32 m0, s36, 16128
  ds_read_b64_tr_b16 a[144:145], v12 offset:16384
  ds_read_b64_tr_b16 a[146:147], v12 offset:16896
  buffer_load_dwordx4 v4, s[8:11], s40 offen offset:256 lds
  v_cvt_pk_bf16_f32 v43, v134, v135
  v_cvt_pk_bf16_f32 v44, v136, v137
  v_mfma_f32_32x32x16_bf16 v[144:159], a[152:155], a[104:107], v[144:159]
  s_waitcnt lgkmcnt(4)
  ds_read_b64_tr_b16 a[148:149], v12 offset:18432
  ds_read_b64_tr_b16 a[150:151], v12 offset:18944
  v_exp_f32 v36, v142
  v_add_f32 v34, 1.0, v34
  v_add_f32 v35, 1.0, v35
  v_mfma_f32_32x32x16_bf16 v[144:159], a[156:159], a[108:111], v[144:159]
  s_add_u32 m0, s36, 20224
  ds_read_b64_tr_b16 a[152:153], v12 offset:20480
  ds_read_b64_tr_b16 a[154:155], v12 offset:20992
  buffer_load_dwordx4 v4, s[8:11], s41 offen offset:256 lds
  v_exp_f32 v37, v143
  v_mfma_f32_32x32x16_bf16 v[144:159], a[160:163], a[112:115], v[144:159]
  ds_read_b64_tr_b16 a[156:157], v12 offset:22528
  ds_read_b64_tr_b16 a[158:159], v12 offset:23040
  v_mul_f32 v138, v138, v38
  v_mul_f32 v139, v139, v39
  v_mfma_f32_32x32x16_bf16 v[144:159], a[164:167], a[116:119], v[144:159]
  s_add_u32 m0, s36, 24320
  ds_read_b64_tr_b16 a[160:161], v9 offset:24576
  ds_read_b64_tr_b16 a[162:163], v9 offset:25088
  buffer_load_dwordx4 v4, s[8:11], s42 offen offset:256 lds
  v_rcp_f32 v34, v34
  v_mfma_f32_32x32x16_bf16 v[144:159], a[168:171], a[120:123], v[144:159]
  s_waitcnt lgkmcnt(4)
  ds_read_b64_tr_b16 a[164:165], v9 offset:26624
  ds_read_b64_tr_b16 a[166:167], v9 offset:27136
  v_rcp_f32 v35, v35
  v_add_f32 v36, 1.0, v36
  v_add_f32 v37, 1.0, v37
  v_mfma_f32_32x32x16_bf16 v[144:159], a[172:175], a[124:127], v[144:159]
  s_add_u32 m0, s36, 28416
  ds_read_b64_tr_b16 a[168:169], v9 offset:28672
  ds_read_b64_tr_b16 a[170:171], v9 offset:29184
  buffer_load_dwordx4 v4, s[8:11], s43 offen offset:256 lds
  v_mul_f32 v140, v140, v34
  v_mul_f32 v141, v141, v35
  v_mfma_f32_32x32x16_bf16 v[144:159], a[144:147], a[128:131], v[144:159]
  ds_read_b64_tr_b16 a[172:173], v9 offset:30720
  ds_read_b64_tr_b16 a[174:175], v9 offset:31232
  v_rcp_f32 v36, v36
  v_rcp_f32 v37, v37
  v_mfma_f32_32x32x16_bf16 v[144:159], a[148:151], a[132:135], v[144:159]
  s_add_u32 m0, s36, 32512
  ds_read_b64_tr_b16 a[144:145], v9 offset:32768
  ds_read_b64_tr_b16 a[146:147], v9 offset:33280
  buffer_load_dwordx4 v4, s[8:11], s44 offen offset:256 lds
  v_cvt_pk_bf16_f32 v45, v138, v139
  v_cvt_pk_bf16_f32 v46, v140, v141
  v_mfma_f32_32x32x16_bf16 v[144:159], a[152:155], a[136:139], v[144:159]
  s_waitcnt lgkmcnt(4)
  ds_read_b64_tr_b16 a[148:149], v9 offset:34816
  ds_read_b64_tr_b16 a[150:151], v9 offset:35328
  v_mul_f32 v142, v142, v36
  v_mul_f32 v143, v143, v37
  v_mfma_f32_32x32x16_bf16 v[144:159], a[156:159], a[140:143], v[144:159]
  ds_read_b64_tr_b16 a[152:153], v9 offset:36864
  ds_read_b64_tr_b16 a[154:155], v9 offset:37376
  v_cvt_pk_bf16_f32 v47, v142, v143
  v_mfma_f32_32x32x16_bf16 v[112:127], a[160:163], a[0:3], 0
  s_add_u32 m0, s36, 36608
  ds_read_b64_tr_b16 a[156:157], v9 offset:38912
  ds_read_b64_tr_b16 a[158:159], v9 offset:39424
  buffer_load_dwordx4 v4, s[8:11], s45 offen offset:256 lds
  v_permlane16_swap_b32 v40, v44
  v_permlane16_swap_b32 v41, v45
  v_mfma_f32_32x32x16_bf16 v[112:127], a[164:167], a[4:7], v[112:127]
  s_waitcnt lgkmcnt(4)
  ds_read_b64_tr_b16 a[160:161], v9 offset:40960
  ds_read_b64_tr_b16 a[162:163], v9 offset:41472
  v_permlane16_swap_b32 v42, v46
  v_permlane16_swap_b32 v43, v47
  v_mfma_f32_32x32x16_bf16 v[112:127], a[168:171], a[8:11], v[112:127]
  s_add_u32 m0, s36, 40704
  ds_read_b64_tr_b16 a[164:165], v9 offset:43008
  ds_read_b64_tr_b16 a[166:167], v9 offset:43520
  buffer_load_dwordx4 v4, s[8:11], s46 offen offset:256 lds
  v_mfma_f32_32x32x16_bf16 v[112:127], a[172:175], a[12:15], v[112:127]
  ds_read_b64_tr_b16 a[168:169], v9 offset:45056
  ds_read_b64_tr_b16 a[170:171], v9 offset:45568
  v_exp_f32 v38, v144
  v_exp_f32 v39, v145
  v_mfma_f32_32x32x16_bf16 v[112:127], a[144:147], a[16:19], v[112:127]
  s_add_u32 m0, s36, 44800
  ds_read_b64_tr_b16 a[172:173], v9 offset:47104
  ds_read_b64_tr_b16 a[174:175], v9 offset:47616
  buffer_load_dwordx4 v4, s[8:11], s47 offen offset:256 lds
  v_exp_f32 v34, v146
  v_mfma_f32_32x32x16_bf16 v[112:127], a[148:151], a[20:23], v[112:127]
  s_waitcnt lgkmcnt(4)
  s_waitcnt vmcnt(8)
  s_barrier
  ds_read_b64_tr_b16 a[144:145], v10 offset:0
  ds_read_b64_tr_b16 a[146:147], v10 offset:512
  v_add_f32 v38, 1.0, v38
  v_add_f32 v39, 1.0, v39
  s_lshl_b32 s93, s30, 5
  s_add_u32 s93, s93, s29
  s_lshl_b32 s93, s93, 2
  s_add_u32 s93, s93, 4096
  s_cmp_eq_u32 s28, 0
  s_cselect_b32 s93, s93, 1073741824
  v_mov_b32 v0, s34
  buffer_store_dword v0, off, s[16:19], s93 sc1
  v_mfma_f32_32x32x16_bf16 v[112:127], a[152:155], a[24:27], v[112:127]
  s_add_u32 m0, s36, 48896
  ds_read_b64_tr_b16 a[148:149], v10 offset:2048
  ds_read_b64_tr_b16 a[150:151], v10 offset:2560
  buffer_load_dwordx4 v4, s[8:11], s48 offen offset:256 lds
  v_exp_f32 v35, v147
  v_mfma_f32_32x32x16_bf16 v[112:127], a[156:159], a[28:31], v[112:127]
  s_xor_b32 s94, s30, 0
  ds_read_b64_tr_b16 a[152:153], v10 offset:4096
  ds_read_b64_tr_b16 a[154:155], v10 offset:4608
  v_rcp_f32 v38, v38
  v_rcp_f32 v39, v39
  v_mfma_f32_32x32x16_bf16 v[112:127], a[160:163], a[32:35], v[112:127]
  s_and_b32 s95, s94, 1
  ds_read_b64_tr_b16 a[156:157], v10 offset:6144
  ds_read_b64_tr_b16 a[158:159], v10 offset:6656
  v_exp_f32 v36, v148
  v_add_f32 v34, 1.0, v34
  v_add_f32 v35, 1.0, v35
  v_mfma_f32_32x32x16_bf16 v[112:127], a[164:167], a[36:39], v[112:127]
  s_waitcnt lgkmcnt(4)
  ds_read_b64_tr_b16 a[160:161], v10 offset:8192
  ds_read_b64_tr_b16 a[162:163], v10 offset:8704
  v_exp_f32 v37, v149
  v_mul_f32 v144, v144, v38
  v_mul_f32 v145, v145, v39
  v_mfma_f32_32x32x16_bf16 v[112:127], a[168:171], a[40:43], v[112:127]
  s_add_u32 m0, s36, 52992
  ds_read_b64_tr_b16 a[164:165], v10 offset:10240
  ds_read_b64_tr_b16 a[166:167], v10 offset:10752
  buffer_load_dwordx4 v4, s[8:11], s49 offen offset:256 lds
  v_rcp_f32 v34, v34
  v_mfma_f32_32x32x16_bf16 v[112:127], a[172:175], a[44:47], v[112:127]
  s_mul_i32 s94, s94, 288
  ds_read_b64_tr_b16 a[168:169], v10 offset:12288
  ds_read_b64_tr_b16 a[170:171], v10 offset:12800
  v_rcp_f32 v35, v35
  v_exp_f32 v38, v150
  v_mfma_f32_32x32x16_bf16 v[112:127], a[144:147], a[48:51], v[112:127]
  s_add_u32 m0, s36, 57088
  ds_read_b64_tr_b16 a[172:173], v10 offset:14336
  ds_read_b64_tr_b16 a[174:175], v10 offset:14848
  buffer_load_dwordx4 v4, s[8:11], s50 offen offset:256 lds
  v_add_f32 v36, 1.0, v36
  v_add_f32 v37, 1.0, v37
  v_mfma_f32_32x32x16_bf16 v[112:127], a[148:151], a[52:55], v[112:127]
  s_waitcnt lgkmcnt(4)
  ds_read_b64_tr_b16 a[144:145], v10 offset:16384
  ds_read_b64_tr_b16 a[146:147], v10 offset:16896
  v_exp_f32 v39, v151
  v_mul_f32 v146, v146, v34
  v_mul_f32 v147, v147, v35
  v_mfma_f32_32x32x16_bf16 v[112:127], a[152:155], a[56:59], v[112:127]
  s_add_u32 m0, s36, 61184
  ds_read_b64_tr_b16 a[148:149], v10 offset:18432
  ds_read_b64_tr_b16 a[150:151], v10 offset:18944
  buffer_load_dwordx4 v4, s[8:11], s51 offen offset:256 lds
  v_cvt_pk_bf16_f32 v48, v144, v145
  v_cvt_pk_bf16_f32 v49, v146, v147
  v_mfma_f32_32x32x16_bf16 v[112:127], a[156:159], a[60:63], v[112:127]
  s_lshl_b32 s99, s95, 5
  ds_read_b64_tr_b16 a[152:153], v10 offset:20480
  ds_read_b64_tr_b16 a[154:155], v10 offset:20992
  v_rcp_f32 v36, v36
  v_rcp_f32 v37, v37
  v_mfma_f32_32x32x16_bf16 v[112:127], a[160:163], a[64:67], v[112:127]
  s_add_u32 m0, s36, 65280
  ds_read_b64_tr_b16 a[156:157], v10 offset:22528
  ds_read_b64_tr_b16 a[158:159], v10 offset:23040
  buffer_load_dwordx4 v4, s[8:11], s52 offen offset:256 lds
  v_exp_f32 v34, v152
  v_mfma_f32_32x32x16_bf16 v[112:127], a[164:167], a[68:71], v[112:127]
  s_waitcnt lgkmcnt(4)
  ds_read_b64_tr_b16 a[160:161], v10 offset:24576
  ds_read_b64_tr_b16 a[162:163], v10 offset:25088
  v_add_f32 v38, 1.0, v38
  v_add_f32 v39, 1.0, v39
  v_mfma_f32_32x32x16_bf16 v[112:127], a[168:171], a[72:75], v[112:127]
  s_add_u32 m0, s36, 69376
  ds_read_b64_tr_b16 a[164:165], v10 offset:26624
  ds_read_b64_tr_b16 a[166:167], v10 offset:27136
  buffer_load_dwordx4 v4, s[8:11], s53 offen offset:256 lds
  v_exp_f32 v35, v153
  v_mfma_f32_32x32x16_bf16 v[112:127], a[172:175], a[76:79], v[112:127]
  s_add_u32 s99, s99, s94
  ds_read_b64_tr_b16 a[168:169], v10 offset:28672
  ds_read_b64_tr_b16 a[170:171], v10 offset:29184
  v_mul_f32 v148, v148, v36
  v_mul_f32 v149, v149, v37
  v_mfma_f32_32x32x16_bf16 v[112:127], a[144:147], a[80:83], v[112:127]
  s_waitcnt lgkmcnt(4)
  ds_read_b64_tr_b16 a[172:173], v10 offset:30720
  ds_read_b64_tr_b16 a[174:175], v10 offset:31232
  v_rcp_f32 v38, v38
  v_rcp_f32 v39, v39
  v_mfma_f32_32x32x16_bf16 v[112:127], a[148:151], a[84:87], v[112:127]
  s_add_u32 m0, s36, 73472
  ds_read_b64_tr_b16 a[144:145], v10 offset:32768
  ds_read_b64_tr_b16 a[146:147], v10 offset:33280
  buffer_load_dwordx4 v4, s[8:11], s54 offen offset:256 lds
  v_exp_f32 v36, v154
  v_mfma_f32_32x32x16_bf16 v[112:127], a[152:155], a[88:91], v[112:127]
  s_mul_i32 s99, s99, 1152
  ds_read_b64_tr_b16 a[148:149], v10 offset:34816
  ds_read_b64_tr_b16 a[150:151], v10 offset:35328
  v_add_f32 v34, 1.0, v34
  v_add_f32 v35, 1.0, v35
  v_cvt_pk_bf16_f32 v50, v148, v149
  v_mfma_f32_32x32x16_bf16 v[112:127], a[156:159], a[92:95], v[112:127]
  s_add_u32 m0, s36, 77568
  ds_read_b64_tr_b16 a[152:153], v10 offset:36864
  ds_read_b64_tr_b16 a[154:155], v10 offset:37376
  buffer_load_dwordx4 v4, s[8:11], s55 offen offset:256 lds
  v_exp_f32 v37, v155
  v_mfma_f32_32x32x16_bf16 v[112:127], a[160:163], a[96:99], v[112:127]
  s_waitcnt lgkmcnt(4)
  ds_read_b64_tr_b16 a[156:157], v10 offset:38912
  ds_read_b64_tr_b16 a[158:159], v10 offset:39424
  v_mul_f32 v150, v150, v38
  v_mul_f32 v151, v151, v39
  v_mfma_f32_32x32x16_bf16 v[112:127], a[164:167], a[100:103], v[112:127]
  s_add_u32 m0, s36, 81664
  ds_read_b64_tr_b16 a[160:161], v10 offset:40960
  ds_read_b64_tr_b16 a[162:163], v10 offset:41472
  buffer_load_dwordx4 v4, s[8:11], s56 offen offset:256 lds
  v_rcp_f32 v34, v34
  v_mfma_f32_32x32x16_bf16 v[112:127], a[168:171], a[104:107], v[112:127]
  s_add_u32 s58, s99, 0
  ds_read_b64_tr_b16 a[164:165], v10 offset:43008
  ds_read_b64_tr_b16 a[166:167], v10 offset:43520
  v_rcp_f32 v35, v35
  v_exp_f32 v38, v156
  v_mfma_f32_32x32x16_bf16 v[112:127], a[172:175], a[108:111], v[112:127]
  s_add_u32 m0, s36, 85760
  ds_read_b64_tr_b16 a[168:169], v10 offset:45056
  ds_read_b64_tr_b16 a[170:171], v10 offset:45568
  buffer_load_dwordx4 v4, s[8:11], s57 offen offset:256 lds
  v_add_f32 v36, 1.0, v36
  v_add_f32 v37, 1.0, v37
  v_mfma_f32_32x32x16_bf16 v[112:127], a[144:147], a[112:115], v[112:127]
  s_waitcnt lgkmcnt(4)
  ds_read_b64_tr_b16 a[172:173], v10 offset:47104
  ds_read_b64_tr_b16 a[174:175], v10 offset:47616
  v_exp_f32 v39, v157
  v_mul_f32 v152, v152, v34
  v_mul_f32 v153, v153, v35
  v_mfma_f32_32x32x16_bf16 v[112:127], a[148:151], a[116:119], v[112:127]
  s_add_u32 s59, s99, 36864
  ds_read_b64_tr_b16 a[144:145], v12 offset:24576
  ds_read_b64_tr_b16 a[146:147], v12 offset:25088
  v_rcp_f32 v36, v36
  v_rcp_f32 v37, v37
  v_mfma_f32_32x32x16_bf16 v[112:127], a[152:155], a[120:123], v[112:127]
  s_add_u32 s60, s99, 73728
  ds_read_b64_tr_b16 a[148:149], v12 offset:26624
  ds_read_b64_tr_b16 a[150:151], v12 offset:27136
  v_exp_f32 v34, v158
  v_add_f32 v38, 1.0, v38
  v_add_f32 v39, 1.0, v39
  v_mfma_f32_32x32x16_bf16 v[112:127], a[156:159], a[124:127], v[112:127]
  s_lshl_b32 s96, s32, 9
  s_sub_u32 s96, 512, s96
  ds_read_b64_tr_b16 a[152:153], v12 offset:28672
  ds_read_b64_tr_b16 a[154:155], v12 offset:29184
  buffer_load_dword a213, v73, s[8:11], s96 offen
  v_cvt_pk_bf16_f32 v51, v150, v151
  v_cvt_pk_bf16_f32 v52, v152, v153
  v_mfma_f32_32x32x16_bf16 v[112:127], a[160:163], a[128:131], v[112:127]
  s_waitcnt lgkmcnt(4)
  ds_read_b64_tr_b16 a[156:157], v12 offset:30720
  ds_read_b64_tr_b16 a[158:159], v12 offset:31232
  v_exp_f32 v35, v159
  v_mul_f32 v154, v154, v36
  v_mul_f32 v155, v155, v37
  v_mfma_f32_32x32x16_bf16 v[112:127], a[164:167], a[132:135], v[112:127]
  s_xor_b32 s97, s30, 0
  s_mul_i32 s97, s97, 331776
  ds_read_b64_tr_b16 a[160:161], v12 offset:32768
  ds_read_b64_tr_b16 a[162:163], v12 offset:33280
  buffer_load_dword a219, v78, s[12:15], s97 offen
  v_rcp_f32 v38, v38
  v_mfma_f32_32x32x16_bf16 v[112:127], a[168:171], a[136:139], v[112:127]
  s_add_u32 s61, s99, 110592
  ds_read_b64_tr_b16 a[164:165], v12 offset:34816
  ds_read_b64_tr_b16 a[166:167], v12 offset:35328
  v_rcp_f32 v39, v39
  v_add_f32 v34, 1.0, v34
  v_add_f32 v35, 1.0, v35
  v_mfma_f32_32x32x16_bf16 v[112:127], a[172:175], a[140:143], v[112:127]
  s_add_u32 s97, s80, 0
  ds_read_b64_tr_b16 a[168:169], v12 offset:36864
  ds_read_b64_tr_b16 a[170:171], v12 offset:37376
  buffer_store_dwordx4 v[40:43], v2, s[16:19], s97 offen sc1
  v_mfma_f32_32x32x16_bf16 v[128:143], a[144:147], a[0:3], 0
  s_waitcnt lgkmcnt(4)
  ds_read_b64_tr_b16 a[172:173], v12 offset:38912
  ds_read_b64_tr_b16 a[174:175], v12 offset:39424
  v_mul_f32 v156, v156, v38
  v_mul_f32 v157, v157, v39
  v_cvt_pk_bf16_f32 v53, v154, v155
  v_mfma_f32_32x32x16_bf16 v[128:143], a[148:151], a[4:7], v[128:143]
  s_add_u32 s97, s80, 1024
  ds_read_b64_tr_b16 a[144:145], v12 offset:40960
  ds_read_b64_tr_b16 a[146:147], v12 offset:41472
  buffer_store_dwordx4 v[44:47], v2, s[16:19], s97 offen sc1
  v_mfma_f32_32x32x16_bf16 v[128:143], a[152:155], a[8:11], v[128:143]
  s_add_u32 s62, s99, 147456
  ds_read_b64_tr_b16 a[148:149], v12 offset:43008
  ds_read_b64_tr_b16 a[150:151], v12 offset:43520
  v_rcp_f32 v34, v34
  v_rcp_f32 v35, v35
  v_mfma_f32_32x32x16_bf16 v[128:143], a[156:159], a[12:15], v[128:143]
  s_add_u32 s63, s99, 184320
  ds_read_b64_tr_b16 a[152:153], v12 offset:45056
  ds_read_b64_tr_b16 a[154:155], v12 offset:45568
  v_exp_f32 v36, v112
  v_exp_f32 v37, v113
  v_mfma_f32_32x32x16_bf16 v[128:143], a[160:163], a[16:19], v[128:143]
  s_waitcnt lgkmcnt(4)
  ds_read_b64_tr_b16 a[156:157], v12 offset:47104
  ds_read_b64_tr_b16 a[158:159], v12 offset:47616
  v_mul_f32 v158, v158, v34
  v_mul_f32 v159, v159, v35
  v_cvt_pk_bf16_f32 v54, v156, v157
  v_mfma_f32_32x32x16_bf16 v[128:143], a[164:167], a[20:23], v[128:143]
  s_add_u32 s64, s99, 221184
  ds_read_b64_tr_b16 a[160:161], v13 offset:0
  ds_read_b64_tr_b16 a[162:163], v13 offset:512
  v_exp_f32 v38, v114
  v_add_f32 v36, 1.0, v36
  v_add_f32 v37, 1.0, v37
  v_mfma_f32_32x32x16_bf16 v[128:143], a[168:171], a[24:27], v[128:143]
  s_add_u32 s65, s99, 258048
  ds_read_b64_tr_b16 a[164:165], v13 offset:2048
  ds_read_b64_tr_b16 a[166:167], v13 offset:2560
  v_cvt_pk_bf16_f32 v55, v158, v159
  v_permlane16_swap_b32 v48, v52
  v_permlane16_swap_b32 v49, v53
  v_mfma_f32_32x32x16_bf16 v[128:143], a[172:175], a[28:31], v[128:143]
  s_lshl_b32 s95, s95, 8
  ds_read_b64_tr_b16 a[168:169], v13 offset:4096
  ds_read_b64_tr_b16 a[170:171], v13 offset:4608
  v_exp_f32 v39, v115
  v_rcp_f32 v36, v36
  v_mfma_f32_32x32x16_bf16 v[128:143], a[144:147], a[32:35], v[128:143]
  s_waitcnt lgkmcnt(4)
  ds_read_b64_tr_b16 a[172:173], v13 offset:6144
  ds_read_b64_tr_b16 a[174:175], v13 offset:6656
  v_rcp_f32 v37, v37
  v_exp_f32 v34, v116
  v_mfma_f32_32x32x16_bf16 v[128:143], a[148:151], a[36:39], v[128:143]
  s_sub_u32 s94, s94, s95
  ds_read_b64_tr_b16 a[144:145], v13 offset:8192
  ds_read_b64_tr_b16 a[146:147], v13 offset:8704
  v_add_f32 v38, 1.0, v38
  v_add_f32 v39, 1.0, v39
  v_permlane16_swap_b32 v50, v54
  v_mfma_f32_32x32x16_bf16 v[128:143], a[152:155], a[40:43], v[128:143]
  s_add_u32 s94, s94, 256
  ds_read_b64_tr_b16 a[148:149], v13 offset:10240
  ds_read_b64_tr_b16 a[150:151], v13 offset:10752
  v_exp_f32 v35, v117
  v_mul_f32 v112, v112, v36
  v_mul_f32 v113, v113, v37
  v_mfma_f32_32x32x16_bf16 v[128:143], a[156:159], a[44:47], v[128:143]
  s_mul_i32 s66, s94, 1152
  ds_read_b64_tr_b16 a[152:153], v13 offset:12288
  ds_read_b64_tr_b16 a[154:155], v13 offset:12800
  v_rcp_f32 v38, v38
  v_rcp_f32 v39, v39
  v_mfma_f32_32x32x16_bf16 v[128:143], a[160:163], a[48:51], v[128:143]
  s_waitcnt lgkmcnt(4)
  ds_read_b64_tr_b16 a[156:157], v13 offset:14336
  ds_read_b64_tr_b16 a[158:159], v13 offset:14848
  v_exp_f32 v36, v118
  v_add_f32 v34, 1.0, v34
  v_add_f32 v35, 1.0, v35
  v_mfma_f32_32x32x16_bf16 v[128:143], a[164:167], a[52:55], v[128:143]
  s_xor_b32 s94, s30, 1
  ds_read_b64_tr_b16 a[160:161], v13 offset:16384
  ds_read_b64_tr_b16 a[162:163], v13 offset:16896
  v_exp_f32 v37, v119
  v_mul_f32 v114, v114, v38
  v_mul_f32 v115, v115, v39
  v_mfma_f32_32x32x16_bf16 v[128:143], a[168:171], a[56:59], v[128:143]
  s_and_b32 s95, s94, 1
  ds_read_b64_tr_b16 a[164:165], v13 offset:18432
  ds_read_b64_tr_b16 a[166:167], v13 offset:18944
  v_permlane16_swap_b32 v51, v55
  v_cvt_pk_bf16_f32 v56, v112, v113
  v_cvt_pk_bf16_f32 v57, v114, v115
  v_mfma_f32_32x32x16_bf16 v[128:143], a[172:175], a[60:63], v[128:143]
  s_waitcnt lgkmcnt(4)
  ds_read_b64_tr_b16 a[168:169], v13 offset:20480
  ds_read_b64_tr_b16 a[170:171], v13 offset:20992
  v_rcp_f32 v34, v34
  v_rcp_f32 v35, v35
  v_mfma_f32_32x32x16_bf16 v[128:143], a[144:147], a[64:67], v[128:143]
  s_add_u32 s97, s80, 2048
  ds_read_b64_tr_b16 a[172:173], v13 offset:22528
  ds_read_b64_tr_b16 a[174:175], v13 offset:23040
  buffer_store_dwordx4 v[48:51], v2, s[16:19], s97 offen sc1
  v_mfma_f32_32x32x16_bf16 v[128:143], a[148:151], a[68:71], v[128:143]
  s_mul_i32 s94, s94, 288
  ds_read_b64_tr_b16 a[144:145], v13 offset:24576
  ds_read_b64_tr_b16 a[146:147], v13 offset:25088
  v_exp_f32 v38, v120
  v_add_f32 v36, 1.0, v36
  v_add_f32 v37, 1.0, v37
  v_mfma_f32_32x32x16_bf16 v[128:143], a[152:155], a[72:75], v[128:143]
  s_add_u32 s97, s80, 3072
  ds_read_b64_tr_b16 a[148:149], v13 offset:26624
  ds_read_b64_tr_b16 a[150:151], v13 offset:27136
  buffer_store_dwordx4 v[52:55], v2, s[16:19], s97 offen sc1
  v_mfma_f32_32x32x16_bf16 v[128:143], a[156:159], a[76:79], v[128:143]
  s_waitcnt lgkmcnt(4)
  ds_read_b64_tr_b16 a[152:153], v13 offset:28672
  ds_read_b64_tr_b16 a[154:155], v13 offset:29184
  v_exp_f32 v39, v121
  v_mul_f32 v116, v116, v34
  v_mul_f32 v117, v117, v35
  v_mfma_f32_32x32x16_bf16 v[128:143], a[160:163], a[80:83], v[128:143]
  s_lshl_b32 s99, s95, 5
  ds_read_b64_tr_b16 a[156:157], v13 offset:30720
  ds_read_b64_tr_b16 a[158:159], v13 offset:31232
  v_rcp_f32 v36, v36
  v_rcp_f32 v37, v37
  v_mfma_f32_32x32x16_bf16 v[128:143], a[164:167], a[84:87], v[128:143]
  s_add_u32 s99, s99, s94
  ds_read_b64_tr_b16 a[160:161], v13 offset:32768
  ds_read_b64_tr_b16 a[162:163], v13 offset:33280
  v_exp_f32 v34, v122
  v_add_f32 v38, 1.0, v38
  v_add_f32 v39, 1.0, v39
  v_mfma_f32_32x32x16_bf16 v[128:143], a[168:171], a[88:91], v[128:143]
  s_mul_i32 s99, s99, 1152
  ds_read_b64_tr_b16 a[164:165], v13 offset:34816
  ds_read_b64_tr_b16 a[166:167], v13 offset:35328
  v_exp_f32 v35, v123
  v_mul_f32 v118, v118, v36
  v_mul_f32 v119, v119, v37
  v_mfma_f32_32x32x16_bf16 v[128:143], a[172:175], a[92:95], v[128:143]
  s_waitcnt lgkmcnt(4)
  ds_read_b64_tr_b16 a[168:169], v13 offset:36864
  ds_read_b64_tr_b16 a[170:171], v13 offset:37376
  v_rcp_f32 v38, v38
  v_rcp_f32 v39, v39
  v_mfma_f32_32x32x16_bf16 v[128:143], a[144:147], a[96:99], v[128:143]
  s_waitcnt vmcnt(15)
  s_barrier
  ds_read_b64_tr_b16 a[172:173], v13 offset:38912
  ds_read_b64_tr_b16 a[174:175], v13 offset:39424
  v_exp_f32 v36, v124
  v_add_f32 v34, 1.0, v34
  v_add_f32 v35, 1.0, v35
  v_mfma_f32_32x32x16_bf16 v[128:143], a[148:151], a[100:103], v[128:143]
  s_add_u32 m0, s36, 89728
  ds_read_b64_tr_b16 a[144:145], v13 offset:40960
  ds_read_b64_tr_b16 a[146:147], v13 offset:41472
  buffer_load_dwordx4 v4, s[8:11], s40 offen offset:384 lds
  v_cvt_pk_bf16_f32 v58, v116, v117
  v_cvt_pk_bf16_f32 v59, v118, v119
  v_mfma_f32_32x32x16_bf16 v[128:143], a[152:155], a[104:107], v[128:143]
  s_waitcnt lgkmcnt(4)
  ds_read_b64_tr_b16 a[148:149], v13 offset:43008
  ds_read_b64_tr_b16 a[150:151], v13 offset:43520
  v_exp_f32 v37, v125
  v_mul_f32 v120, v120, v38
  v_mul_f32 v121, v121, v39
  v_mfma_f32_32x32x16_bf16 v[128:143], a[156:159], a[108:111], v[128:143]
  s_add_u32 m0, s36, 93824
  ds_read_b64_tr_b16 a[152:153], v13 offset:45056
  ds_read_b64_tr_b16 a[154:155], v13 offset:45568
  buffer_load_dwordx4 v4, s[8:11], s41 offen offset:384 lds
  v_rcp_f32 v34, v34
  v_mfma_f32_32x32x16_bf16 v[128:143], a[160:163], a[112:115], v[128:143]
  s_add_u32 s67, s99, 0
  ds_read_b64_tr_b16 a[156:157], v13 offset:47104
  ds_read_b64_tr_b16 a[158:159], v13 offset:47616
  v_rcp_f32 v35, v35
  v_exp_f32 v38, v126
  v_mfma_f32_32x32x16_bf16 v[128:143], a[164:167], a[116:119], v[128:143]
  s_add_u32 m0, s36, 97920
  ds_read_b64_tr_b16 a[160:161], v8 offset:0
  ds_read_b64_tr_b16 a[162:163], v8 offset:512
  buffer_load_dwordx4 v4, s[8:11], s42 offen offset:384 lds
  v_add_f32 v36, 1.0, v36
  v_add_f32 v37, 1.0, v37
  v_mfma_f32_32x32x16_bf16 v[128:143], a[168:171], a[120:123], v[128:143]
  s_waitcnt lgkmcnt(4)
  ds_read_b64_tr_b16 a[164:165], v8 offset:2048
  ds_read_b64_tr_b16 a[166:167], v8 offset:2560
  v_exp_f32 v39, v127
  v_mul_f32 v122, v122, v34
  v_mul_f32 v123, v123, v35
  v_mfma_f32_32x32x16_bf16 v[128:143], a[172:175], a[124:127], v[128:143]
  s_add_u32 m0, s36, 102016
  ds_read_b64_tr_b16 a[168:169], v8 offset:4096
  ds_read_b64_tr_b16 a[170:171], v8 offset:4608
  buffer_load_dwordx4 v4, s[8:11], s43 offen offset:384 lds
  v_cvt_pk_bf16_f32 v60, v120, v121
  v_cvt_pk_bf16_f32 v61, v122, v123
  v_mfma_f32_32x32x16_bf16 v[128:143], a[144:147], a[128:131], v[128:143]
  s_add_u32 s68, s99, 36864
  ds_read_b64_tr_b16 a[172:173], v8 offset:6144
  ds_read_b64_tr_b16 a[174:175], v8 offset:6656
  v_rcp_f32 v36, v36
  v_rcp_f32 v37, v37
  v_mfma_f32_32x32x16_bf16 v[128:143], a[148:151], a[132:135], v[128:143]
  s_add_u32 m0, s36, 106112
  ds_read_b64_tr_b16 a[144:145], v8 offset:8192
  ds_read_b64_tr_b16 a[146:147], v8 offset:8704
  buffer_load_dwordx4 v4, s[8:11], s44 offen offset:384 lds
  v_add_f32 v38, 1.0, v38
  v_add_f32 v39, 1.0, v39
  v_mfma_f32_32x32x16_bf16 v[128:143], a[152:155], a[136:139], v[128:143]
  s_waitcnt lgkmcnt(4)
  ds_read_b64_tr_b16 a[148:149], v8 offset:10240
  ds_read_b64_tr_b16 a[150:151], v8 offset:10752
  v_mul_f32 v124, v124, v36
  v_mul_f32 v125, v125, v37
  v_mfma_f32_32x32x16_bf16 v[128:143], a[156:159], a[140:143], v[128:143]
  s_add_u32 s69, s99, 73728
  ds_read_b64_tr_b16 a[152:153], v8 offset:12288
  ds_read_b64_tr_b16 a[154:155], v8 offset:12800
  v_rcp_f32 v38, v38
  v_rcp_f32 v39, v39
  v_mfma_f32_32x32x16_bf16 v[144:159], a[160:163], a[0:3], 0
  s_add_u32 m0, s36, 110208
  ds_read_b64_tr_b16 a[156:157], v8 offset:14336
  ds_read_b64_tr_b16 a[158:159], v8 offset:14848
  buffer_load_dwordx4 v4, s[8:11], s45 offen offset:384 lds
  v_mul_f32 v126, v126, v38
  v_mul_f32 v127, v127, v39
  v_mfma_f32_32x32x16_bf16 v[144:159], a[164:167], a[4:7], v[144:159]
  s_waitcnt lgkmcnt(4)
  ds_read_b64_tr_b16 a[160:161], v8 offset:16384
  ds_read_b64_tr_b16 a[162:163], v8 offset:16896
  v_cvt_pk_bf16_f32 v62, v124, v125
  v_cvt_pk_bf16_f32 v63, v126, v127
  v_mfma_f32_32x32x16_bf16 v[144:159], a[168:171], a[8:11], v[144:159]
  s_add_u32 m0, s36, 114304
  ds_read_b64_tr_b16 a[164:165], v8 offset:18432
  ds_read_b64_tr_b16 a[166:167], v8 offset:18944
  buffer_load_dwordx4 v4, s[8:11], s46 offen offset:384 lds
  v_permlane16_swap_b32 v56, v60
  v_permlane16_swap_b32 v57, v61
  v_mfma_f32_32x32x16_bf16 v[144:159], a[172:175], a[12:15], v[144:159]
  s_add_u32 s70, s99, 110592
  ds_read_b64_tr_b16 a[168:169], v8 offset:20480
  ds_read_b64_tr_b16 a[170:171], v8 offset:20992
  v_exp_f32 v34, v128
  v_exp_f32 v35, v129
  v_mfma_f32_32x32x16_bf16 v[144:159], a[144:147], a[16:19], v[144:159]
  s_add_u32 m0, s36, 118400
  ds_read_b64_tr_b16 a[172:173], v8 offset:22528
  ds_read_b64_tr_b16 a[174:175], v8 offset:23040
  buffer_load_dwordx4 v4, s[8:11], s47 offen offset:384 lds
  v_permlane16_swap_b32 v58, v62
  v_permlane16_swap_b32 v59, v63
  v_mfma_f32_32x32x16_bf16 v[144:159], a[148:151], a[20:23], v[144:159]
  s_waitcnt lgkmcnt(4)
  s_waitcnt vmcnt(14)
  s_barrier
  ds_read_b64_tr_b16 a[144:145], v8 offset:24576
  ds_read_b64_tr_b16 a[146:147], v8 offset:25088
  v_exp_f32 v36, v130
  v_add_f32 v34, 1.0, v34
  v_add_f32 v35, 1.0, v35
  v_mfma_f32_32x32x16_bf16 v[144:159], a[152:155], a[24:27], v[144:159]
  s_add_u32 m0, s36, 122496
  ds_read_b64_tr_b16 a[148:149], v8 offset:26624
  ds_read_b64_tr_b16 a[150:151], v8 offset:27136
  buffer_load_dwordx4 v4, s[8:11], s48 offen offset:384 lds
  v_exp_f32 v37, v131
  v_mfma_f32_32x32x16_bf16 v[144:159], a[156:159], a[28:31], v[144:159]
  s_add_u32 s71, s99, 147456
  ds_read_b64_tr_b16 a[152:153], v8 offset:28672
  ds_read_b64_tr_b16 a[154:155], v8 offset:29184
  v_rcp_f32 v34, v34
  v_rcp_f32 v35, v35
  v_mfma_f32_32x32x16_bf16 v[144:159], a[160:163], a[32:35], v[144:159]
  s_movk_i32 s93, 4096
  ds_read_b64_tr_b16 a[156:157], v8 offset:30720
  ds_read_b64_tr_b16 a[158:159], v8 offset:31232
  buffer_load_dword v180, v181, s[16:19], s93 offen sc1
  v_exp_f32 v38, v132
  v_mfma_f32_32x32x16_bf16 v[144:159], a[164:167], a[36:39], v[144:159]
  s_waitcnt lgkmcnt(4)
  ds_read_b64_tr_b16 a[160:161], v8 offset:32768
  ds_read_b64_tr_b16 a[162:163], v8 offset:33280
  v_add_f32 v36, 1.0, v36
  v_add_f32 v37, 1.0, v37
  v_mfma_f32_32x32x16_bf16 v[144:159], a[168:171], a[40:43], v[144:159]
  s_add_u32 m0, s36, 126592
  ds_read_b64_tr_b16 a[164:165], v8 offset:34816
  ds_read_b64_tr_b16 a[166:167], v8 offset:35328
  buffer_load_dwordx4 v4, s[8:11], s49 offen offset:384 lds
  v_exp_f32 v39, v133
  v_mfma_f32_32x32x16_bf16 v[144:159], a[172:175], a[44:47], v[144:159]
  s_add_u32 s72, s99, 184320
  ds_read_b64_tr_b16 a[168:169], v8 offset:36864
  ds_read_b64_tr_b16 a[170:171], v8 offset:37376
  v_mul_f32 v128, v128, v34
  v_mul_f32 v129, v129, v35
  v_mfma_f32_32x32x16_bf16 v[144:159], a[144:147], a[48:51], v[144:159]
  s_add_u32 m0, s36, 130688
  ds_read_b64_tr_b16 a[172:173], v8 offset:38912
  ds_read_b64_tr_b16 a[174:175], v8 offset:39424
  buffer_load_dwordx4 v4, s[8:11], s50 offen offset:384 lds
  v_rcp_f32 v36, v36
  v_mfma_f32_32x32x16_bf16 v[144:159], a[148:151], a[52:55], v[144:159]
  s_waitcnt lgkmcnt(4)
  ds_read_b64_tr_b16 a[144:145], v8 offset:40960
  ds_read_b64_tr_b16 a[146:147], v8 offset:41472
  v_rcp_f32 v37, v37
  v_exp_f32 v34, v134
  v_mfma_f32_32x32x16_bf16 v[144:159], a[152:155], a[56:59], v[144:159]
  s_add_u32 m0, s36, 134784
  ds_read_b64_tr_b16 a[148:149], v8 offset:43008
  ds_read_b64_tr_b16 a[150:151], v8 offset:43520
  buffer_load_dwordx4 v4, s[8:11], s51 offen offset:384 lds
  v_add_f32 v38, 1.0, v38
  v_add_f32 v39, 1.0, v39
  v_mfma_f32_32x32x16_bf16 v[144:159], a[156:159], a[60:63], v[144:159]
  s_add_u32 s73, s99, 221184
  ds_read_b64_tr_b16 a[152:153], v8 offset:45056
  ds_read_b64_tr_b16 a[154:155], v8 offset:45568
  v_exp_f32 v35, v135
  v_mul_f32 v130, v130, v36
  v_mul_f32 v131, v131, v37
  v_mfma_f32_32x32x16_bf16 v[144:159], a[160:163], a[64:67], v[144:159]
  s_add_u32 m0, s36, 138880
  ds_read_b64_tr_b16 a[156:157], v8 offset:47104
  ds_read_b64_tr_b16 a[158:159], v8 offset:47616
  buffer_load_dwordx4 v4, s[8:11], s52 offen offset:384 lds
  v_cvt_pk_bf16_f32 v64, v128, v129
  v_cvt_pk_bf16_f32 v65, v130, v131
  v_mfma_f32_32x32x16_bf16 v[144:159], a[164:167], a[68:71], v[144:159]
  s_waitcnt lgkmcnt(4)
  ds_read_b64_tr_b16 a[160:161], v9 offset:0
  ds_read_b64_tr_b16 a[162:163], v9 offset:512
  v_rcp_f32 v38, v38
  v_rcp_f32 v39, v39
  v_mfma_f32_32x32x16_bf16 v[144:159], a[168:171], a[72:75], v[144:159]
  s_add_u32 m0, s36, 142976
  ds_read_b64_tr_b16 a[164:165], v9 offset:2048
  ds_read_b64_tr_b16 a[166:167], v9 offset:2560
  buffer_load_dwordx4 v4, s[8:11], s53 offen offset:384 lds
  v_exp_f32 v36, v136
  v_mfma_f32_32x32x16_bf16 v[144:159], a[172:175], a[76:79], v[144:159]
  s_add_u32 s74, s99, 258048
  ds_read_b64_tr_b16 a[168:169], v9 offset:4096
  ds_read_b64_tr_b16 a[170:171], v9 offset:4608
  v_add_f32 v34, 1.0, v34
  v_add_f32 v35, 1.0, v35
  v_mfma_f32_32x32x16_bf16 v[144:159], a[144:147], a[80:83], v[144:159]
  s_waitcnt lgkmcnt(4)
  ds_read_b64_tr_b16 a[172:173], v9 offset:6144
  ds_read_b64_tr_b16 a[174:175], v9 offset:6656
  v_exp_f32 v37, v137
  v_mul_f32 v132, v132, v38
  v_mul_f32 v133, v133, v39
  v_mfma_f32_32x32x16_bf16 v[144:159], a[148:151], a[84:87], v[144:159]
  s_add_u32 m0, s36, 147072
  ds_read_b64_tr_b16 a[144:145], v9 offset:8192
  ds_read_b64_tr_b16 a[146:147], v9 offset:8704
  buffer_load_dwordx4 v4, s[8:11], s54 offen offset:384 lds
  v_rcp_f32 v34, v34
  v_mfma_f32_32x32x16_bf16 v[144:159], a[152:155], a[88:91], v[144:159]
  s_lshl_b32 s95, s95, 8
  ds_read_b64_tr_b16 a[148:149], v9 offset:10240
  ds_read_b64_tr_b16 a[150:151], v9 offset:10752
  v_rcp_f32 v35, v35
  v_exp_f32 v38, v138
  v_mfma_f32_32x32x16_bf16 v[144:159], a[156:159], a[92:95], v[144:159]
  s_add_u32 m0, s36, 151168
  ds_read_b64_tr_b16 a[152:153], v9 offset:12288
  ds_read_b64_tr_b16 a[154:155], v9 offset:12800
  buffer_load_dwordx4 v4, s[8:11], s55 offen offset:384 lds
  v_add_f32 v36, 1.0, v36
  v_add_f32 v37, 1.0, v37
  v_mfma_f32_32x32x16_bf16 v[144:159], a[160:163], a[96:99], v[144:159]
  s_waitcnt lgkmcnt(4)
  ds_read_b64_tr_b16 a[156:157], v9 offset:14336
  ds_read_b64_tr_b16 a[158:159], v9 offset:14848
  v_exp_f32 v39, v139
  v_mul_f32 v134, v134, v34
  v_mul_f32 v135, v135, v35
  v_mfma_f32_32x32x16_bf16 v[144:159], a[164:167], a[100:103], v[144:159]
  s_add_u32 m0, s36, 155264
  ds_read_b64_tr_b16 a[160:161], v9 offset:16384
  ds_read_b64_tr_b16 a[162:163], v9 offset:16896
  buffer_load_dwordx4 v4, s[8:11], s56 offen offset:384 lds
  v_cvt_pk_bf16_f32 v66, v132, v133
  v_cvt_pk_bf16_f32 v67, v134, v135
  v_mfma_f32_32x32x16_bf16 v[144:159], a[168:171], a[104:107], v[144:159]
  s_sub_u32 s94, s94, s95
  ds_read_b64_tr_b16 a[164:165], v9 offset:18432
  ds_read_b64_tr_b16 a[166:167], v9 offset:18944
  v_rcp_f32 v36, v36
  v_rcp_f32 v37, v37
  v_mfma_f32_32x32x16_bf16 v[144:159], a[172:175], a[108:111], v[144:159]
  s_add_u32 m0, s36, 159360
  ds_read_b64_tr_b16 a[168:169], v9 offset:20480
  ds_read_b64_tr_b16 a[170:171], v9 offset:20992
  buffer_load_dwordx4 v4, s[8:11], s57 offen offset:384 lds
  v_exp_f32 v34, v140
  v_mfma_f32_32x32x16_bf16 v[144:159], a[144:147], a[112:115], v[144:159]
  s_waitcnt lgkmcnt(4)
  ds_read_b64_tr_b16 a[172:173], v9 offset:22528
  ds_read_b64_tr_b16 a[174:175], v9 offset:23040
  v_add_f32 v38, 1.0, v38
  v_add_f32 v39, 1.0, v39
  v_mfma_f32_32x32x16_bf16 v[144:159], a[148:151], a[116:119], v[144:159]
  s_add_u32 s94, s94, 256
  ds_read_b64_tr_b16 a[144:145], v11 offset:0
  ds_read_b64_tr_b16 a[146:147], v11 offset:512
  v_exp_f32 v35, v141
  v_mul_f32 v136, v136, v36
  v_mul_f32 v137, v137, v37
  v_mfma_f32_32x32x16_bf16 v[144:159], a[152:155], a[120:123], v[144:159]
  s_mul_i32 s75, s94, 1152
  ds_read_b64_tr_b16 a[148:149], v11 offset:2048
  ds_read_b64_tr_b16 a[150:151], v11 offset:2560
  v_rcp_f32 v38, v38
  v_rcp_f32 v39, v39
  v_mfma_f32_32x32x16_bf16 v[144:159], a[156:159], a[124:127], v[144:159]
  s_waitcnt lgkmcnt(4)
  ds_read_b64_tr_b16 a[152:153], v11 offset:4096
  ds_read_b64_tr_b16 a[154:155], v11 offset:4608
  v_exp_f32 v36, v142
  v_add_f32 v34, 1.0, v34
  v_add_f32 v35, 1.0, v35
  v_mfma_f32_32x32x16_bf16 v[144:159], a[160:163], a[128:131], v[144:159]
  s_add_u32 s97, s80, 4096
  ds_read_b64_tr_b16 a[156:157], v11 offset:6144
  ds_read_b64_tr_b16 a[158:159], v11 offset:6656
  buffer_store_dwordx4 v[56:59], v2, s[16:19], s97 offen sc1
  s_movk_i32 s93, 4096
  s_waitcnt vmcnt(10)
  v_cmp_ne_u32 vcc, s34, v180
  s_cbranch_vccz L_f1_ok
  s_mov_b32 s98, 0
L_f1_spin:
  s_sleep 1
  buffer_load_dword v180, v181, s[16:19], s93 offen sc1
  s_waitcnt vmcnt(0)
  v_cmp_ne_u32 vcc, s34, v180
  s_cbranch_vccz L_f1_ok
  s_add_u32 s98, s98, 1
  s_cmp_lt_u32 s98, 0x8000
  s_cbranch_scc1 L_f1_spin
L_f1_ok:
  s_nop 1
  s_cmp_eq_u32 s85, 1
  s_cbranch_scc0 L_z2
  s_lshl_b32 s91, s79, 3
  s_add_u32 s91, s91, s38
  s_lshl_b32 s91, s91, 2
  s_add_u32 s91, s91, s28
  s_lshl_b32 s91, s91, 11
  s_add_u32 s91, s91, 2097152
  buffer_load_dwordx2 v[168:169], v3, s[16:19], s91 offen offset:0 sc1
  buffer_load_dwordx2 v[170:171], v3, s[16:19], s91 offen offset:512 sc1
  buffer_load_dwordx2 v[172:173], v3, s[16:19], s91 offen offset:1024 sc1
  buffer_load_dwordx2 v[174:175], v3, s[16:19], s91 offen offset:1536 sc1
L_z2:
  s_lshl_b32 s91, s78, 3
  s_add_u32 s91, s91, s39
  s_lshl_b32 s91, s91, 2
  s_add_u32 s91, s91, s28
  s_lshl_b32 s91, s91, 11
  s_add_u32 s91, s91, 2097152
  s_lshr_b32 s92, 4352, s30
  s_bitcmp0_b32 s92, 0
  s_cselect_b32 s91, s91, 1073741824
  v_mfma_f32_32x32x16_bf16 v[144:159], a[164:167], a[132:135], v[144:159]
  ds_read_b64_tr_b16 a[160:161], v11 offset:8192
  ds_read_b64_tr_b16 a[162:163], v11 offset:8704
  v_exp_f32 v37, v143
  v_mul_f32 v138, v138, v38
  v_mul_f32 v139, v139, v39
  v_mfma_f32_32x32x16_bf16 v[144:159], a[168:171], a[136:139], v[144:159]
  s_add_u32 s97, s80, 5120
  ds_read_b64_tr_b16 a[164:165], v11 offset:10240
  ds_read_b64_tr_b16 a[166:167], v11 offset:10752
  buffer_store_dwordx4 v[60:63], v2, s[16:19], s97 offen sc1
  v_mfma_f32_32x32x16_bf16 v[144:159], a[172:175], a[140:143], v[144:159]
  s_waitcnt lgkmcnt(4)
  ds_read_b64_tr_b16 a[168:169], v11 offset:12288
  ds_read_b64_tr_b16 a[170:171], v11 offset:12800
  v_rcp_f32 v34, v34
  v_rcp_f32 v35, v35
  v_mfma_f32_32x32x16_bf16 v[112:127], a[144:147], a[0:3], 0
  s_add_u32 m0, s36, 0
  s_add_u32 s97, s89, 0
  ds_read_b64_tr_b16 a[172:173], v11 offset:14336
  ds_read_b64_tr_b16 a[174:175], v11 offset:14848
  buffer_load_dwordx4 v2, s[16:19], s97 offen sc1 lds
  v_cvt_pk_bf16_f32 v68, v136, v137
  v_cvt_pk_bf16_f32 v69, v138, v139
  v_mfma_f32_32x32x16_bf16 v[112:127], a[148:151], a[4:7], v[112:127]
  ds_read_b64_tr_b16 a[144:145], v11 offset:16384
  ds_read_b64_tr_b16 a[146:147], v11 offset:16896
  v_add_f32 v36, 1.0, v36
  v_add_f32 v37, 1.0, v37
  v_mul_f32 v140, v140, v34
  v_mfma_f32_32x32x16_bf16 v[112:127], a[152:155], a[8:11], v[112:127]
  s_add_u32 m0, s36, 4096
  s_add_u32 s97, s89, 4096
  ds_read_b64_tr_b16 a[148:149], v11 offset:18432
  ds_read_b64_tr_b16 a[150:151], v11 offset:18944
  buffer_load_dwordx4 v2, s[16:19], s97 offen sc1 lds
  v_mul_f32 v141, v141, v35
  v_mfma_f32_32x32x16_bf16 v[112:127], a[156:159], a[12:15], v[112:127]
  s_waitcnt lgkmcnt(4)
  ds_read_b64_tr_b16 a[152:153], v11 offset:20480
  ds_read_b64_tr_b16 a[154:155], v11 offset:20992
  v_rcp_f32 v36, v36
  v_rcp_f32 v37, v37
  v_mfma_f32_32x32x16_bf16 v[112:127], a[160:163], a[16:19], v[112:127]
  s_add_u32 m0, s36, 8192
  s_add_u32 s97, s89, 8192
  ds_read_b64_tr_b16 a[156:157], v11 offset:22528
  ds_read_b64_tr_b16 a[158:159], v11 offset:23040
  buffer_load_dwordx4 v2, s[16:19], s97 offen sc1 lds
  v_exp_f32 v38, v144
  v_mfma_f32_32x32x16_bf16 v[112:127], a[164:167], a[20:23], v[112:127]
  ds_read_b64_tr_b16 a[160:161], v11 offset:24576
  ds_read_b64_tr_b16 a[162:163], v11 offset:25088
  v_exp_f32 v39, v145
  v_mul_f32 v142, v142, v36
  v_mul_f32 v143, v143, v37
  v_mfma_f32_32x32x16_bf16 v[112:127], a[168:171], a[24:27], v[112:127]
  s_add_u32 m0, s36, 12288
  s_add_u32 s97, s89, 12288
  ds_read_b64_tr_b16 a[164:165], v11 offset:26624
  ds_read_b64_tr_b16 a[166:167], v11 offset:27136
  buffer_load_dwordx4 v2, s[16:19], s97 offen sc1 lds
  v_cvt_pk_bf16_f32 v70, v140, v141
  v_cvt_pk_bf16_f32 v71, v142, v143
  v_mfma_f32_32x32x16_bf16 v[112:127], a[172:175], a[28:31], v[112:127]
  s_waitcnt lgkmcnt(4)
  ds_read_b64_tr_b16 a[168:169], v11 offset:28672
  ds_read_b64_tr_b16 a[170:171], v11 offset:29184
  v_permlane16_swap_b32 v64, v68
  v_permlane16_swap_b32 v65, v69
  v_permlane16_swap_b32 v66, v70
  v_mfma_f32_32x32x16_bf16 v[112:127], a[144:147], a[32:35], v[112:127]
  ds_read_b64_tr_b16 a[172:173], v11 offset:30720
  ds_read_b64_tr_b16 a[174:175], v11 offset:31232
  buffer_load_dwordx2 v[160:161], v3, s[16:19], s91 offen offset:0 sc1
  v_exp_f32 v34, v146
  v_mfma_f32_32x32x16_bf16 v[112:127], a[148:151], a[36:39], v[112:127]
  ds_read_b64_tr_b16 a[144:145], v11 offset:32768
  ds_read_b64_tr_b16 a[146:147], v11 offset:33280
  v_add_f32 v38, 1.0, v38
  v_add_f32 v39, 1.0, v39
  v_permlane16_swap_b32 v67, v71
  v_mfma_f32_32x32x16_bf16 v[112:127], a[152:155], a[40:43], v[112:127]
  ds_read_b64_tr_b16 a[148:149], v11 offset:34816
  ds_read_b64_tr_b16 a[150:151], v11 offset:35328
  buffer_load_dwordx2 v[162:163], v3, s[16:19], s91 offen offset:512 sc1
  v_exp_f32 v35, v147
  v_mfma_f32_32x32x16_bf16 v[112:127], a[156:159], a[44:47], v[112:127]
  s_waitcnt lgkmcnt(4)
  ds_read_b64_tr_b16 a[152:153], v11 offset:36864
  ds_read_b64_tr_b16 a[154:155], v11 offset:37376
  v_rcp_f32 v38, v38
  v_rcp_f32 v39, v39
  v_mfma_f32_32x32x16_bf16 v[112:127], a[160:163], a[48:51], v[112:127]
  ds_read_b64_tr_b16 a[156:157], v11 offset:38912
  ds_read_b64_tr_b16 a[158:159], v11 offset:39424
  buffer_load_dwordx2 v[164:165], v3, s[16:19], s91 offen offset:1024 sc1
  v_exp_f32 v36, v148
  v_mfma_f32_32x32x16_bf16 v[112:127], a[164:167], a[52:55], v[112:127]
  ds_read_b64_tr_b16 a[160:161], v11 offset:40960
  ds_read_b64_tr_b16 a[162:163], v11 offset:41472
  v_add_f32 v34, 1.0, v34
  v_add_f32 v35, 1.0, v35
  v_mfma_f32_32x32x16_bf16 v[112:127], a[168:171], a[56:59], v[112:127]
  ds_read_b64_tr_b16 a[164:165], v11 offset:43008
  ds_read_b64_tr_b16 a[166:167], v11 offset:43520
  buffer_load_dwordx2 v[166:167], v3, s[16:19], s91 offen offset:1536 sc1
  v_exp_f32 v37, v149
  v_mfma_f32_32x32x16_bf16 v[112:127], a[172:175], a[60:63], v[112:127]
  s_waitcnt lgkmcnt(4)
  ds_read_b64_tr_b16 a[168:169], v11 offset:45056
  ds_read_b64_tr_b16 a[170:171], v11 offset:45568
  v_mul_f32 v144, v144, v38
  v_mul_f32 v145, v145, v39
  v_mfma_f32_32x32x16_bf16 v[112:127], a[144:147], a[64:67], v[112:127]
  s_add_u32 s97, s80, 6144
  ds_read_b64_tr_b16 a[172:173], v11 offset:47104
  ds_read_b64_tr_b16 a[174:175], v11 offset:47616
  buffer_store_dwordx4 v[64:67], v2, s[16:19], s97 offen sc1
  v_mfma_f32_32x32x16_bf16 v[112:127], a[148:151], a[68:71], v[112:127]
  ds_read_b64_tr_b16 a[144:145], v12 offset:0
  ds_read_b64_tr_b16 a[146:147], v12 offset:512
  v_rcp_f32 v34, v34
  v_rcp_f32 v35, v35
  v_mfma_f32_32x32x16_bf16 v[112:127], a[152:155], a[72:75], v[112:127]
  s_add_u32 s97, s80, 7168
  ds_read_b64_tr_b16 a[148:149], v12 offset:2048
  ds_read_b64_tr_b16 a[150:151], v12 offset:2560
  buffer_store_dwordx4 v[68:71], v2, s[16:19], s97 offen sc1
  v_mfma_f32_32x32x16_bf16 v[112:127], a[156:159], a[76:79], v[112:127]
  s_waitcnt lgkmcnt(4)
  ds_read_b64_tr_b16 a[152:153], v12 offset:4096
  ds_read_b64_tr_b16 a[154:155], v12 offset:4608
  v_exp_f32 v38, v150
  v_add_f32 v36, 1.0, v36
  v_add_f32 v37, 1.0, v37
  v_mfma_f32_32x32x16_bf16 v[112:127], a[160:163], a[80:83], v[112:127]
  ds_read_b64_tr_b16 a[156:157], v12 offset:6144
  ds_read_b64_tr_b16 a[158:159], v12 offset:6656
  v_exp_f32 v39, v151
  v_mul_f32 v146, v146, v34
  v_mul_f32 v147, v147, v35
  v_mfma_f32_32x32x16_bf16 v[112:127], a[164:167], a[84:87], v[112:127]
  ds_read_b64_tr_b16 a[160:161], v12 offset:8192
  ds_read_b64_tr_b16 a[162:163], v12 offset:8704
  v_rcp_f32 v36, v36
  v_rcp_f32 v37, v37
  v_mfma_f32_32x32x16_bf16 v[112:127], a[168:171], a[88:91], v[112:127]
  ds_read_b64_tr_b16 a[164:165], v12 offset:10240
  ds_read_b64_tr_b16 a[166:167], v12 offset:10752
  v_exp_f32 v34, v152
  v_add_f32 v38, 1.0, v38
  v_add_f32 v39, 1.0, v39
  v_mfma_f32_32x32x16_bf16 v[112:127], a[172:175], a[92:95], v[112:127]
  s_waitcnt lgkmcnt(4)
  ds_read_b64_tr_b16 a[168:169], v12 offset:12288
  ds_read_b64_tr_b16 a[170:171], v12 offset:12800
  v_exp_f32 v35, v153
  v_mul_f32 v148, v148, v36
  v_mul_f32 v149, v149, v37
  v_mfma_f32_32x32x16_bf16 v[112:127], a[144:147], a[96:99], v[112:127]
  s_barrier
  ds_read_b64_tr_b16 a[172:173], v12 offset:14336
  ds_read_b64_tr_b16 a[174:175], v12 offset:14848
  v_cvt_pk_bf16_f32 v72, v144, v145
  v_cvt_pk_bf16_f32 v73, v146, v147
  v_cvt_pk_bf16_f32 v74, v148, v149
  v_mfma_f32_32x32x16_bf16 v[112:127], a[148:151], a[100:103], v[112:127]
  s_add_u32 m0, s36, 16384
  ds_read_b64_tr_b16 a[144:145], v12 offset:16384
  ds_read_b64_tr_b16 a[146:147], v12 offset:16896
  buffer_load_dwordx4 v5, s[8:11], s40 offen lds
  v_rcp_f32 v38, v38
  v_mfma_f32_32x32x16_bf16 v[112:127], a[152:155], a[104:107], v[112:127]
  s_waitcnt lgkmcnt(4)
  ds_read_b64_tr_b16 a[148:149], v12 offset:18432
  ds_read_b64_tr_b16 a[150:151], v12 offset:18944
  v_rcp_f32 v39, v39
  v_exp_f32 v36, v154
  s_lshr_b32 s99, s31, 1
  s_add_u32 s99, s99, 1
  s_and_b32 s99, s99, 3
  s_cmp_eq_u32 s99, 3
  s_cselect_b32 s99, -3, 1
  s_lshl_b32 s99, s99, 7
  v_add_u32 v4, s99, v6
  v_mfma_f32_32x32x16_bf16 v[112:127], a[156:159], a[108:111], v[112:127]
  s_add_u32 m0, s36, 20480
  ds_read_b64_tr_b16 a[152:153], v12 offset:20480
  ds_read_b64_tr_b16 a[154:155], v12 offset:20992
  buffer_load_dwordx4 v5, s[8:11], s42 offen lds
  v_add_f32 v34, 1.0, v34
  v_add_f32 v35, 1.0, v35
  v_mfma_f32_32x32x16_bf16 v[112:127], a[160:163], a[112:115], v[112:127]
  ds_read_b64_tr_b16 a[156:157], v12 offset:22528
  ds_read_b64_tr_b16 a[158:159], v12 offset:23040
  v_exp_f32 v37, v155
  v_mul_f32 v150, v150, v38
  v_mul_f32 v151, v151, v39
  v_mfma_f32_32x32x16_bf16 v[112:127], a[164:167], a[116:119], v[112:127]
  s_add_u32 m0, s36, 24576
  ds_read_b64_tr_b16 a[160:161], v9 offset:24576
  ds_read_b64_tr_b16 a[162:163], v9 offset:25088
  buffer_load_dwordx4 v5, s[8:11], s44 offen lds
  v_rcp_f32 v34, v34
  v_mfma_f32_32x32x16_bf16 v[112:127], a[168:171], a[120:123], v[112:127]
  s_waitcnt lgkmcnt(4)
  ds_read_b64_tr_b16 a[164:165], v9 offset:26624
  ds_read_b64_tr_b16 a[166:167], v9 offset:27136
  v_rcp_f32 v35, v35
  v_exp_f32 v38, v156
  v_mfma_f32_32x32x16_bf16 v[112:127], a[172:175], a[124:127], v[112:127]
  s_add_u32 m0, s36, 28672
  ds_read_b64_tr_b16 a[168:169], v9 offset:28672
  ds_read_b64_tr_b16 a[170:171], v9 offset:29184
  buffer_load_dwordx4 v5, s[8:11], s46 offen lds
  v_add_f32 v36, 1.0, v36
  v_add_f32 v37, 1.0, v37
  v_mfma_f32_32x32x16_bf16 v[112:127], a[144:147], a[128:131], v[112:127]
  ds_read_b64_tr_b16 a[172:173], v9 offset:30720
  ds_read_b64_tr_b16 a[174:175], v9 offset:31232
  v_exp_f32 v39, v157
  v_mul_f32 v152, v152, v34
  v_mul_f32 v153, v153, v35
  v_mfma_f32_32x32x16_bf16 v[112:127], a[148:151], a[132:135], v[112:127]
  s_add_u32 m0, s36, 32768
  ds_read_b64_tr_b16 a[144:145], v9 offset:32768
  ds_read_b64_tr_b16 a[146:147], v9 offset:33280
  buffer_load_dwordx4 v5, s[8:11], s48 offen lds
  v_cvt_pk_bf16_f32 v75, v150, v151
  v_cvt_pk_bf16_f32 v76, v152, v153
  v_mfma_f32_32x32x16_bf16 v[112:127], a[152:155], a[136:139], v[112:127]
  s_waitcnt lgkmcnt(4)
  ds_read_b64_tr_b16 a[148:149], v9 offset:34816
  ds_read_b64_tr_b16 a[150:151], v9 offset:35328
  v_rcp_f32 v36, v36
  v_rcp_f32 v37, v37
  v_mfma_f32_32x32x16_bf16 v[112:127], a[156:159], a[140:143], v[112:127]
  ds_read_b64_tr_b16 a[152:153], v9 offset:36864
  ds_read_b64_tr_b16 a[154:155], v9 offset:37376
  v_exp_f32 v34, v158
  v_add_f32 v38, 1.0, v38
  v_add_f32 v39, 1.0, v39
  v_mfma_f32_32x32x16_bf16 v[128:143], a[160:163], a[0:3], 0
  s_add_u32 m0, s36, 36864
  ds_read_b64_tr_b16 a[156:157], v9 offset:38912
  ds_read_b64_tr_b16 a[158:159], v9 offset:39424
  buffer_load_dwordx4 v5, s[8:11], s50 offen lds
  v_exp_f32 v35, v159
  v_mfma_f32_32x32x16_bf16 v[128:143], a[164:167], a[4:7], v[128:143]
  s_waitcnt lgkmcnt(4)
  ds_read_b64_tr_b16 a[160:161], v9 offset:40960
  ds_read_b64_tr_b16 a[162:163], v9 offset:41472
  v_mul_f32 v154, v154, v36
  v_mul_f32 v155, v155, v37
  v_mfma_f32_32x32x16_bf16 v[128:143], a[168:171], a[8:11], v[128:143]
  s_add_u32 m0, s36, 40960
  ds_read_b64_tr_b16 a[164:165], v9 offset:43008
  ds_read_b64_tr_b16 a[166:167], v9 offset:43520
  buffer_load_dwordx4 v5, s[8:11], s52 offen lds
  v_rcp_f32 v38, v38
  v_mfma_f32_32x32x16_bf16 v[128:143], a[172:175], a[12:15], v[128:143]
  ds_read_b64_tr_b16 a[168:169], v9 offset:45056
  ds_read_b64_tr_b16 a[170:171], v9 offset:45568
  v_rcp_f32 v39, v39
  v_exp_f32 v36, v112
  v_mfma_f32_32x32x16_bf16 v[128:143], a[144:147], a[16:19], v[128:143]
  s_add_u32 m0, s36, 45056
  ds_read_b64_tr_b16 a[172:173], v9 offset:47104
  ds_read_b64_tr_b16 a[174:175], v9 offset:47616
  buffer_load_dwordx4 v5, s[8:11], s54 offen lds
  v_add_f32 v34, 1.0, v34
  v_add_f32 v35, 1.0, v35
  v_mfma_f32_32x32x16_bf16 v[128:143], a[148:151], a[20:23], v[128:143]
  s_waitcnt lgkmcnt(4)
  s_waitcnt vmcnt(20)
  s_waitcnt vmcnt(14)
  s_barrier
  ds_read_b64_tr_b16 a[144:145], v10 offset:0
  ds_read_b64_tr_b16 a[146:147], v10 offset:512
  ds_read_b128 a[176:179], v2 offset:0
  v_exp_f32 v37, v113
  v_mul_f32 v156, v156, v38
  v_mfma_f32_32x32x16_bf16 v[128:143], a[152:155], a[24:27], v[128:143]
  s_add_u32 m0, s36, 49152
  ds_read_b64_tr_b16 a[148:149], v10 offset:2048
  ds_read_b64_tr_b16 a[150:151], v10 offset:2560
  ds_read_b128 a[180:183], v2 offset:1024
  buffer_load_dwordx4 v5, s[8:11], s56 offen lds
  v_mul_f32 v157, v157, v39
  v_mfma_f32_32x32x16_bf16 v[128:143], a[156:159], a[28:31], v[128:143]
  ds_read_b64_tr_b16 a[152:153], v10 offset:4096
  ds_read_b64_tr_b16 a[154:155], v10 offset:4608
  ds_read_b128 a[184:187], v2 offset:2048
  v_rcp_f32 v34, v34
  v_cvt_pk_bf16_f32 v77, v154, v155
  v_mfma_f32_32x32x16_bf16 v[128:143], a[160:163], a[32:35], v[128:143]
  ds_read_b64_tr_b16 a[156:157], v10 offset:6144
  ds_read_b64_tr_b16 a[158:159], v10 offset:6656
  ds_read_b128 a[188:191], v2 offset:3072
  v_rcp_f32 v35, v35
  v_cvt_pk_bf16_f32 v78, v156, v157
  v_mfma_f32_32x32x16_bf16 v[128:143], a[164:167], a[36:39], v[128:143]
  s_waitcnt lgkmcnt(7)
  ds_read_b64_tr_b16 a[160:161], v10 offset:8192
  ds_read_b64_tr_b16 a[162:163], v10 offset:8704
  ds_read_b128 a[192:195], v2 offset:4096
  v_exp_f32 v38, v114
  v_add_f32 v36, 1.0, v36
  v_mfma_f32_32x32x16_bf16 v[128:143], a[168:171], a[40:43], v[128:143]
  ds_read_b64_tr_b16 a[164:165], v10 offset:10240
  ds_read_b64_tr_b16 a[166:167], v10 offset:10752
  ds_read_b128 a[196:199], v2 offset:5120
  v_add_f32 v37, 1.0, v37
  v_mfma_f32_32x32x16_bf16 v[128:143], a[172:175], a[44:47], v[128:143]
  ds_read_b64_tr_b16 a[168:169], v10 offset:12288
  ds_read_b64_tr_b16 a[170:171], v10 offset:12800
  ds_read_b128 a[200:203], v2 offset:6144
  v_exp_f32 v39, v115
  v_mul_f32 v158, v158, v34
  s_lshr_b32 s99, s31, 1
  s_add_u32 s99, s99, 2
  s_and_b32 s99, s99, 3
  s_cmp_eq_u32 s99, 3
  s_cselect_b32 s99, -3, 1
  s_lshl_b32 s99, s99, 7
  v_add_u32 v5, s99, v4
  v_mfma_f32_32x32x16_bf16 v[128:143], a[144:147], a[48:51], v[128:143]
  ds_read_b64_tr_b16 a[172:173], v10 offset:14336
  ds_read_b64_tr_b16 a[174:175], v10 offset:14848
  ds_read_b128 a[204:207], v2 offset:7168
  v_mul_f32 v159, v159, v35
  v_mfma_f32_32x32x16_bf16 v[128:143], a[148:151], a[52:55], v[128:143]
  s_waitcnt lgkmcnt(7)
  ds_read_b64_tr_b16 a[144:145], v10 offset:16384
  ds_read_b64_tr_b16 a[146:147], v10 offset:16896
  ds_read_b128 a[208:211], v2 offset:8192
  v_rcp_f32 v36, v36
  v_cvt_pk_bf16_f32 v79, v158, v159
  v_mfma_f32_32x32x16_bf16 v[128:143], a[152:155], a[56:59], v[128:143]
  s_mul_i32 s41, s30, 55296
  ds_read_b64_tr_b16 a[148:149], v10 offset:18432
  ds_read_b64_tr_b16 a[150:151], v10 offset:18944
  ds_read_b128 a[212:215], v2 offset:9216
  v_permlane16_swap_b32 v72, v76
  v_permlane16_swap_b32 v73, v77
  v_permlane16_swap_b32 v74, v78
  v_mfma_f32_32x32x16_bf16 v[128:143], a[156:159], a[60:63], v[128:143]
  s_add_u32 m0, s36, 53248
  ds_read_b64_tr_b16 a[152:153], v10 offset:20480
  ds_read_b64_tr_b16 a[154:155], v10 offset:20992
  ds_read_b128 a[216:219], v2 offset:10240
  buffer_load_dwordx4 v6, s[12:15], s58 offen lds
  v_rcp_f32 v37, v37
  v_exp_f32 v34, v116
  v_mfma_f32_32x32x16_bf16 v[128:143], a[160:163], a[64:67], v[128:143]
  s_waitcnt lgkmcnt(7)
  ds_read_b64_tr_b16 a[156:157], v10 offset:22528
  ds_read_b64_tr_b16 a[158:159], v10 offset:23040
  ds_read_b128 a[220:223], v2 offset:11264
  v_add_f32 v38, 1.0, v38
  v_add_f32 v39, 1.0, v39
  v_permlane16_swap_b32 v75, v79
  v_mfma_f32_32x32x16_bf16 v[128:143], a[164:167], a[68:71], v[128:143]
  s_add_u32 m0, s36, 57344
  ds_read_b64_tr_b16 a[160:161], v10 offset:24576
  ds_read_b64_tr_b16 a[162:163], v10 offset:25088
  ds_read_b128 a[224:227], v2 offset:12288
  buffer_load_dwordx4 v6, s[12:15], s59 offen lds
  v_exp_f32 v35, v117
  v_mul_f32 v112, v112, v36
  v_mul_f32 v113, v113, v37
  v_mfma_f32_32x32x16_bf16 v[128:143], a[168:171], a[72:75], v[128:143]
  s_add_u32 s41, s41, s36
  ds_read_b64_tr_b16 a[164:165], v10 offset:26624
  ds_read_b64_tr_b16 a[166:167], v10 offset:27136
  ds_read_b128 a[228:231], v2 offset:13312
  v_rcp_f32 v38, v38
  v_cvt_pk_bf16_f32 v80, v112, v113
  v_mfma_f32_32x32x16_bf16 v[128:143], a[172:175], a[76:79], v[128:143]
  s_add_u32 m0, s36, 61440
  ds_read_b64_tr_b16 a[168:169], v10 offset:28672
  ds_read_b64_tr_b16 a[170:171], v10 offset:29184
  ds_read_b128 a[232:235], v2 offset:14336
  buffer_load_dwordx4 v6, s[12:15], s60 offen lds
  v_rcp_f32 v39, v39
  v_exp_f32 v36, v118
  v_mfma_f32_32x32x16_bf16 v[128:143], a[144:147], a[80:83], v[128:143]
  s_waitcnt lgkmcnt(7)
  ds_read_b64_tr_b16 a[172:173], v10 offset:30720
  ds_read_b64_tr_b16 a[174:175], v10 offset:31232
  ds_read_b128 a[236:239], v2 offset:15360
  v_add_f32 v34, 1.0, v34
  v_add_f32 v35, 1.0, v35
  v_mfma_f32_32x32x16_bf16 v[128:143], a[148:151], a[84:87], v[128:143]
  s_add_u32 s41, s41, 327680
  ds_read_b64_tr_b16 a[144:145], v10 offset:32768
  ds_read_b64_tr_b16 a[146:147], v10 offset:33280
  v_exp_f32 v37, v119
  v_mul_f32 v114, v114, v38
  v_mul_f32 v115, v115, v39
  v_mfma_f32_32x32x16_bf16 v[128:143], a[152:155], a[88:91], v[128:143]
  s_add_u32 m0, s36, 65536
  ds_read_b64_tr_b16 a[148:149], v10 offset:34816
  ds_read_b64_tr_b16 a[150:151], v10 offset:35328
  buffer_load_dwordx4 v6, s[12:15], s61 offen lds
  v_rcp_f32 v34, v34
  v_rcp_f32 v35, v35
  v_mfma_f32_32x32x16_bf16 v[128:143], a[156:159], a[92:95], v[128:143]
  s_waitcnt lgkmcnt(5)
  ds_read_b64_tr_b16 a[152:153], v10 offset:36864
  ds_read_b64_tr_b16 a[154:155], v10 offset:37376
  v_exp_f32 v38, v120
  v_add_f32 v36, 1.0, v36
  v_add_f32 v37, 1.0, v37
  v_mfma_f32_32x32x16_bf16 v[128:143], a[160:163], a[96:99], v[128:143]
  s_waitcnt lgkmcnt(6)
  s_barrier
  ds_read_b64_tr_b16 a[156:157], v10 offset:38912
  ds_read_b64_tr_b16 a[158:159], v10 offset:39424
  v_exp_f32 v39, v121
  v_mul_f32 v116, v116, v34
  v_mul_f32 v117, v117, v35
  v_mfma_f32_32x32x16_bf16 v[128:143], a[164:167], a[100:103], v[128:143]
  s_add_u32 m0, s36, 69632
  ds_read_b64_tr_b16 a[160:161], v10 offset:40960
  ds_read_b64_tr_b16 a[162:163], v10 offset:41472
  buffer_load_dwordx4 v6, s[12:15], s62 offen lds
  v_cvt_pk_bf16_f32 v81, v114, v115
  v_cvt_pk_bf16_f32 v82, v116, v117
  v_mfma_f32_32x32x16_bf16 v[128:143], a[168:171], a[104:107], v[128:143]
  s_waitcnt lgkmcnt(4)
  ds_read_b64_tr_b16 a[164:165], v10 offset:43008
  ds_read_b64_tr_b16 a[166:167], v10 offset:43520
  v_rcp_f32 v36, v36
  v_rcp_f32 v37, v37
  v_mfma_f32_32x32x16_bf16 v[128:143], a[172:175], a[108:111], v[128:143]
  s_add_u32 m0, s36, 73728
  ds_read_b64_tr_b16 a[168:169], v10 offset:45056
  ds_read_b64_tr_b16 a[170:171], v10 offset:45568
  buffer_load_dwordx4 v6, s[12:15], s63 offen lds
  v_exp_f32 v34, v122
  v_mfma_f32_32x32x16_bf16 v[128:143], a[144:147], a[112:115], v[128:143]
  s_xor_b32 s43, s83, 4
  ds_read_b64_tr_b16 a[172:173], v10 offset:47104
  ds_read_b64_tr_b16 a[174:175], v10 offset:47616
  v_add_f32 v38, 1.0, v38
  v_add_f32 v39, 1.0, v39
  v_mfma_f32_32x32x16_bf16 v[128:143], a[148:151], a[116:119], v[128:143]
  s_add_u32 m0, s36, 77824
  ds_read_b64_tr_b16 a[144:145], v12 offset:24576
  ds_read_b64_tr_b16 a[146:147], v12 offset:25088
  buffer_load_dwordx4 v6, s[12:15], s64 offen lds
  v_exp_f32 v35, v123
  v_mfma_f32_32x32x16_bf16 v[128:143], a[152:155], a[120:123], v[128:143]
  s_waitcnt lgkmcnt(4)
  ds_read_b64_tr_b16 a[148:149], v12 offset:26624
  ds_read_b64_tr_b16 a[150:151], v12 offset:27136
  v_mul_f32 v118, v118, v36
  v_mul_f32 v119, v119, v37
  v_and_b32 v177, 1, v1
  v_mul_u32_u24 v176, 0x8000, v177
  v_lshl_or_b32 v176, v176, 16, v176
  v_xor_b32 v177, 0x80008000, v176
  v_and_b32 v178, 0x80000000, v177
  v_or_b32 v178, 1.0, v178
  v_and_b32 v248, 15, v1
  v_lshrrev_b32 v179, 4, v1
  s_lshl_b32 s93, s28, 2
  v_add_u32 v179, s93, v179
  v_xor_b32 v179, v179, v248
  v_lshlrev_b32 v179, 3, v179
  v_lshl_add_u32 v179, v248, 7, v179
  s_cmp_eq_u32 s85, 1
  s_cbranch_scc0 L_p2b
  s_cmp_lt_u32 s79, 18
  s_cselect_b32 s88, 2, -287
  s_lshl_b32 s99, s79, 4
  s_add_i32 s88, s88, s99
  s_cmp_lt_u32 s78, 18
  s_cselect_b32 s89, 2, -287
  s_lshl_b32 s99, s78, 4
  s_add_i32 s89, s89, s99
  s_sub_i32 s88, s88, s89
  s_lshl_b32 s88, s88, 1
  s_sub_i32 s88, s88, 943296
  s_sub_i32 s89, s38, s39
  s_mul_i32 s89, s89, 2312
  s_add_i32 s88, s88, s89
  s_ashr_i32 s89, s88, 31
  v_lshl_add_u64 v[242:243], v[240:241], 0, s[88:89]
  s_waitcnt vmcnt(21)
  v_xor_b32_dpp v216, v160, v176 quad_perm:[1,0,3,2] row_mask:0xf bank_mask:0xf
  v_xor_b32_dpp v217, v161, v176 quad_perm:[1,0,3,2] row_mask:0xf bank_mask:0xf
  s_waitcnt vmcnt(20)
  v_xor_b32_dpp v218, v162, v176 quad_perm:[1,0,3,2] row_mask:0xf bank_mask:0xf
  v_xor_b32_dpp v219, v163, v176 quad_perm:[1,0,3,2] row_mask:0xf bank_mask:0xf
  s_waitcnt vmcnt(19)
  v_xor_b32_dpp v252, v164, v176 quad_perm:[1,0,3,2] row_mask:0xf bank_mask:0xf
  v_xor_b32_dpp v253, v165, v176 quad_perm:[1,0,3,2] row_mask:0xf bank_mask:0xf
  s_waitcnt vmcnt(18)
  v_xor_b32_dpp v254, v166, v176 quad_perm:[1,0,3,2] row_mask:0xf bank_mask:0xf
  v_xor_b32_dpp v255, v167, v176 quad_perm:[1,0,3,2] row_mask:0xf bank_mask:0xf
  v_mfma_f32_16x16x32_bf16 v[96:99], a[176:179], v[160:163], 0
  global_load_ushort v200, v[242:243], off
  v_lshlrev_b32 v184, 16, v184
  v_lshlrev_b32 v185, 16, v185
  v_mfma_f32_16x16x32_bf16 v[96:99], a[208:211], v[216:219], v[96:99]
  v_lshlrev_b32 v186, 16, v186
  v_lshlrev_b32 v187, 16, v187
  v_mfma_f32_16x16x32_bf16 v[96:99], a[180:183], v[164:167], v[96:99]
  v_lshl_add_u64 v[242:243], v[242:243], 0, s[24:25]
  global_load_ushort v201, v[242:243], off
  v_lshlrev_b32 v188, 16, v188
  v_lshlrev_b32 v189, 16, v189
  v_mfma_f32_16x16x32_bf16 v[96:99], a[212:215], v[252:255], v[96:99]
  v_lshlrev_b32 v190, 16, v190
  v_lshlrev_b32 v191, 16, v191
  v_mfma_f32_16x16x32_bf16 v[100:103], a[184:187], v[160:163], 0
  v_lshl_add_u64 v[242:243], v[242:243], 0, s[24:25]
  global_load_ushort v202, v[242:243], off
  v_lshlrev_b32 v192, 16, v192
  v_lshlrev_b32 v193, 16, v193
  v_mfma_f32_16x16x32_bf16 v[100:103], a[216:219], v[216:219], v[100:103]
  v_lshlrev_b32 v194, 16, v194
  v_lshlrev_b32 v195, 16, v195
  v_mfma_f32_16x16x32_bf16 v[100:103], a[188:191], v[164:167], v[100:103]
  v_lshl_add_u64 v[242:243], v[242:243], 0, s[24:25]
  global_load_ushort v203, v[242:243], off
  v_lshlrev_b32 v196, 16, v196
  v_lshlrev_b32 v197, 16, v197
  v_mfma_f32_16x16x32_bf16 v[100:103], a[220:223], v[252:255], v[100:103]
  v_lshlrev_b32 v198, 16, v198
  v_lshlrev_b32 v199, 16, v199
  v_mfma_f32_16x16x32_bf16 v[104:107], a[192:195], v[160:163], 0
  v_lshl_add_u64 v[242:243], v[242:243], 0, s[26:27]
  global_load_ushort v204, v[242:243], off
  v_mul_f32_dpp v248, v184, v96 quad_perm:[1,1,3,3] row_mask:0xf bank_mask:0xf
  v_mul_f32_dpp v249, v185, v97 quad_perm:[1,1,3,3] row_mask:0xf bank_mask:0xf
  v_mul_f32_dpp v250, v186, v98 quad_perm:[1,1,3,3] row_mask:0xf bank_mask:0xf
  v_mfma_f32_16x16x32_bf16 v[104:107], a[224:227], v[216:219], v[104:107]
  v_mul_f32_dpp v251, v187, v99 quad_perm:[1,1,3,3] row_mask:0xf bank_mask:0xf
  v_mul_f32_dpp v220, v184, v96 quad_perm:[0,0,2,2] row_mask:0xf bank_mask:0xf
  v_mul_f32_dpp v221, v185, v97 quad_perm:[0,0,2,2] row_mask:0xf bank_mask:0xf
  v_mfma_f32_16x16x32_bf16 v[104:107], a[196:199], v[164:167], v[104:107]
  v_lshl_add_u64 v[242:243], v[242:243], 0, s[24:25]
  global_load_ushort v205, v[242:243], off
  v_mul_f32_dpp v222, v186, v98 quad_perm:[0,0,2,2] row_mask:0xf bank_mask:0xf
  v_mul_f32_dpp v223, v187, v99 quad_perm:[0,0,2,2] row_mask:0xf bank_mask:0xf
  v_fmac_f32_dpp v220, v248, v178 quad_perm:[1,0,3,2] row_mask:0xf bank_mask:0xf
  v_mfma_f32_16x16x32_bf16 v[104:107], a[228:231], v[252:255], v[104:107]
  v_fmac_f32_dpp v221, v249, v178 quad_perm:[1,0,3,2] row_mask:0xf bank_mask:0xf
  v_fmac_f32_dpp v222, v250, v178 quad_perm:[1,0,3,2] row_mask:0xf bank_mask:0xf
  v_fmac_f32_dpp v223, v251, v178 quad_perm:[1,0,3,2] row_mask:0xf bank_mask:0xf
  v_mfma_f32_16x16x32_bf16 v[108:111], a[200:203], v[160:163], 0
  v_lshl_add_u64 v[242:243], v[242:243], 0, s[24:25]
  global_load_ushort v206, v[242:243], off
  v_mul_f32_dpp v248, v188, v100 quad_perm:[1,1,3,3] row_mask:0xf bank_mask:0xf
  v_mul_f32_dpp v249, v189, v101 quad_perm:[1,1,3,3] row_mask:0xf bank_mask:0xf
  v_mul_f32_dpp v250, v190, v102 quad_perm:[1,1,3,3] row_mask:0xf bank_mask:0xf
  v_mfma_f32_16x16x32_bf16 v[108:111], a[232:235], v[216:219], v[108:111]
  v_mul_f32_dpp v251, v191, v103 quad_perm:[1,1,3,3] row_mask:0xf bank_mask:0xf
  v_mul_f32_dpp v224, v188, v100 quad_perm:[0,0,2,2] row_mask:0xf bank_mask:0xf
  v_mul_f32_dpp v225, v189, v101 quad_perm:[0,0,2,2] row_mask:0xf bank_mask:0xf
  v_mfma_f32_16x16x32_bf16 v[108:111], a[204:207], v[164:167], v[108:111]
  v_lshl_add_u64 v[242:243], v[242:243], 0, s[24:25]
  global_load_ushort v207, v[242:243], off
  v_mul_f32_dpp v226, v190, v102 quad_perm:[0,0,2,2] row_mask:0xf bank_mask:0xf
  v_mul_f32_dpp v227, v191, v103 quad_perm:[0,0,2,2] row_mask:0xf bank_mask:0xf
  v_fmac_f32_dpp v224, v248, v178 quad_perm:[1,0,3,2] row_mask:0xf bank_mask:0xf
  v_mfma_f32_16x16x32_bf16 v[108:111], a[236:239], v[252:255], v[108:111]
  v_fmac_f32_dpp v225, v249, v178 quad_perm:[1,0,3,2] row_mask:0xf bank_mask:0xf
  v_fmac_f32_dpp v226, v250, v178 quad_perm:[1,0,3,2] row_mask:0xf bank_mask:0xf
  v_fmac_f32_dpp v227, v251, v178 quad_perm:[1,0,3,2] row_mask:0xf bank_mask:0xf
  v_cvt_pk_bf16_f32 v160, v220, v221
  v_cvt_pk_bf16_f32 v161, v222, v223
  v_cvt_pk_bf16_f32 v162, v224, v225
  v_cvt_pk_bf16_f32 v163, v226, v227
  v_mul_f32_dpp v248, v192, v104 quad_perm:[1,1,3,3] row_mask:0xf bank_mask:0xf
  v_mul_f32_dpp v249, v193, v105 quad_perm:[1,1,3,3] row_mask:0xf bank_mask:0xf
  v_mul_f32_dpp v250, v194, v106 quad_perm:[1,1,3,3] row_mask:0xf bank_mask:0xf
  v_mul_f32_dpp v251, v195, v107 quad_perm:[1,1,3,3] row_mask:0xf bank_mask:0xf
  v_xor_b32_dpp v216, v160, v177 quad_perm:[1,0,3,2] row_mask:0xf bank_mask:0xf
  v_xor_b32_dpp v217, v161, v177 quad_perm:[1,0,3,2] row_mask:0xf bank_mask:0xf
  v_xor_b32_dpp v218, v162, v177 quad_perm:[1,0,3,2] row_mask:0xf bank_mask:0xf
  v_xor_b32_dpp v219, v163, v177 quad_perm:[1,0,3,2] row_mask:0xf bank_mask:0xf
  v_mul_f32_dpp v228, v192, v104 quad_perm:[0,0,2,2] row_mask:0xf bank_mask:0xf
  v_mul_f32_dpp v229, v193, v105 quad_perm:[0,0,2,2] row_mask:0xf bank_mask:0xf
  v_mul_f32_dpp v230, v194, v106 quad_perm:[0,0,2,2] row_mask:0xf bank_mask:0xf
  v_mul_f32_dpp v231, v195, v107 quad_perm:[0,0,2,2] row_mask:0xf bank_mask:0xf
  v_fmac_f32_dpp v228, v248, v178 quad_perm:[1,0,3,2] row_mask:0xf bank_mask:0xf
  v_fmac_f32_dpp v229, v249, v178 quad_perm:[1,0,3,2] row_mask:0xf bank_mask:0xf
  v_fmac_f32_dpp v230, v250, v178 quad_perm:[1,0,3,2] row_mask:0xf bank_mask:0xf
  v_fmac_f32_dpp v231, v251, v178 quad_perm:[1,0,3,2] row_mask:0xf bank_mask:0xf
  v_mfma_f32_16x16x32_bf16 v[96:99], v[160:163], a[176:179], 0
  v_lshl_add_u64 v[242:243], v[242:243], 0, s[26:27]
  global_load_ushort v208, v[242:243], off
  v_mul_f32_dpp v248, v196, v108 quad_perm:[1,1,3,3] row_mask:0xf bank_mask:0xf
  v_mul_f32_dpp v249, v197, v109 quad_perm:[1,1,3,3] row_mask:0xf bank_mask:0xf
  v_mfma_f32_16x16x32_bf16 v[96:99], v[216:219], a[208:211], v[96:99]
  v_mul_f32_dpp v250, v198, v110 quad_perm:[1,1,3,3] row_mask:0xf bank_mask:0xf
  v_mul_f32_dpp v251, v199, v111 quad_perm:[1,1,3,3] row_mask:0xf bank_mask:0xf
  v_mul_f32_dpp v232, v196, v108 quad_perm:[0,0,2,2] row_mask:0xf bank_mask:0xf
  v_mfma_f32_16x16x32_bf16 v[100:103], v[160:163], a[184:187], 0
  v_lshl_add_u64 v[242:243], v[242:243], 0, s[24:25]
  global_load_ushort v209, v[242:243], off
  v_mul_f32_dpp v233, v197, v109 quad_perm:[0,0,2,2] row_mask:0xf bank_mask:0xf
  v_mul_f32_dpp v234, v198, v110 quad_perm:[0,0,2,2] row_mask:0xf bank_mask:0xf
  v_mfma_f32_16x16x32_bf16 v[100:103], v[216:219], a[216:219], v[100:103]
  v_mul_f32_dpp v235, v199, v111 quad_perm:[0,0,2,2] row_mask:0xf bank_mask:0xf
  v_fmac_f32_dpp v232, v248, v178 quad_perm:[1,0,3,2] row_mask:0xf bank_mask:0xf
  v_fmac_f32_dpp v233, v249, v178 quad_perm:[1,0,3,2] row_mask:0xf bank_mask:0xf
  v_mfma_f32_16x16x32_bf16 v[104:107], v[160:163], a[192:195], 0
  v_lshl_add_u64 v[242:243], v[242:243], 0, s[24:25]
  global_load_ushort v210, v[242:243], off
  v_fmac_f32_dpp v234, v250, v178 quad_perm:[1,0,3,2] row_mask:0xf bank_mask:0xf
  v_fmac_f32_dpp v235, v251, v178 quad_perm:[1,0,3,2] row_mask:0xf bank_mask:0xf
  v_mfma_f32_16x16x32_bf16 v[104:107], v[216:219], a[224:227], v[104:107]
  v_cvt_pk_bf16_f32 v164, v228, v229
  v_cvt_pk_bf16_f32 v165, v230, v231
  v_cvt_pk_bf16_f32 v166, v232, v233
  v_mfma_f32_16x16x32_bf16 v[184:187], v[160:163], a[200:203], 0
  v_lshl_add_u64 v[242:243], v[242:243], 0, s[24:25]
  global_load_ushort v211, v[242:243], off
  v_cvt_pk_bf16_f32 v167, v234, v235
  v_xor_b32_dpp v252, v164, v177 quad_perm:[1,0,3,2] row_mask:0xf bank_mask:0xf
  v_mfma_f32_16x16x32_bf16 v[184:187], v[216:219], a[232:235], v[184:187]
  v_xor_b32_dpp v253, v165, v177 quad_perm:[1,0,3,2] row_mask:0xf bank_mask:0xf
  v_xor_b32_dpp v254, v166, v177 quad_perm:[1,0,3,2] row_mask:0xf bank_mask:0xf
  v_xor_b32_dpp v255, v167, v177 quad_perm:[1,0,3,2] row_mask:0xf bank_mask:0xf
  v_mfma_f32_16x16x32_bf16 v[96:99], v[164:167], a[180:183], v[96:99]
  v_lshl_add_u64 v[242:243], v[242:243], 0, s[26:27]
  global_load_ushort v212, v[242:243], off
  v_mfma_f32_16x16x32_bf16 v[96:99], v[252:255], a[212:215], v[96:99]
  v_lshl_add_u64 v[242:243], v[242:243], 0, s[24:25]
  global_load_ushort v213, v[242:243], off
  v_mfma_f32_16x16x32_bf16 v[100:103], v[164:167], a[188:191], v[100:103]
  v_lshl_add_u64 v[242:243], v[242:243], 0, s[24:25]
  global_load_ushort v214, v[242:243], off
  v_mfma_f32_16x16x32_bf16 v[100:103], v[252:255], a[220:223], v[100:103]
  v_lshl_add_u64 v[242:243], v[242:243], 0, s[24:25]
  global_load_ushort v215, v[242:243], off
  v_mfma_f32_16x16x32_bf16 v[104:107], v[164:167], a[196:199], v[104:107]
  v_mfma_f32_16x16x32_bf16 v[104:107], v[252:255], a[228:231], v[104:107]
  v_mfma_f32_16x16x32_bf16 v[184:187], v[164:167], a[204:207], v[184:187]
  s_nop 0
  v_cvt_pk_bf16_f32 v220, v96, v97
  v_cvt_pk_bf16_f32 v221, v98, v99
  v_mfma_f32_16x16x32_bf16 v[184:187], v[252:255], a[236:239], v[184:187]
  ds_write_b64 v179, v[220:221] offset:0
  v_cvt_pk_bf16_f32 v222, v100, v101
  v_cvt_pk_bf16_f32 v223, v102, v103
  ds_write_b64 v179, v[222:223] offset:2048
  v_cvt_pk_bf16_f32 v224, v104, v105
  v_cvt_pk_bf16_f32 v225, v106, v107
  ds_write_b64 v179, v[224:225] offset:4096
  s_nop 0
  v_cvt_pk_bf16_f32 v226, v184, v185
  v_cvt_pk_bf16_f32 v227, v186, v187
  ds_write_b64 v179, v[226:227] offset:6144
  s_xor_b32 s97, s30, 1
  s_mul_i32 s97, s97, 331776
  buffer_load_dword v236, v33, s[12:15], s97 offen
  v_xor_b32_dpp v216, v168, v176 quad_perm:[1,0,3,2] row_mask:0xf bank_mask:0xf
  v_xor_b32_dpp v217, v169, v176 quad_perm:[1,0,3,2] row_mask:0xf bank_mask:0xf
  v_xor_b32_dpp v218, v170, v176 quad_perm:[1,0,3,2] row_mask:0xf bank_mask:0xf
  v_xor_b32_dpp v219, v171, v176 quad_perm:[1,0,3,2] row_mask:0xf bank_mask:0xf
  v_xor_b32_dpp v252, v172, v176 quad_perm:[1,0,3,2] row_mask:0xf bank_mask:0xf
  v_xor_b32_dpp v253, v173, v176 quad_perm:[1,0,3,2] row_mask:0xf bank_mask:0xf
  v_xor_b32_dpp v254, v174, v176 quad_perm:[1,0,3,2] row_mask:0xf bank_mask:0xf
  v_xor_b32_dpp v255, v175, v176 quad_perm:[1,0,3,2] row_mask:0xf bank_mask:0xf
  v_mfma_f32_16x16x32_bf16 v[184:187], a[176:179], v[168:171], 0
  s_waitcnt vmcnt(16)
  v_lshlrev_b32 v200, 16, v200
  s_waitcnt vmcnt(15)
  v_lshlrev_b32 v201, 16, v201
  v_mfma_f32_16x16x32_bf16 v[184:187], a[208:211], v[216:219], v[184:187]
  s_waitcnt vmcnt(14)
  v_lshlrev_b32 v202, 16, v202
  s_waitcnt vmcnt(13)
  v_lshlrev_b32 v203, 16, v203
  v_mfma_f32_16x16x32_bf16 v[184:187], a[180:183], v[172:175], v[184:187]
  s_waitcnt vmcnt(12)
  v_lshlrev_b32 v204, 16, v204
  s_waitcnt vmcnt(11)
  v_lshlrev_b32 v205, 16, v205
  v_mfma_f32_16x16x32_bf16 v[184:187], a[212:215], v[252:255], v[184:187]
  s_waitcnt vmcnt(10)
  v_lshlrev_b32 v206, 16, v206
  s_waitcnt vmcnt(9)
  v_lshlrev_b32 v207, 16, v207
  v_mfma_f32_16x16x32_bf16 v[188:191], a[184:187], v[168:171], 0
  s_waitcnt vmcnt(8)
  v_lshlrev_b32 v208, 16, v208
  s_waitcnt vmcnt(7)
  v_lshlrev_b32 v209, 16, v209
  v_mfma_f32_16x16x32_bf16 v[188:191], a[216:219], v[216:219], v[188:191]
  s_waitcnt vmcnt(6)
  v_lshlrev_b32 v210, 16, v210
  s_waitcnt vmcnt(5)
  v_lshlrev_b32 v211, 16, v211
  v_mfma_f32_16x16x32_bf16 v[188:191], a[188:191], v[172:175], v[188:191]
  s_waitcnt vmcnt(4)
  v_lshlrev_b32 v212, 16, v212
  s_waitcnt vmcnt(3)
  v_lshlrev_b32 v213, 16, v213
  v_mfma_f32_16x16x32_bf16 v[188:191], a[220:223], v[252:255], v[188:191]
  s_waitcnt vmcnt(2)
  v_lshlrev_b32 v214, 16, v214
  s_waitcnt vmcnt(1)
  v_lshlrev_b32 v215, 16, v215
  v_mfma_f32_16x16x32_bf16 v[192:195], a[192:195], v[168:171], 0
  v_mul_f32_dpp v248, v200, v184 quad_perm:[1,1,3,3] row_mask:0xf bank_mask:0xf
  v_mul_f32_dpp v249, v201, v185 quad_perm:[1,1,3,3] row_mask:0xf bank_mask:0xf
  v_mul_f32_dpp v250, v202, v186 quad_perm:[1,1,3,3] row_mask:0xf bank_mask:0xf
  v_mfma_f32_16x16x32_bf16 v[192:195], a[224:227], v[216:219], v[192:195]
  v_mul_f32_dpp v251, v203, v187 quad_perm:[1,1,3,3] row_mask:0xf bank_mask:0xf
  v_mul_f32_dpp v220, v200, v184 quad_perm:[0,0,2,2] row_mask:0xf bank_mask:0xf
  v_mul_f32_dpp v221, v201, v185 quad_perm:[0,0,2,2] row_mask:0xf bank_mask:0xf
  v_mfma_f32_16x16x32_bf16 v[192:195], a[196:199], v[172:175], v[192:195]
  v_mul_f32_dpp v222, v202, v186 quad_perm:[0,0,2,2] row_mask:0xf bank_mask:0xf
  v_mul_f32_dpp v223, v203, v187 quad_perm:[0,0,2,2] row_mask:0xf bank_mask:0xf
  v_fmac_f32_dpp v220, v248, v178 quad_perm:[1,0,3,2] row_mask:0xf bank_mask:0xf
  v_mfma_f32_16x16x32_bf16 v[192:195], a[228:231], v[252:255], v[192:195]
  v_fmac_f32_dpp v221, v249, v178 quad_perm:[1,0,3,2] row_mask:0xf bank_mask:0xf
  v_fmac_f32_dpp v222, v250, v178 quad_perm:[1,0,3,2] row_mask:0xf bank_mask:0xf
  v_fmac_f32_dpp v223, v251, v178 quad_perm:[1,0,3,2] row_mask:0xf bank_mask:0xf
  v_mfma_f32_16x16x32_bf16 v[196:199], a[200:203], v[168:171], 0
  v_mul_f32_dpp v248, v204, v188 quad_perm:[1,1,3,3] row_mask:0xf bank_mask:0xf
  v_mul_f32_dpp v249, v205, v189 quad_perm:[1,1,3,3] row_mask:0xf bank_mask:0xf
  v_mul_f32_dpp v250, v206, v190 quad_perm:[1,1,3,3] row_mask:0xf bank_mask:0xf
  v_mfma_f32_16x16x32_bf16 v[196:199], a[232:235], v[216:219], v[196:199]
  v_mul_f32_dpp v251, v207, v191 quad_perm:[1,1,3,3] row_mask:0xf bank_mask:0xf
  v_mul_f32_dpp v224, v204, v188 quad_perm:[0,0,2,2] row_mask:0xf bank_mask:0xf
  v_mul_f32_dpp v225, v205, v189 quad_perm:[0,0,2,2] row_mask:0xf bank_mask:0xf
  v_mfma_f32_16x16x32_bf16 v[196:199], a[204:207], v[172:175], v[196:199]
  v_mul_f32_dpp v226, v206, v190 quad_perm:[0,0,2,2] row_mask:0xf bank_mask:0xf
  v_mul_f32_dpp v227, v207, v191 quad_perm:[0,0,2,2] row_mask:0xf bank_mask:0xf
  v_fmac_f32_dpp v224, v248, v178 quad_perm:[1,0,3,2] row_mask:0xf bank_mask:0xf
  v_mfma_f32_16x16x32_bf16 v[196:199], a[236:239], v[252:255], v[196:199]
  v_fmac_f32_dpp v225, v249, v178 quad_perm:[1,0,3,2] row_mask:0xf bank_mask:0xf
  v_fmac_f32_dpp v226, v250, v178 quad_perm:[1,0,3,2] row_mask:0xf bank_mask:0xf
  v_fmac_f32_dpp v227, v251, v178 quad_perm:[1,0,3,2] row_mask:0xf bank_mask:0xf
  v_cvt_pk_bf16_f32 v168, v220, v221
  v_cvt_pk_bf16_f32 v169, v222, v223
  v_cvt_pk_bf16_f32 v170, v224, v225
  v_cvt_pk_bf16_f32 v171, v226, v227
  v_mul_f32_dpp v248, v208, v192 quad_perm:[1,1,3,3] row_mask:0xf bank_mask:0xf
  v_mul_f32_dpp v249, v209, v193 quad_perm:[1,1,3,3] row_mask:0xf bank_mask:0xf
  v_mul_f32_dpp v250, v210, v194 quad_perm:[1,1,3,3] row_mask:0xf bank_mask:0xf
  v_mul_f32_dpp v251, v211, v195 quad_perm:[1,1,3,3] row_mask:0xf bank_mask:0xf
  v_xor_b32_dpp v216, v168, v177 quad_perm:[1,0,3,2] row_mask:0xf bank_mask:0xf
  v_xor_b32_dpp v217, v169, v177 quad_perm:[1,0,3,2] row_mask:0xf bank_mask:0xf
  v_xor_b32_dpp v218, v170, v177 quad_perm:[1,0,3,2] row_mask:0xf bank_mask:0xf
  v_xor_b32_dpp v219, v171, v177 quad_perm:[1,0,3,2] row_mask:0xf bank_mask:0xf
  v_mul_f32_dpp v228, v208, v192 quad_perm:[0,0,2,2] row_mask:0xf bank_mask:0xf
  v_mul_f32_dpp v229, v209, v193 quad_perm:[0,0,2,2] row_mask:0xf bank_mask:0xf
  v_mul_f32_dpp v230, v210, v194 quad_perm:[0,0,2,2] row_mask:0xf bank_mask:0xf
  v_mul_f32_dpp v231, v211, v195 quad_perm:[0,0,2,2] row_mask:0xf bank_mask:0xf
  v_fmac_f32_dpp v228, v248, v178 quad_perm:[1,0,3,2] row_mask:0xf bank_mask:0xf
  v_fmac_f32_dpp v229, v249, v178 quad_perm:[1,0,3,2] row_mask:0xf bank_mask:0xf
  v_fmac_f32_dpp v230, v250, v178 quad_perm:[1,0,3,2] row_mask:0xf bank_mask:0xf
  v_fmac_f32_dpp v231, v251, v178 quad_perm:[1,0,3,2] row_mask:0xf bank_mask:0xf
  v_mfma_f32_16x16x32_bf16 v[184:187], v[168:171], a[176:179], 0
  v_mul_f32_dpp v248, v212, v196 quad_perm:[1,1,3,3] row_mask:0xf bank_mask:0xf
  v_mul_f32_dpp v249, v213, v197 quad_perm:[1,1,3,3] row_mask:0xf bank_mask:0xf
  v_mfma_f32_16x16x32_bf16 v[184:187], v[216:219], a[208:211], v[184:187]
  v_mul_f32_dpp v250, v214, v198 quad_perm:[1,1,3,3] row_mask:0xf bank_mask:0xf
  v_mul_f32_dpp v251, v215, v199 quad_perm:[1,1,3,3] row_mask:0xf bank_mask:0xf
  v_mul_f32_dpp v232, v212, v196 quad_perm:[0,0,2,2] row_mask:0xf bank_mask:0xf
  v_mfma_f32_16x16x32_bf16 v[188:191], v[168:171], a[184:187], 0
  v_mul_f32_dpp v233, v213, v197 quad_perm:[0,0,2,2] row_mask:0xf bank_mask:0xf
  v_mul_f32_dpp v234, v214, v198 quad_perm:[0,0,2,2] row_mask:0xf bank_mask:0xf
  v_mfma_f32_16x16x32_bf16 v[188:191], v[216:219], a[216:219], v[188:191]
  v_mul_f32_dpp v235, v215, v199 quad_perm:[0,0,2,2] row_mask:0xf bank_mask:0xf
  v_fmac_f32_dpp v232, v248, v178 quad_perm:[1,0,3,2] row_mask:0xf bank_mask:0xf
  v_fmac_f32_dpp v233, v249, v178 quad_perm:[1,0,3,2] row_mask:0xf bank_mask:0xf
  v_mfma_f32_16x16x32_bf16 v[192:195], v[168:171], a[192:195], 0
  v_fmac_f32_dpp v234, v250, v178 quad_perm:[1,0,3,2] row_mask:0xf bank_mask:0xf
  v_fmac_f32_dpp v235, v251, v178 quad_perm:[1,0,3,2] row_mask:0xf bank_mask:0xf
  v_mfma_f32_16x16x32_bf16 v[192:195], v[216:219], a[224:227], v[192:195]
  v_cvt_pk_bf16_f32 v172, v228, v229
  v_cvt_pk_bf16_f32 v173, v230, v231
  v_cvt_pk_bf16_f32 v174, v232, v233
  v_mfma_f32_16x16x32_bf16 v[200:203], v[168:171], a[200:203], 0
  v_cvt_pk_bf16_f32 v175, v234, v235
  v_xor_b32_dpp v252, v172, v177 quad_perm:[1,0,3,2] row_mask:0xf bank_mask:0xf
  v_mfma_f32_16x16x32_bf16 v[200:203], v[216:219], a[232:235], v[200:203]
  v_xor_b32_dpp v253, v173, v177 quad_perm:[1,0,3,2] row_mask:0xf bank_mask:0xf
  v_xor_b32_dpp v254, v174, v177 quad_perm:[1,0,3,2] row_mask:0xf bank_mask:0xf
  v_xor_b32_dpp v255, v175, v177 quad_perm:[1,0,3,2] row_mask:0xf bank_mask:0xf
  v_mfma_f32_16x16x32_bf16 v[184:187], v[172:175], a[180:183], v[184:187]
  s_nop 0
  v_mfma_f32_16x16x32_bf16 v[184:187], v[252:255], a[212:215], v[184:187]
  v_mfma_f32_16x16x32_bf16 v[188:191], v[172:175], a[188:191], v[188:191]
  v_mfma_f32_16x16x32_bf16 v[188:191], v[252:255], a[220:223], v[188:191]
  v_mfma_f32_16x16x32_bf16 v[192:195], v[172:175], a[196:199], v[192:195]
  v_mfma_f32_16x16x32_bf16 v[192:195], v[252:255], a[228:231], v[192:195]
  v_mfma_f32_16x16x32_bf16 v[200:203], v[172:175], a[204:207], v[200:203]
  s_nop 0
  s_nop 1
  v_cvt_pk_bf16_f32 v220, v184, v185
  v_cvt_pk_bf16_f32 v221, v186, v187
  v_mfma_f32_16x16x32_bf16 v[200:203], v[252:255], a[236:239], v[200:203]
  ds_write_b64 v179, v[220:221] offset:8192
  v_cvt_pk_bf16_f32 v222, v188, v189
  v_cvt_pk_bf16_f32 v223, v190, v191
  ds_write_b64 v179, v[222:223] offset:10240
  v_cvt_pk_bf16_f32 v224, v192, v193
  v_cvt_pk_bf16_f32 v225, v194, v195
  ds_write_b64 v179, v[224:225] offset:12288
  s_nop 0
  v_cvt_pk_bf16_f32 v226, v200, v201
  v_cvt_pk_bf16_f32 v227, v202, v203
  ds_write_b64 v179, v[226:227] offset:14336
L_p2b:
  s_lshr_b32 s92, 4352, s30
  s_bitcmp1_b32 s92, 0
  s_cbranch_scc0 L_p2c
  s_xor_b32 s97, s30, 1
  s_mul_i32 s97, s97, 331776
  s_waitcnt vmcnt(0)
  buffer_load_dword v236, v33, s[12:15], s97 offen
L_p2c:
  s_lshr_b32 s92, 4352, s30
  s_bitcmp0_b32 s92, 0
  s_cselect_b32 s92, 0, 1
  s_or_b32 s92, s92, s85
  s_cmp_eq_u32 s92, 0
  s_cbranch_scc0 L_p2a
  s_xor_b32 s97, s30, 1
  s_mul_i32 s97, s97, 331776
  s_waitcnt vmcnt(0)
  buffer_load_dword v236, v33, s[12:15], s97 offen
  v_xor_b32_dpp v216, v160, v176 quad_perm:[1,0,3,2] row_mask:0xf bank_mask:0xf
  v_xor_b32_dpp v217, v161, v176 quad_perm:[1,0,3,2] row_mask:0xf bank_mask:0xf
  v_xor_b32_dpp v218, v162, v176 quad_perm:[1,0,3,2] row_mask:0xf bank_mask:0xf
  v_xor_b32_dpp v219, v163, v176 quad_perm:[1,0,3,2] row_mask:0xf bank_mask:0xf
  v_xor_b32_dpp v252, v164, v176 quad_perm:[1,0,3,2] row_mask:0xf bank_mask:0xf
  v_xor_b32_dpp v253, v165, v176 quad_perm:[1,0,3,2] row_mask:0xf bank_mask:0xf
  v_xor_b32_dpp v254, v166, v176 quad_perm:[1,0,3,2] row_mask:0xf bank_mask:0xf
  v_xor_b32_dpp v255, v167, v176 quad_perm:[1,0,3,2] row_mask:0xf bank_mask:0xf
  v_mfma_f32_16x16x32_bf16 v[96:99], a[176:179], v[160:163], 0
  v_lshlrev_b32 v184, 16, v184
  v_lshlrev_b32 v185, 16, v185
  v_mfma_f32_16x16x32_bf16 v[96:99], a[208:211], v[216:219], v[96:99]
  v_lshlrev_b32 v186, 16, v186
  v_lshlrev_b32 v187, 16, v187
  v_mfma_f32_16x16x32_bf16 v[96:99], a[180:183], v[164:167], v[96:99]
  v_lshlrev_b32 v188, 16, v188
  v_lshlrev_b32 v189, 16, v189
  v_mfma_f32_16x16x32_bf16 v[96:99], a[212:215], v[252:255], v[96:99]
  v_lshlrev_b32 v190, 16, v190
  v_lshlrev_b32 v191, 16, v191
  v_mfma_f32_16x16x32_bf16 v[100:103], a[184:187], v[160:163], 0
  v_lshlrev_b32 v192, 16, v192
  v_lshlrev_b32 v193, 16, v193
  v_mfma_f32_16x16x32_bf16 v[100:103], a[216:219], v[216:219], v[100:103]
  v_lshlrev_b32 v194, 16, v194
  v_lshlrev_b32 v195, 16, v195
  v_mfma_f32_16x16x32_bf16 v[100:103], a[188:191], v[164:167], v[100:103]
  v_lshlrev_b32 v196, 16, v196
  v_lshlrev_b32 v197, 16, v197
  v_mfma_f32_16x16x32_bf16 v[100:103], a[220:223], v[252:255], v[100:103]
  v_lshlrev_b32 v198, 16, v198
  v_lshlrev_b32 v199, 16, v199
  v_mfma_f32_16x16x32_bf16 v[104:107], a[192:195], v[160:163], 0
  v_mul_f32_dpp v248, v184, v96 quad_perm:[1,1,3,3] row_mask:0xf bank_mask:0xf
  v_mul_f32_dpp v249, v185, v97 quad_perm:[1,1,3,3] row_mask:0xf bank_mask:0xf
  v_mul_f32_dpp v250, v186, v98 quad_perm:[1,1,3,3] row_mask:0xf bank_mask:0xf
  v_mfma_f32_16x16x32_bf16 v[104:107], a[224:227], v[216:219], v[104:107]
  v_mul_f32_dpp v251, v187, v99 quad_perm:[1,1,3,3] row_mask:0xf bank_mask:0xf
  v_mul_f32_dpp v220, v184, v96 quad_perm:[0,0,2,2] row_mask:0xf bank_mask:0xf
  v_mul_f32_dpp v221, v185, v97 quad_perm:[0,0,2,2] row_mask:0xf bank_mask:0xf
  v_mfma_f32_16x16x32_bf16 v[104:107], a[196:199], v[164:167], v[104:107]
  v_mul_f32_dpp v222, v186, v98 quad_perm:[0,0,2,2] row_mask:0xf bank_mask:0xf
  v_mul_f32_dpp v223, v187, v99 quad_perm:[0,0,2,2] row_mask:0xf bank_mask:0xf
  v_fmac_f32_dpp v220, v248, v178 quad_perm:[1,0,3,2] row_mask:0xf bank_mask:0xf
  v_mfma_f32_16x16x32_bf16 v[104:107], a[228:231], v[252:255], v[104:107]
  v_fmac_f32_dpp v221, v249, v178 quad_perm:[1,0,3,2] row_mask:0xf bank_mask:0xf
  v_fmac_f32_dpp v222, v250, v178 quad_perm:[1,0,3,2] row_mask:0xf bank_mask:0xf
  v_fmac_f32_dpp v223, v251, v178 quad_perm:[1,0,3,2] row_mask:0xf bank_mask:0xf
  v_mfma_f32_16x16x32_bf16 v[108:111], a[200:203], v[160:163], 0
  v_mul_f32_dpp v248, v188, v100 quad_perm:[1,1,3,3] row_mask:0xf bank_mask:0xf
  v_mul_f32_dpp v249, v189, v101 quad_perm:[1,1,3,3] row_mask:0xf bank_mask:0xf
  v_mul_f32_dpp v250, v190, v102 quad_perm:[1,1,3,3] row_mask:0xf bank_mask:0xf
  v_mfma_f32_16x16x32_bf16 v[108:111], a[232:235], v[216:219], v[108:111]
  v_mul_f32_dpp v251, v191, v103 quad_perm:[1,1,3,3] row_mask:0xf bank_mask:0xf
  v_mul_f32_dpp v224, v188, v100 quad_perm:[0,0,2,2] row_mask:0xf bank_mask:0xf
  v_mul_f32_dpp v225, v189, v101 quad_perm:[0,0,2,2] row_mask:0xf bank_mask:0xf
  v_mfma_f32_16x16x32_bf16 v[108:111], a[204:207], v[164:167], v[108:111]
  v_mul_f32_dpp v226, v190, v102 quad_perm:[0,0,2,2] row_mask:0xf bank_mask:0xf
  v_mul_f32_dpp v227, v191, v103 quad_perm:[0,0,2,2] row_mask:0xf bank_mask:0xf
  v_fmac_f32_dpp v224, v248, v178 quad_perm:[1,0,3,2] row_mask:0xf bank_mask:0xf
  v_mfma_f32_16x16x32_bf16 v[108:111], a[236:239], v[252:255], v[108:111]
  v_fmac_f32_dpp v225, v249, v178 quad_perm:[1,0,3,2] row_mask:0xf bank_mask:0xf
  v_fmac_f32_dpp v226, v250, v178 quad_perm:[1,0,3,2] row_mask:0xf bank_mask:0xf
  v_fmac_f32_dpp v227, v251, v178 quad_perm:[1,0,3,2] row_mask:0xf bank_mask:0xf
  v_cvt_pk_bf16_f32 v160, v220, v221
  v_cvt_pk_bf16_f32 v161, v222, v223
  v_cvt_pk_bf16_f32 v162, v224, v225
  v_cvt_pk_bf16_f32 v163, v226, v227
  v_mul_f32_dpp v248, v192, v104 quad_perm:[1,1,3,3] row_mask:0xf bank_mask:0xf
  v_mul_f32_dpp v249, v193, v105 quad_perm:[1,1,3,3] row_mask:0xf bank_mask:0xf
  v_mul_f32_dpp v250, v194, v106 quad_perm:[1,1,3,3] row_mask:0xf bank_mask:0xf
  v_mul_f32_dpp v251, v195, v107 quad_perm:[1,1,3,3] row_mask:0xf bank_mask:0xf
  v_xor_b32_dpp v216, v160, v177 quad_perm:[1,0,3,2] row_mask:0xf bank_mask:0xf
  v_xor_b32_dpp v217, v161, v177 quad_perm:[1,0,3,2] row_mask:0xf bank_mask:0xf
  v_xor_b32_dpp v218, v162, v177 quad_perm:[1,0,3,2] row_mask:0xf bank_mask:0xf
  v_xor_b32_dpp v219, v163, v177 quad_perm:[1,0,3,2] row_mask:0xf bank_mask:0xf
  v_mul_f32_dpp v228, v192, v104 quad_perm:[0,0,2,2] row_mask:0xf bank_mask:0xf
  v_mul_f32_dpp v229, v193, v105 quad_perm:[0,0,2,2] row_mask:0xf bank_mask:0xf
  v_mul_f32_dpp v230, v194, v106 quad_perm:[0,0,2,2] row_mask:0xf bank_mask:0xf
  v_mul_f32_dpp v231, v195, v107 quad_perm:[0,0,2,2] row_mask:0xf bank_mask:0xf
  v_fmac_f32_dpp v228, v248, v178 quad_perm:[1,0,3,2] row_mask:0xf bank_mask:0xf
  v_fmac_f32_dpp v229, v249, v178 quad_perm:[1,0,3,2] row_mask:0xf bank_mask:0xf
  v_fmac_f32_dpp v230, v250, v178 quad_perm:[1,0,3,2] row_mask:0xf bank_mask:0xf
  v_fmac_f32_dpp v231, v251, v178 quad_perm:[1,0,3,2] row_mask:0xf bank_mask:0xf
  v_mfma_f32_16x16x32_bf16 v[96:99], v[160:163], a[176:179], 0
  v_mul_f32_dpp v248, v196, v108 quad_perm:[1,1,3,3] row_mask:0xf bank_mask:0xf
  v_mul_f32_dpp v249, v197, v109 quad_perm:[1,1,3,3] row_mask:0xf bank_mask:0xf
  v_mfma_f32_16x16x32_bf16 v[96:99], v[216:219], a[208:211], v[96:99]
  v_mul_f32_dpp v250, v198, v110 quad_perm:[1,1,3,3] row_mask:0xf bank_mask:0xf
  v_mul_f32_dpp v251, v199, v111 quad_perm:[1,1,3,3] row_mask:0xf bank_mask:0xf
  v_mul_f32_dpp v232, v196, v108 quad_perm:[0,0,2,2] row_mask:0xf bank_mask:0xf
  v_mfma_f32_16x16x32_bf16 v[100:103], v[160:163], a[184:187], 0
  v_mul_f32_dpp v233, v197, v109 quad_perm:[0,0,2,2] row_mask:0xf bank_mask:0xf
  v_mul_f32_dpp v234, v198, v110 quad_perm:[0,0,2,2] row_mask:0xf bank_mask:0xf
  v_mfma_f32_16x16x32_bf16 v[100:103], v[216:219], a[216:219], v[100:103]
  v_mul_f32_dpp v235, v199, v111 quad_perm:[0,0,2,2] row_mask:0xf bank_mask:0xf
  v_fmac_f32_dpp v232, v248, v178 quad_perm:[1,0,3,2] row_mask:0xf bank_mask:0xf
  v_fmac_f32_dpp v233, v249, v178 quad_perm:[1,0,3,2] row_mask:0xf bank_mask:0xf
  v_mfma_f32_16x16x32_bf16 v[104:107], v[160:163], a[192:195], 0
  v_fmac_f32_dpp v234, v250, v178 quad_perm:[1,0,3,2] row_mask:0xf bank_mask:0xf
  v_fmac_f32_dpp v235, v251, v178 quad_perm:[1,0,3,2] row_mask:0xf bank_mask:0xf
  v_mfma_f32_16x16x32_bf16 v[104:107], v[216:219], a[224:227], v[104:107]
  v_cvt_pk_bf16_f32 v164, v228, v229
  v_cvt_pk_bf16_f32 v165, v230, v231
  v_cvt_pk_bf16_f32 v166, v232, v233
  v_mfma_f32_16x16x32_bf16 v[184:187], v[160:163], a[200:203], 0
  v_cvt_pk_bf16_f32 v167, v234, v235
  v_xor_b32_dpp v252, v164, v177 quad_perm:[1,0,3,2] row_mask:0xf bank_mask:0xf
  v_mfma_f32_16x16x32_bf16 v[184:187], v[216:219], a[232:235], v[184:187]
  v_xor_b32_dpp v253, v165, v177 quad_perm:[1,0,3,2] row_mask:0xf bank_mask:0xf
  v_xor_b32_dpp v254, v166, v177 quad_perm:[1,0,3,2] row_mask:0xf bank_mask:0xf
  v_xor_b32_dpp v255, v167, v177 quad_perm:[1,0,3,2] row_mask:0xf bank_mask:0xf
  v_mfma_f32_16x16x32_bf16 v[96:99], v[164:167], a[180:183], v[96:99]
  s_nop 0
  v_mfma_f32_16x16x32_bf16 v[96:99], v[252:255], a[212:215], v[96:99]
  v_mfma_f32_16x16x32_bf16 v[100:103], v[164:167], a[188:191], v[100:103]
  v_mfma_f32_16x16x32_bf16 v[100:103], v[252:255], a[220:223], v[100:103]
  v_mfma_f32_16x16x32_bf16 v[104:107], v[164:167], a[196:199], v[104:107]
  v_mfma_f32_16x16x32_bf16 v[104:107], v[252:255], a[228:231], v[104:107]
  v_mfma_f32_16x16x32_bf16 v[184:187], v[164:167], a[204:207], v[184:187]
  s_nop 0
  s_nop 1
  v_cvt_pk_bf16_f32 v220, v96, v97
  v_cvt_pk_bf16_f32 v221, v98, v99
  v_mfma_f32_16x16x32_bf16 v[184:187], v[252:255], a[236:239], v[184:187]
  ds_write_b64 v179, v[220:221] offset:0
  v_cvt_pk_bf16_f32 v222, v100, v101
  v_cvt_pk_bf16_f32 v223, v102, v103
  ds_write_b64 v179, v[222:223] offset:2048
  v_cvt_pk_bf16_f32 v224, v104, v105
  v_cvt_pk_bf16_f32 v225, v106, v107
  ds_write_b64 v179, v[224:225] offset:4096
  s_nop 0
  v_cvt_pk_bf16_f32 v226, v184, v185
  v_cvt_pk_bf16_f32 v227, v186, v187
  ds_write_b64 v179, v[226:227] offset:6144
L_p2a:
  s_waitcnt vmcnt(21)
  v_lshrrev_b32 v161, 4, v1
  s_mul_i32 s93, s28, 16
  v_add_u32 v161, s93, v161
  s_waitcnt vmcnt(20)
  v_and_b32 v162, 15, v1
  v_lshlrev_b32 v160, 7, v161
  v_lshl_add_u32 v160, v162, 3, v160
  v_xor_b32 v162, v162, v161
  v_and_b32 v162, 15, v162
  v_lshlrev_b32 v162, 3, v162
  v_lshl_add_u32 v161, v161, 7, v162
  v_xor_b32 v162, 32, v161
  v_xor_b32 v163, 64, v161
  s_waitcnt vmcnt(19)
  v_xor_b32 v164, 96, v161
  s_lshl_b32 s87, s78, 16
  s_lshl_b32 s88, s39, 13
  s_add_u32 s87, s87, s88
  s_add_u32 s87, s87, 2097152
  s_lshr_b32 s92, 4352, s30
  s_bitcmp0_b32 s92, 0
  s_cselect_b32 s87, s87, 1073741824
  s_waitcnt lgkmcnt(0)
  s_barrier
  ds_read_b64_tr_b16 v[168:169], v161 offset:0
  ds_read_b64_tr_b16 v[170:171], v162 offset:512
  ds_read_b64_tr_b16 v[172:173], v163 offset:1024
  ds_read_b64_tr_b16 v[174:175], v164 offset:1536
  v_mfma_f32_32x32x16_bf16 v[128:143], a[156:159], a[124:127], v[128:143]
  s_and_b32 s55, s31, 1
  ds_read_b64_tr_b16 a[152:153], v12 offset:28672
  ds_read_b64_tr_b16 a[154:155], v12 offset:29184
  v_rcp_f32 v38, v38
  v_rcp_f32 v39, v39
  v_mfma_f32_32x32x16_bf16 v[128:143], a[160:163], a[128:131], v[128:143]
  s_add_u32 s97, s80, 8192
  ds_read_b64_tr_b16 a[156:157], v12 offset:30720
  ds_read_b64_tr_b16 a[158:159], v12 offset:31232
  buffer_store_dwordx4 v[72:75], v2, s[16:19], s97 offen sc1
  v_mfma_f32_32x32x16_bf16 v[128:143], a[164:167], a[132:135], v[128:143]
  s_lshl_b32 s55, s55, 11
  ds_read_b64_tr_b16 a[160:161], v12 offset:32768
  ds_read_b64_tr_b16 a[162:163], v12 offset:33280
  v_exp_f32 v36, v124
  v_add_f32 v34, 1.0, v34
  v_add_f32 v35, 1.0, v35
  v_mfma_f32_32x32x16_bf16 v[128:143], a[168:171], a[136:139], v[128:143]
  s_waitcnt lgkmcnt(4)
  ds_read_b64_tr_b16 a[164:165], v12 offset:34816
  ds_read_b64_tr_b16 a[166:167], v12 offset:35328
  buffer_store_dwordx2 v[168:169], v160, s[16:19], s87 offen offset:0 sc1
  v_exp_f32 v37, v125
  v_mfma_f32_32x32x16_bf16 v[128:143], a[172:175], a[140:143], v[128:143]
  s_xor_b32 s53, s55, 2048
  ds_read_b64_tr_b16 a[168:169], v12 offset:36864
  ds_read_b64_tr_b16 a[170:171], v12 offset:37376
  v_mul_f32 v120, v120, v38
  v_mul_f32 v121, v121, v39
  v_cvt_pk_bf16_f32 v83, v118, v119
  v_mfma_f32_32x32x16_bf16 v[144:159], a[144:147], a[0:3], 0
  s_add_u32 s45, s31, 2
  ds_read_b64_tr_b16 a[172:173], v12 offset:38912
  ds_read_b64_tr_b16 a[174:175], v12 offset:39424
  buffer_store_dwordx2 v[170:171], v160, s[16:19], s87 offen offset:512 sc1
  v_rcp_f32 v34, v34
  v_rcp_f32 v35, v35
  v_mfma_f32_32x32x16_bf16 v[144:159], a[148:151], a[4:7], v[144:159]
  s_and_b32 s45, s45, 6
  ds_read_b64_tr_b16 a[144:145], v12 offset:40960
  ds_read_b64_tr_b16 a[146:147], v12 offset:41472
  v_exp_f32 v38, v126
  v_add_f32 v36, 1.0, v36
  v_add_f32 v37, 1.0, v37
  v_mfma_f32_32x32x16_bf16 v[144:159], a[152:155], a[8:11], v[144:159]
  s_waitcnt lgkmcnt(4)
  ds_read_b64_tr_b16 a[148:149], v12 offset:43008
  ds_read_b64_tr_b16 a[150:151], v12 offset:43520
  buffer_store_dwordx2 v[172:173], v160, s[16:19], s87 offen offset:1024 sc1
  v_exp_f32 v39, v127
  v_mfma_f32_32x32x16_bf16 v[144:159], a[156:159], a[12:15], v[144:159]
  s_lshl_b32 s45, s45, 11
  ds_read_b64_tr_b16 a[152:153], v12 offset:45056
  ds_read_b64_tr_b16 a[154:155], v12 offset:45568
  v_mul_f32 v122, v122, v34
  v_mul_f32 v123, v123, v35
  v_cvt_pk_bf16_f32 v84, v120, v121
  v_mfma_f32_32x32x16_bf16 v[144:159], a[160:163], a[16:19], v[144:159]
  s_add_u32 s45, s45, s81
  ds_read_b64_tr_b16 a[156:157], v12 offset:47104
  ds_read_b64_tr_b16 a[158:159], v12 offset:47616
  buffer_store_dwordx2 v[174:175], v160, s[16:19], s87 offen offset:1536 sc1
  v_rcp_f32 v36, v36
  v_rcp_f32 v37, v37
  v_mfma_f32_32x32x16_bf16 v[144:159], a[164:167], a[20:23], v[144:159]
  s_waitcnt lgkmcnt(4)
  ds_read_b64_tr_b16 a[160:161], v13 offset:0
  ds_read_b64_tr_b16 a[162:163], v13 offset:512
  v_exp_f32 v34, v128
  v_add_f32 v38, 1.0, v38
  v_add_f32 v39, 1.0, v39
  v_mfma_f32_32x32x16_bf16 v[144:159], a[168:171], a[24:27], v[144:159]
  s_add_u32 s97, s80, 9216
  ds_read_b64_tr_b16 a[164:165], v13 offset:2048
  ds_read_b64_tr_b16 a[166:167], v13 offset:2560
  buffer_store_dwordx4 v[76:79], v2, s[16:19], s97 offen sc1
  s_cmp_eq_u32 s85, 1
  s_cbranch_scc0 L_t2b
  ds_read_b64_tr_b16 v[176:177], v161 offset:8192
  ds_read_b64_tr_b16 v[178:179], v162 offset:8704
  ds_read_b64_tr_b16 v[180:181], v163 offset:9216
  ds_read_b64_tr_b16 v[182:183], v164 offset:9728
  s_lshl_b32 s87, s79, 16
  s_lshl_b32 s88, s38, 13
  s_add_u32 s87, s87, s88
  s_add_u32 s87, s87, 2097152
  s_waitcnt lgkmcnt(3)
  buffer_store_dwordx2 v[176:177], v160, s[16:19], s87 offen offset:0 sc1
  s_waitcnt lgkmcnt(2)
  buffer_store_dwordx2 v[178:179], v160, s[16:19], s87 offen offset:512 sc1
  s_waitcnt lgkmcnt(1)
  buffer_store_dwordx2 v[180:181], v160, s[16:19], s87 offen offset:1024 sc1
  s_waitcnt lgkmcnt(0)
  buffer_store_dwordx2 v[182:183], v160, s[16:19], s87 offen offset:1536 sc1
L_t2b:
  v_mfma_f32_32x32x16_bf16 v[144:159], a[172:175], a[28:31], v[144:159]
  s_add_u32 s47, s31, 4
  ds_read_b64_tr_b16 a[168:169], v13 offset:4096
  ds_read_b64_tr_b16 a[170:171], v13 offset:4608
  v_exp_f32 v35, v129
  v_mul_f32 v124, v124, v36
  v_mul_f32 v125, v125, v37
  v_mfma_f32_32x32x16_bf16 v[144:159], a[144:147], a[32:35], v[144:159]
  s_and_b32 s47, s47, 6
  ds_read_b64_tr_b16 a[172:173], v13 offset:6144
  ds_read_b64_tr_b16 a[174:175], v13 offset:6656
  v_rcp_f32 v38, v38
  v_rcp_f32 v39, v39
  v_mfma_f32_32x32x16_bf16 v[144:159], a[148:151], a[36:39], v[144:159]
  s_waitcnt lgkmcnt(4)
  ds_read_b64_tr_b16 a[144:145], v13 offset:8192
  ds_read_b64_tr_b16 a[146:147], v13 offset:8704
  v_exp_f32 v36, v130
  v_add_f32 v34, 1.0, v34
  v_add_f32 v35, 1.0, v35
  v_mfma_f32_32x32x16_bf16 v[144:159], a[152:155], a[40:43], v[144:159]
  s_lshl_b32 s47, s47, 11
  ds_read_b64_tr_b16 a[148:149], v13 offset:10240
  ds_read_b64_tr_b16 a[150:151], v13 offset:10752
  v_exp_f32 v37, v131
  v_mul_f32 v126, v126, v38
  v_mul_f32 v127, v127, v39
  v_mfma_f32_32x32x16_bf16 v[144:159], a[156:159], a[44:47], v[144:159]
  s_add_u32 s47, s47, s81
  ds_read_b64_tr_b16 a[152:153], v13 offset:12288
  ds_read_b64_tr_b16 a[154:155], v13 offset:12800
  v_cvt_pk_bf16_f32 v85, v122, v123
  v_cvt_pk_bf16_f32 v86, v124, v125
  v_cvt_pk_bf16_f32 v87, v126, v127
  v_mfma_f32_32x32x16_bf16 v[144:159], a[160:163], a[48:51], v[144:159]
  s_add_u32 s49, s31, 6
  ds_read_b64_tr_b16 a[156:157], v13 offset:14336
  ds_read_b64_tr_b16 a[158:159], v13 offset:14848
  v_permlane16_swap_b32 v80, v84
  v_permlane16_swap_b32 v81, v85
  v_permlane16_swap_b32 v82, v86
  v_mfma_f32_32x32x16_bf16 v[144:159], a[164:167], a[52:55], v[144:159]
  s_waitcnt lgkmcnt(4)
  ds_read_b64_tr_b16 a[160:161], v13 offset:16384
  ds_read_b64_tr_b16 a[162:163], v13 offset:16896
  v_rcp_f32 v34, v34
  v_rcp_f32 v35, v35
  v_mfma_f32_32x32x16_bf16 v[144:159], a[168:171], a[56:59], v[144:159]
  s_and_b32 s49, s49, 6
  ds_read_b64_tr_b16 a[164:165], v13 offset:18432
  ds_read_b64_tr_b16 a[166:167], v13 offset:18944
  v_exp_f32 v38, v132
  v_add_f32 v36, 1.0, v36
  v_add_f32 v37, 1.0, v37
  v_mfma_f32_32x32x16_bf16 v[144:159], a[172:175], a[60:63], v[144:159]
  s_lshl_b32 s49, s49, 11
  ds_read_b64_tr_b16 a[168:169], v13 offset:20480
  ds_read_b64_tr_b16 a[170:171], v13 offset:20992
  v_exp_f32 v39, v133
  v_mul_f32 v128, v128, v34
  v_mul_f32 v129, v129, v35
  v_mfma_f32_32x32x16_bf16 v[144:159], a[144:147], a[64:67], v[144:159]
  s_add_u32 s49, s49, s81
  ds_read_b64_tr_b16 a[172:173], v13 offset:22528
  ds_read_b64_tr_b16 a[174:175], v13 offset:23040
  v_rcp_f32 v36, v36
  v_rcp_f32 v37, v37
  v_mfma_f32_32x32x16_bf16 v[144:159], a[148:151], a[68:71], v[144:159]
  s_waitcnt lgkmcnt(4)
  ds_read_b64_tr_b16 a[144:145], v13 offset:24576
  ds_read_b64_tr_b16 a[146:147], v13 offset:25088
  v_exp_f32 v34, v134
  v_add_f32 v38, 1.0, v38
  v_add_f32 v39, 1.0, v39
  v_mfma_f32_32x32x16_bf16 v[144:159], a[152:155], a[72:75], v[144:159]
  s_add_u32 s51, s31, 8
  ds_read_b64_tr_b16 a[148:149], v13 offset:26624
  ds_read_b64_tr_b16 a[150:151], v13 offset:27136
  v_exp_f32 v35, v135
  v_mul_f32 v130, v130, v36
  v_mul_f32 v131, v131, v37
  v_mfma_f32_32x32x16_bf16 v[144:159], a[156:159], a[76:79], v[144:159]
  s_and_b32 s51, s51, 6
  ds_read_b64_tr_b16 a[152:153], v13 offset:28672
  ds_read_b64_tr_b16 a[154:155], v13 offset:29184
  v_permlane16_swap_b32 v83, v87
  v_cvt_pk_bf16_f32 v88, v128, v129
  v_cvt_pk_bf16_f32 v89, v130, v131
  v_mfma_f32_32x32x16_bf16 v[144:159], a[160:163], a[80:83], v[144:159]
  s_lshl_b32 s51, s51, 11
  ds_read_b64_tr_b16 a[156:157], v13 offset:30720
  ds_read_b64_tr_b16 a[158:159], v13 offset:31232
  v_rcp_f32 v38, v38
  v_rcp_f32 v39, v39
  v_mfma_f32_32x32x16_bf16 v[144:159], a[164:167], a[84:87], v[144:159]
  s_waitcnt lgkmcnt(4)
  ds_read_b64_tr_b16 a[160:161], v13 offset:32768
  ds_read_b64_tr_b16 a[162:163], v13 offset:33280
  v_exp_f32 v36, v136
  v_add_f32 v34, 1.0, v34
  v_add_f32 v35, 1.0, v35
  v_mfma_f32_32x32x16_bf16 v[144:159], a[168:171], a[88:91], v[144:159]
  s_add_u32 s51, s51, s81
  ds_read_b64_tr_b16 a[164:165], v13 offset:34816
  ds_read_b64_tr_b16 a[166:167], v13 offset:35328
  v_exp_f32 v37, v137
  v_mul_f32 v132, v132, v38
  v_mul_f32 v133, v133, v39
  v_mfma_f32_32x32x16_bf16 v[144:159], a[172:175], a[92:95], v[144:159]
  ds_read_b64_tr_b16 a[168:169], v13 offset:36864
  ds_read_b64_tr_b16 a[170:171], v13 offset:37376
  v_rcp_f32 v34, v34
  v_rcp_f32 v35, v35
  v_mfma_f32_32x32x16_bf16 v[144:159], a[144:147], a[96:99], v[144:159]
  s_waitcnt vmcnt(13)
  s_barrier
  ds_read_b64_tr_b16 a[172:173], v13 offset:38912
  ds_read_b64_tr_b16 a[174:175], v13 offset:39424
  v_exp_f32 v38, v138
  v_add_f32 v36, 1.0, v36
  v_add_f32 v37, 1.0, v37
  v_mfma_f32_32x32x16_bf16 v[144:159], a[148:151], a[100:103], v[144:159]
  s_waitcnt lgkmcnt(4)
  s_add_u32 m0, s36, 90112
  ds_read_b64_tr_b16 a[144:145], v13 offset:40960
  ds_read_b64_tr_b16 a[146:147], v13 offset:41472
  buffer_load_dwordx4 v4, s[12:15], s58 offen lds
  v_exp_f32 v39, v139
  v_mfma_f32_32x32x16_bf16 v[144:159], a[152:155], a[104:107], v[144:159]
  ds_read_b64_tr_b16 a[148:149], v13 offset:43008
  ds_read_b64_tr_b16 a[150:151], v13 offset:43520
  v_mul_f32 v134, v134, v34
  v_mul_f32 v135, v135, v35
  v_cvt_pk_bf16_f32 v90, v132, v133
  s_lshr_b32 s99, s31, 1
  s_add_u32 s99, s99, 3
  s_and_b32 s99, s99, 3
  s_cmp_eq_u32 s99, 3
  s_cselect_b32 s99, -3, 1
  s_lshl_b32 s99, s99, 7
  v_add_u32 v33, s99, v5
  v_mfma_f32_32x32x16_bf16 v[144:159], a[156:159], a[108:111], v[144:159]
  ds_read_b64_tr_b16 a[152:153], v13 offset:45056
  ds_read_b64_tr_b16 a[154:155], v13 offset:45568
  v_rcp_f32 v36, v36
  v_rcp_f32 v37, v37
  v_mfma_f32_32x32x16_bf16 v[144:159], a[160:163], a[112:115], v[144:159]
  s_add_u32 m0, s36, 94208
  ds_read_b64_tr_b16 a[156:157], v13 offset:47104
  ds_read_b64_tr_b16 a[158:159], v13 offset:47616
  buffer_load_dwordx4 v4, s[12:15], s59 offen lds
  v_exp_f32 v34, v140
  v_mfma_f32_32x32x16_bf16 v[144:159], a[164:167], a[116:119], v[144:159]
  s_waitcnt lgkmcnt(4)
  ds_read_b64_tr_b16 a[160:161], v14 offset:0
  ds_read_b64_tr_b16 a[162:163], v14 offset:256
  v_add_f32 v38, 1.0, v38
  v_add_f32 v39, 1.0, v39
  v_cvt_pk_bf16_f32 v91, v134, v135
  v_mfma_f32_32x32x16_bf16 v[144:159], a[168:171], a[120:123], v[144:159]
  ds_read_b64_tr_b16 a[164:165], v14 offset:1024
  ds_read_b64_tr_b16 a[166:167], v14 offset:1280
  v_exp_f32 v35, v141
  v_mul_f32 v136, v136, v36
  v_mul_f32 v137, v137, v37
  v_mfma_f32_32x32x16_bf16 v[144:159], a[172:175], a[124:127], v[144:159]
  ds_read_b64_tr_b16 a[168:169], v14 offset:2048
  ds_read_b64_tr_b16 a[170:171], v14 offset:2304
  v_rcp_f32 v38, v38
  v_rcp_f32 v39, v39
  v_mfma_f32_32x32x16_bf16 v[144:159], a[144:147], a[128:131], v[144:159]
  s_add_u32 m0, s36, 98304
  ds_read_b64_tr_b16 a[172:173], v14 offset:3072
  ds_read_b64_tr_b16 a[174:175], v14 offset:3328
  buffer_load_dwordx4 v4, s[12:15], s60 offen lds
  v_exp_f32 v36, v142
  v_mfma_f32_32x32x16_bf16 v[144:159], a[148:151], a[132:135], v[144:159]
  s_waitcnt lgkmcnt(4)
  ds_read_b64_tr_b16 a[144:145], v14 offset:4096
  ds_read_b64_tr_b16 a[146:147], v14 offset:4352
  v_add_f32 v34, 1.0, v34
  v_add_f32 v35, 1.0, v35
  v_cvt_pk_bf16_f32 v92, v136, v137
  v_mfma_f32_32x32x16_bf16 v[144:159], a[152:155], a[136:139], v[144:159]
  ds_read_b64_tr_b16 a[148:149], v14 offset:5120
  ds_read_b64_tr_b16 a[150:151], v14 offset:5376
  v_exp_f32 v37, v143
  v_mul_f32 v138, v138, v38
  v_mul_f32 v139, v139, v39
  v_mfma_f32_32x32x16_bf16 v[144:159], a[156:159], a[140:143], v[144:159]
  s_add_u32 m0, s36, 102400
  ds_read_b64_tr_b16 a[152:153], v14 offset:6144
  ds_read_b64_tr_b16 a[154:155], v14 offset:6400
  buffer_load_dwordx4 v4, s[12:15], s61 offen lds
  v_rcp_f32 v34, v34
  v_mfma_f32_32x32x16_bf16 v[112:127], a[160:163], a[0:3], 0
  ds_read_b64_tr_b16 a[156:157], v14 offset:7168
  ds_read_b64_tr_b16 a[158:159], v14 offset:7424
  v_rcp_f32 v35, v35
  v_add_f32 v36, 1.0, v36
  v_add_f32 v37, 1.0, v37
  v_mfma_f32_32x32x16_bf16 v[112:127], a[164:167], a[4:7], v[112:127]
  s_waitcnt lgkmcnt(4)
  ds_read_b64_tr_b16 a[160:161], v14 offset:8192
  ds_read_b64_tr_b16 a[162:163], v14 offset:8448
  v_mul_f32 v140, v140, v34
  v_mul_f32 v141, v141, v35
  v_cvt_pk_bf16_f32 v93, v138, v139
  v_mfma_f32_32x32x16_bf16 v[112:127], a[168:171], a[8:11], v[112:127]
  ds_read_b64_tr_b16 a[164:165], v14 offset:9216
  ds_read_b64_tr_b16 a[166:167], v14 offset:9472
  v_rcp_f32 v36, v36
  v_rcp_f32 v37, v37
  v_mfma_f32_32x32x16_bf16 v[112:127], a[172:175], a[12:15], v[112:127]
  s_add_u32 m0, s36, 106496
  ds_read_b64_tr_b16 a[168:169], v14 offset:10240
  ds_read_b64_tr_b16 a[170:171], v14 offset:10496
  buffer_load_dwordx4 v4, s[12:15], s62 offen lds
  v_exp_f32 v38, v144
  v_mfma_f32_32x32x16_bf16 v[112:127], a[144:147], a[16:19], v[112:127]
  s_waitcnt lgkmcnt(4)
  ds_read_b64_tr_b16 a[172:173], v14 offset:11264
  ds_read_b64_tr_b16 a[174:175], v14 offset:11520
  v_exp_f32 v39, v145
  v_mul_f32 v142, v142, v36
  v_mul_f32 v143, v143, v37
  v_mfma_f32_32x32x16_bf16 v[112:127], a[148:151], a[20:23], v[112:127]
  s_waitcnt vmcnt(11)
  s_waitcnt vmcnt(5)
  s_barrier
  ds_read_b64_tr_b16 a[144:145], v14 offset:12288
  ds_read_b64_tr_b16 a[146:147], v14 offset:12544
  v_exp_f32 v34, v146
  v_add_f32 v38, 1.0, v38
  v_add_f32 v39, 1.0, v39
  s_lshr_b32 s92, 4352, s30
  s_bitcmp0_b32 s92, 0
  s_cbranch_scc0 L_f2a
  s_lshl_b32 s93, s78, 3
  s_add_u32 s93, s93, s39
  s_lshl_b32 s93, s93, 2
  s_add_u32 s93, s93, 8192
  s_cmp_eq_u32 s28, 0
  s_cselect_b32 s93, s93, 1073741824
  v_mov_b32 v0, s34
  buffer_store_dword v0, off, s[16:19], s93 sc1
L_f2a:
  s_cmp_eq_u32 s85, 1
  s_cbranch_scc0 L_f2b
  s_lshl_b32 s93, s79, 3
  s_add_u32 s93, s93, s38
  s_lshl_b32 s93, s93, 2
  s_add_u32 s93, s93, 8192
  s_cmp_eq_u32 s28, 0
  s_cselect_b32 s93, s93, 1073741824
  v_mov_b32 v0, s34
  buffer_store_dword v0, off, s[16:19], s93 sc1
L_f2b:
  v_mfma_f32_32x32x16_bf16 v[112:127], a[152:155], a[24:27], v[112:127]
  s_add_u32 m0, s36, 110592
  ds_read_b64_tr_b16 a[148:149], v14 offset:13312
  ds_read_b64_tr_b16 a[150:151], v14 offset:13568
  buffer_load_dwordx4 v4, s[12:15], s63 offen lds
  v_cvt_pk_bf16_f32 v94, v140, v141
  v_cvt_pk_bf16_f32 v95, v142, v143
  v_mfma_f32_32x32x16_bf16 v[112:127], a[156:159], a[28:31], v[112:127]
  ds_read_b64_tr_b16 a[152:153], v14 offset:14336
  ds_read_b64_tr_b16 a[154:155], v14 offset:14592
  v_permlane16_swap_b32 v88, v92
  v_permlane16_swap_b32 v89, v93
  v_permlane16_swap_b32 v90, v94
  v_mfma_f32_32x32x16_bf16 v[112:127], a[160:163], a[32:35], v[112:127]
  s_waitcnt lgkmcnt(4)
  ds_read_b64_tr_b16 a[156:157], v14 offset:15360
  ds_read_b64_tr_b16 a[158:159], v14 offset:15616
  v_exp_f32 v35, v147
  v_rcp_f32 v38, v38
  v_mfma_f32_32x32x16_bf16 v[112:127], a[164:167], a[36:39], v[112:127]
  ds_read_b64_tr_b16 a[160:161], v14 offset:16384
  ds_read_b64_tr_b16 a[162:163], v14 offset:16640
  v_rcp_f32 v39, v39
  v_exp_f32 v36, v148
  v_mfma_f32_32x32x16_bf16 v[112:127], a[168:171], a[40:43], v[112:127]
  s_add_u32 m0, s36, 114688
  ds_read_b64_tr_b16 a[164:165], v14 offset:17408
  ds_read_b64_tr_b16 a[166:167], v14 offset:17664
  buffer_load_dwordx4 v4, s[12:15], s64 offen lds
  v_add_f32 v34, 1.0, v34
  v_add_f32 v35, 1.0, v35
  v_mfma_f32_32x32x16_bf16 v[112:127], a[172:175], a[44:47], v[112:127]
  ds_read_b64_tr_b16 a[168:169], v14 offset:18432
  ds_read_b64_tr_b16 a[170:171], v14 offset:18688
  v_exp_f32 v37, v149
  v_mul_f32 v144, v144, v38
  v_mul_f32 v145, v145, v39
  v_mfma_f32_32x32x16_bf16 v[112:127], a[144:147], a[48:51], v[112:127]
  s_waitcnt lgkmcnt(4)
  ds_read_b64_tr_b16 a[172:173], v14 offset:19456
  ds_read_b64_tr_b16 a[174:175], v14 offset:19712
  v_rcp_f32 v34, v34
  v_rcp_f32 v35, v35
  v_mfma_f32_32x32x16_bf16 v[112:127], a[148:151], a[52:55], v[112:127]
  ds_read_b64_tr_b16 a[144:145], v14 offset:20480
  ds_read_b64_tr_b16 a[146:147], v14 offset:20736
  v_exp_f32 v38, v150
  v_add_f32 v36, 1.0, v36
  v_add_f32 v37, 1.0, v37
  v_mfma_f32_32x32x16_bf16 v[112:127], a[152:155], a[56:59], v[112:127]
  ds_read_b64_tr_b16 a[148:149], v14 offset:21504
  ds_read_b64_tr_b16 a[150:151], v14 offset:21760
  v_exp_f32 v39, v151
  v_mul_f32 v146, v146, v34
  v_mul_f32 v147, v147, v35
  v_mfma_f32_32x32x16_bf16 v[112:127], a[156:159], a[60:63], v[112:127]
  s_add_u32 m0, s36, 126976
  ds_read_b64_tr_b16 a[152:153], v14 offset:22528
  ds_read_b64_tr_b16 a[154:155], v14 offset:22784
  buffer_load_dwordx4 v5, s[12:15], s58 offen lds
  v_permlane16_swap_b32 v91, v95
  v_cvt_pk_bf16_f32 v96, v144, v145
  v_mfma_f32_32x32x16_bf16 v[112:127], a[160:163], a[64:67], v[112:127]
  s_waitcnt lgkmcnt(4)
  ds_read_b64_tr_b16 a[156:157], v14 offset:23552
  ds_read_b64_tr_b16 a[158:159], v14 offset:23808
  v_rcp_f32 v36, v36
  v_rcp_f32 v37, v37
  v_mfma_f32_32x32x16_bf16 v[112:127], a[164:167], a[68:71], v[112:127]
  s_add_u32 m0, s36, 131072
  ds_read_b64_tr_b16 a[160:161], v14 offset:24576
  ds_read_b64_tr_b16 a[162:163], v14 offset:24832
  buffer_load_dwordx4 v5, s[12:15], s59 offen lds
  v_exp_f32 v34, v152
  v_mfma_f32_32x32x16_bf16 v[112:127], a[168:171], a[72:75], v[112:127]
  ds_read_b64_tr_b16 a[164:165], v14 offset:25600
  ds_read_b64_tr_b16 a[166:167], v14 offset:25856
  v_add_f32 v38, 1.0, v38
  v_add_f32 v39, 1.0, v39
  v_cvt_pk_bf16_f32 v97, v146, v147
  v_mfma_f32_32x32x16_bf16 v[112:127], a[172:175], a[76:79], v[112:127]
  s_waitcnt lgkmcnt(4)
  ds_read_b64_tr_b16 a[168:169], v14 offset:26624
  ds_read_b64_tr_b16 a[170:171], v14 offset:26880
  v_exp_f32 v35, v153
  v_mul_f32 v148, v148, v36
  v_mul_f32 v149, v149, v37
  v_mfma_f32_32x32x16_bf16 v[112:127], a[144:147], a[80:83], v[112:127]
  s_add_u32 m0, s36, 135168
  ds_read_b64_tr_b16 a[172:173], v14 offset:27648
  ds_read_b64_tr_b16 a[174:175], v14 offset:27904
  buffer_load_dwordx4 v5, s[12:15], s60 offen lds
  v_rcp_f32 v38, v38
  v_mfma_f32_32x32x16_bf16 v[112:127], a[148:151], a[84:87], v[112:127]
  ds_read_b64_tr_b16 a[144:145], v14 offset:28672
  ds_read_b64_tr_b16 a[146:147], v14 offset:28928
  v_rcp_f32 v39, v39
  v_exp_f32 v36, v154
  v_mfma_f32_32x32x16_bf16 v[112:127], a[152:155], a[88:91], v[112:127]
  s_waitcnt lgkmcnt(4)
  ds_read_b64_tr_b16 a[148:149], v14 offset:29696
  ds_read_b64_tr_b16 a[150:151], v14 offset:29952
  v_add_f32 v34, 1.0, v34
  v_add_f32 v35, 1.0, v35
  v_cvt_pk_bf16_f32 v98, v148, v149
  v_mfma_f32_32x32x16_bf16 v[112:127], a[156:159], a[92:95], v[112:127]
  s_add_u32 m0, s36, 139264
  ds_read_b64_tr_b16 a[152:153], v14 offset:30720
  ds_read_b64_tr_b16 a[154:155], v14 offset:30976
  buffer_load_dwordx4 v5, s[12:15], s61 offen lds
  v_exp_f32 v37, v155
  v_mfma_f32_32x32x16_bf16 v[112:127], a[160:163], a[96:99], v[112:127]
  ds_read_b64_tr_b16 a[156:157], v14 offset:31744
  ds_read_b64_tr_b16 a[158:159], v14 offset:32000
  v_mul_f32 v150, v150, v38
  v_mul_f32 v151, v151, v39
  v_mfma_f32_32x32x16_bf16 v[112:127], a[164:167], a[100:103], v[112:127]
  s_waitcnt lgkmcnt(4)
  ds_read_b64_tr_b16 a[160:161], v14 offset:32768
  ds_read_b64_tr_b16 a[162:163], v14 offset:33024
  v_rcp_f32 v34, v34
  v_rcp_f32 v35, v35
  v_mfma_f32_32x32x16_bf16 v[112:127], a[168:171], a[104:107], v[112:127]
  s_add_u32 m0, s36, 143360
  ds_read_b64_tr_b16 a[164:165], v14 offset:33792
  ds_read_b64_tr_b16 a[166:167], v14 offset:34048
  buffer_load_dwordx4 v5, s[12:15], s62 offen lds
  v_exp_f32 v38, v156
  v_mfma_f32_32x32x16_bf16 v[112:127], a[172:175], a[108:111], v[112:127]
  ds_read_b64_tr_b16 a[168:169], v14 offset:34816
  ds_read_b64_tr_b16 a[170:171], v14 offset:35072
  v_add_f32 v36, 1.0, v36
  v_add_f32 v37, 1.0, v37
  v_cvt_pk_bf16_f32 v99, v150, v151
  v_mfma_f32_32x32x16_bf16 v[112:127], a[144:147], a[112:115], v[112:127]
  s_waitcnt lgkmcnt(4)
  ds_read_b64_tr_b16 a[172:173], v14 offset:35840
  ds_read_b64_tr_b16 a[174:175], v14 offset:36096
  v_exp_f32 v39, v157
  v_mul_f32 v152, v152, v34
  v_mul_f32 v153, v153, v35
  v_mfma_f32_32x32x16_bf16 v[112:127], a[148:151], a[116:119], v[112:127]
  s_add_u32 m0, s36, 147456
  ds_read_b64_tr_b16 a[144:145], v15 offset:36864
  ds_read_b64_tr_b16 a[146:147], v15 offset:37888
  buffer_load_dwordx4 v5, s[12:15], s63 offen lds
  v_rcp_f32 v36, v36
  v_mfma_f32_32x32x16_bf16 v[112:127], a[152:155], a[120:123], v[112:127]
  v_rcp_f32 v37, v37
  v_exp_f32 v34, v158
  v_add_f32 v38, 1.0, v38
  v_mfma_f32_32x32x16_bf16 v[112:127], a[156:159], a[124:127], v[112:127]
  s_waitcnt lgkmcnt(2)
  ds_read_b64_tr_b16 a[148:149], v18 offset:36864
  ds_read_b64_tr_b16 a[150:151], v18 offset:37888
  v_add_f32 v39, 1.0, v39
  v_cvt_pk_bf16_f32 v100, v152, v153
  v_mfma_f32_32x32x16_bf16 v[112:127], a[160:163], a[128:131], v[112:127]
  s_add_u32 m0, s36, 151552
  s_nop 0
  buffer_load_dwordx4 v5, s[12:15], s64 offen lds
  v_exp_f32 v35, v159
  v_mul_f32 v154, v154, v36
  v_mfma_f32_32x32x16_bf16 v[112:127], a[164:167], a[132:135], v[112:127]
  ds_read_b64_tr_b16 a[152:153], v21 offset:36864
  ds_read_b64_tr_b16 a[154:155], v21 offset:37888
  v_mul_f32 v155, v155, v37
  v_mfma_f32_32x32x16_bf16 v[112:127], a[168:171], a[136:139], v[112:127]
  s_add_u32 s97, s80, 10240
  buffer_store_dwordx4 v[80:83], v2, s[16:19], s97 offen sc1
  v_mfma_f32_32x32x16_bf16 v[112:127], a[172:175], a[140:143], v[112:127]
  s_waitcnt lgkmcnt(2)
  ds_read_b64_tr_b16 a[156:157], v24 offset:36864
  ds_read_b64_tr_b16 a[158:159], v24 offset:37888
  v_rcp_f32 v38, v38
  v_rcp_f32 v39, v39
  v_mfma_f32_16x16x32_bf16 v[248:251], a[144:147], v[40:43], 0
  s_add_u32 s97, s80, 11264
  ds_read_b64_tr_b16 a[160:161], v15 offset:40960
  ds_read_b64_tr_b16 a[162:163], v15 offset:41984
  v_mfma_f32_16x16x32_bf16 v[252:255], a[144:147], v[44:47], 0
  ds_read_b64_tr_b16 a[164:165], v18 offset:40960
  ds_read_b64_tr_b16 a[166:167], v18 offset:41984
  v_mfma_f32_16x16x32_bf16 v[244:247], a[148:151], v[44:47], 0
  buffer_store_dwordx4 v[84:87], v2, s[16:19], s97 offen sc1
  v_mfma_f32_16x16x32_bf16 v[240:243], a[148:151], v[40:43], 0
  s_waitcnt lgkmcnt(6)
  ds_read_b64_tr_b16 a[168:169], v21 offset:40960
  ds_read_b64_tr_b16 a[170:171], v21 offset:41984
  v_add_f32 v34, 1.0, v34
  v_add_f32 v35, 1.0, v35
  v_mfma_f32_16x16x32_bf16 v[232:235], a[152:155], v[40:43], 0
  s_add_u32 s97, s80, 12288
  ds_read_b64_tr_b16 a[172:173], v24 offset:40960
  ds_read_b64_tr_b16 a[174:175], v24 offset:41984
  v_mfma_f32_16x16x32_bf16 v[236:239], a[152:155], v[44:47], 0
  s_waitcnt lgkmcnt(8)
  ds_read_b64_tr_b16 a[144:145], v15 offset:45056
  ds_read_b64_tr_b16 a[146:147], v15 offset:46080
  v_mfma_f32_16x16x32_bf16 v[228:231], a[156:159], v[44:47], 0
  s_waitcnt lgkmcnt(8)
  buffer_store_dwordx4 v[88:91], v2, s[16:19], s97 offen sc1
  v_mfma_f32_16x16x32_bf16 v[224:227], a[156:159], v[40:43], 0
  ds_read_b64_tr_b16 a[148:149], v18 offset:45056
  v_mul_f32 v156, v156, v38
  v_mul_f32 v157, v157, v39
  v_mfma_f32_16x16x32_bf16 v[248:251], a[160:163], v[48:51], v[248:251]
  s_waitcnt lgkmcnt(7)
  s_add_u32 s97, s80, 13312
  ds_read_b64_tr_b16 a[150:151], v18 offset:46080
  v_mfma_f32_16x16x32_bf16 v[252:255], a[160:163], v[52:55], v[252:255]
  ds_read_b64_tr_b16 a[152:153], v21 offset:45056
  ds_read_b64_tr_b16 a[154:155], v21 offset:46080
  v_mfma_f32_16x16x32_bf16 v[244:247], a[164:167], v[52:55], v[244:247]
  s_waitcnt lgkmcnt(6)
  buffer_store_dwordx4 v[92:95], v2, s[16:19], s97 offen sc1
  v_mfma_f32_16x16x32_bf16 v[240:243], a[164:167], v[48:51], v[240:243]
  ds_read_b64_tr_b16 a[156:157], v24 offset:45056
  v_cvt_pk_bf16_f32 v101, v154, v155
  v_cvt_pk_bf16_f32 v102, v156, v157
  v_mfma_f32_16x16x32_bf16 v[232:235], a[168:171], v[48:51], v[232:235]
  ds_read_b64_tr_b16 a[158:159], v24 offset:46080
  v_rcp_f32 v34, v34
  v_mfma_f32_16x16x32_bf16 v[236:239], a[168:171], v[52:55], v[236:239]
  ds_read_b64_tr_b16 a[160:161], v16 offset:0
  v_rcp_f32 v35, v35
  v_mfma_f32_16x16x32_bf16 v[228:231], a[172:175], v[52:55], v[228:231]
  ds_read_b64_tr_b16 a[162:163], v16 offset:1024
  v_exp_f32 v36, v112
  v_mfma_f32_16x16x32_bf16 v[224:227], a[172:175], v[48:51], v[224:227]
  s_waitcnt lgkmcnt(4)
  ds_read_b64_tr_b16 a[164:165], v19 offset:0
  v_mfma_f32_16x16x32_bf16 v[248:251], a[144:147], v[56:59], v[248:251]
  ds_read_b64_tr_b16 a[166:167], v19 offset:1024
  v_exp_f32 v37, v113
  v_mfma_f32_16x16x32_bf16 v[252:255], a[144:147], v[60:63], v[252:255]
  ds_read_b64_tr_b16 a[168:169], v22 offset:0
  v_mul_f32 v158, v158, v34
  v_mul_f32 v159, v159, v35
  v_mfma_f32_16x16x32_bf16 v[244:247], a[148:151], v[60:63], v[244:247]
  ds_read_b64_tr_b16 a[170:171], v22 offset:1024
  v_exp_f32 v38, v114
  v_mfma_f32_16x16x32_bf16 v[240:243], a[148:151], v[56:59], v[240:243]
  ds_read_b64_tr_b16 a[172:173], v25 offset:0
  v_cvt_pk_bf16_f32 v103, v158, v159
  v_permlane16_swap_b32 v96, v100
  v_mfma_f32_16x16x32_bf16 v[232:235], a[152:155], v[56:59], v[232:235]
  ds_read_b64_tr_b16 a[174:175], v25 offset:1024
  v_permlane16_swap_b32 v97, v101
  v_permlane16_swap_b32 v98, v102
  v_mfma_f32_16x16x32_bf16 v[236:239], a[152:155], v[60:63], v[236:239]
  s_waitcnt lgkmcnt(6)
  ds_read_b64_tr_b16 a[144:145], v16 offset:4096
  v_add_f32 v36, 1.0, v36
  v_add_f32 v37, 1.0, v37
  v_mfma_f32_16x16x32_bf16 v[228:231], a[156:159], v[60:63], v[228:231]
  s_waitcnt lgkmcnt(5)
  ds_read_b64_tr_b16 a[146:147], v16 offset:5120
  v_mfma_f32_16x16x32_bf16 v[224:227], a[156:159], v[56:59], v[224:227]
  ds_read_b64_tr_b16 a[148:149], v19 offset:4096
  v_exp_f32 v39, v115
  v_mfma_f32_16x16x32_bf16 v[248:251], a[160:163], v[64:67], v[248:251]
  ds_read_b64_tr_b16 a[150:151], v19 offset:5120
  v_rcp_f32 v36, v36
  v_mfma_f32_16x16x32_bf16 v[252:255], a[160:163], v[68:71], v[252:255]
  ds_read_b64_tr_b16 a[152:153], v22 offset:4096
  v_rcp_f32 v37, v37
  v_mfma_f32_16x16x32_bf16 v[244:247], a[164:167], v[68:71], v[244:247]
  ds_read_b64_tr_b16 a[154:155], v22 offset:5120
  v_exp_f32 v34, v116
  v_mfma_f32_16x16x32_bf16 v[240:243], a[164:167], v[64:67], v[240:243]
  s_waitcnt lgkmcnt(6)
  ds_read_b64_tr_b16 a[156:157], v25 offset:4096
  v_add_f32 v38, 1.0, v38
  v_add_f32 v39, 1.0, v39
  v_mfma_f32_16x16x32_bf16 v[232:235], a[168:171], v[64:67], v[232:235]
  s_waitcnt vmcnt(11)
  s_barrier
  ds_read_b64_tr_b16 a[158:159], v25 offset:5120
  v_mfma_f32_16x16x32_bf16 v[236:239], a[168:171], v[68:71], v[236:239]
  s_waitcnt lgkmcnt(6)
  ds_read_b64_tr_b16 a[160:161], v16 offset:8192
  v_mfma_f32_16x16x32_bf16 v[228:231], a[172:175], v[68:71], v[228:231]
  ds_read_b64_tr_b16 a[162:163], v16 offset:9216
  v_exp_f32 v35, v117
  v_mfma_f32_16x16x32_bf16 v[224:227], a[172:175], v[64:67], v[224:227]
  ds_read_b64_tr_b16 a[164:165], v19 offset:8192
  v_mul_f32 v112, v112, v36
  v_mul_f32 v113, v113, v37
  v_mfma_f32_16x16x32_bf16 v[248:251], a[144:147], v[72:75], v[248:251]
  ds_read_b64_tr_b16 a[166:167], v19 offset:9216
  v_permlane16_swap_b32 v99, v103
  v_cvt_pk_bf16_f32 v104, v112, v113
  v_mfma_f32_16x16x32_bf16 v[252:255], a[144:147], v[76:79], v[252:255]
  s_waitcnt lgkmcnt(6)
  ds_read_b64_tr_b16 a[168:169], v22 offset:8192
  v_rcp_f32 v38, v38
  v_mfma_f32_16x16x32_bf16 v[244:247], a[148:151], v[76:79], v[244:247]
  ds_read_b64_tr_b16 a[170:171], v22 offset:9216
  v_rcp_f32 v39, v39
  v_mfma_f32_16x16x32_bf16 v[240:243], a[148:151], v[72:75], v[240:243]
  ds_read_b64_tr_b16 a[172:173], v25 offset:8192
  v_exp_f32 v36, v118
  v_mfma_f32_16x16x32_bf16 v[232:235], a[152:155], v[72:75], v[232:235]
  s_waitcnt lgkmcnt(5)
  ds_read_b64_tr_b16 a[174:175], v25 offset:9216
  v_mfma_f32_16x16x32_bf16 v[236:239], a[152:155], v[76:79], v[236:239]
  ds_read_b64_tr_b16 a[144:145], v16 offset:12288
  v_add_f32 v34, 1.0, v34
  v_add_f32 v35, 1.0, v35
  v_mfma_f32_16x16x32_bf16 v[228:231], a[156:159], v[76:79], v[228:231]
  ds_read_b64_tr_b16 a[146:147], v16 offset:13312
  v_exp_f32 v37, v119
  v_mfma_f32_16x16x32_bf16 v[224:227], a[156:159], v[72:75], v[224:227]
  ds_read_b64_tr_b16 a[148:149], v19 offset:12288
  v_mul_f32 v114, v114, v38
  v_mul_f32 v115, v115, v39
  v_mfma_f32_16x16x32_bf16 v[248:251], a[160:163], v[80:83], v[248:251]
  s_waitcnt lgkmcnt(5)
  s_add_u32 s97, s80, 14336
  ds_read_b64_tr_b16 a[150:151], v19 offset:13312
  v_mfma_f32_16x16x32_bf16 v[252:255], a[160:163], v[84:87], v[252:255]
  ds_read_b64_tr_b16 a[152:153], v22 offset:12288
  ds_read_b64_tr_b16 a[154:155], v22 offset:13312
  v_mfma_f32_16x16x32_bf16 v[244:247], a[164:167], v[84:87], v[244:247]
  buffer_store_dwordx4 v[96:99], v2, s[16:19], s97 offen sc1
  v_mfma_f32_16x16x32_bf16 v[240:243], a[164:167], v[80:83], v[240:243]
  ds_read_b64_tr_b16 a[156:157], v25 offset:12288
  v_rcp_f32 v34, v34
  v_mfma_f32_16x16x32_bf16 v[232:235], a[168:171], v[80:83], v[232:235]
  s_waitcnt lgkmcnt(5)
  s_add_u32 s97, s80, 15360
  ds_read_b64_tr_b16 a[158:159], v25 offset:13312
  v_mfma_f32_16x16x32_bf16 v[236:239], a[168:171], v[84:87], v[236:239]
  ds_read_b64_tr_b16 a[160:161], v16 offset:24576
  ds_read_b64_tr_b16 a[162:163], v16 offset:25600
  v_mfma_f32_16x16x32_bf16 v[228:231], a[172:175], v[84:87], v[228:231]
  buffer_store_dwordx4 v[100:103], v2, s[16:19], s97 offen sc1
  v_mfma_f32_16x16x32_bf16 v[224:227], a[172:175], v[80:83], v[224:227]
  ds_read_b64_tr_b16 a[164:165], v19 offset:24576
  v_rcp_f32 v35, v35
  v_mfma_f32_16x16x32_bf16 v[248:251], a[144:147], v[88:91], v[248:251]
  ds_read_b64_tr_b16 a[166:167], v19 offset:25600
  v_exp_f32 v38, v120
  v_mfma_f32_16x16x32_bf16 v[252:255], a[144:147], v[92:95], v[252:255]
  s_waitcnt lgkmcnt(6)
  ds_read_b64_tr_b16 a[168:169], v22 offset:24576
  v_mfma_f32_16x16x32_bf16 v[244:247], a[148:151], v[92:95], v[244:247]
  ds_read_b64_tr_b16 a[170:171], v22 offset:25600
  v_add_f32 v36, 1.0, v36
  v_add_f32 v37, 1.0, v37
  v_mfma_f32_16x16x32_bf16 v[240:243], a[148:151], v[88:91], v[240:243]
  ds_read_b64_tr_b16 a[172:173], v25 offset:24576
  v_exp_f32 v39, v121
  v_mfma_f32_16x16x32_bf16 v[232:235], a[152:155], v[88:91], v[232:235]
  ds_read_b64_tr_b16 a[174:175], v25 offset:25600
  v_mul_f32 v116, v116, v34
  v_mul_f32 v117, v117, v35
  v_mfma_f32_16x16x32_bf16 v[236:239], a[152:155], v[92:95], v[236:239]
  s_waitcnt lgkmcnt(6)
  ds_read_b64_tr_b16 a[144:145], v16 offset:28672
  v_cvt_pk_bf16_f32 v105, v114, v115
  v_cvt_pk_bf16_f32 v106, v116, v117
  v_mfma_f32_16x16x32_bf16 v[228:231], a[156:159], v[92:95], v[228:231]
  ds_read_b64_tr_b16 a[146:147], v16 offset:29696
  v_rcp_f32 v36, v36
  v_mfma_f32_16x16x32_bf16 v[224:227], a[156:159], v[88:91], v[224:227]
  ds_read_b64_tr_b16 a[148:149], v19 offset:28672
  v_rcp_f32 v37, v37
  v_mfma_f32_16x16x32_bf16 v[216:219], a[160:163], v[40:43], 0
  s_waitcnt lgkmcnt(5)
  ds_read_b64_tr_b16 a[150:151], v19 offset:29696
  v_mfma_f32_16x16x32_bf16 v[220:223], a[160:163], v[44:47], 0
  ds_read_b64_tr_b16 a[152:153], v22 offset:28672
  v_exp_f32 v34, v122
  v_mfma_f32_16x16x32_bf16 v[212:215], a[164:167], v[44:47], 0
  ds_read_b64_tr_b16 a[154:155], v22 offset:29696
  v_add_f32 v38, 1.0, v38
  v_add_f32 v39, 1.0, v39
  v_mfma_f32_16x16x32_bf16 v[208:211], a[164:167], v[40:43], 0
  ds_read_b64_tr_b16 a[156:157], v25 offset:28672
  v_exp_f32 v35, v123
  v_mfma_f32_16x16x32_bf16 v[200:203], a[168:171], v[40:43], 0
  s_waitcnt lgkmcnt(5)
  s_add_u32 m0, s36, 16384
  ds_read_b64_tr_b16 a[158:159], v25 offset:29696
  v_mfma_f32_16x16x32_bf16 v[204:207], a[168:171], v[44:47], 0
  ds_read_b64_tr_b16 a[160:161], v16 offset:32768
  ds_read_b64_tr_b16 a[162:163], v16 offset:33792
  v_mfma_f32_16x16x32_bf16 v[196:199], a[172:175], v[44:47], 0
  buffer_load_dwordx4 v33, s[12:15], s58 offen lds
  v_mfma_f32_16x16x32_bf16 v[192:195], a[172:175], v[40:43], 0
  ds_read_b64_tr_b16 a[164:165], v19 offset:32768
  v_mul_f32 v118, v118, v36
  v_mul_f32 v119, v119, v37
  v_mfma_f32_16x16x32_bf16 v[216:219], a[144:147], v[48:51], v[216:219]
  s_waitcnt lgkmcnt(5)
  s_add_u32 m0, s36, 20480
  ds_read_b64_tr_b16 a[166:167], v19 offset:33792
  v_mfma_f32_16x16x32_bf16 v[220:223], a[144:147], v[52:55], v[220:223]
  ds_read_b64_tr_b16 a[168:169], v22 offset:32768
  ds_read_b64_tr_b16 a[170:171], v22 offset:33792
  v_mfma_f32_16x16x32_bf16 v[212:215], a[148:151], v[52:55], v[212:215]
  buffer_load_dwordx4 v33, s[12:15], s59 offen lds
  v_mfma_f32_16x16x32_bf16 v[208:211], a[148:151], v[48:51], v[208:211]
  ds_read_b64_tr_b16 a[172:173], v25 offset:32768
  v_rcp_f32 v38, v38
  v_mfma_f32_16x16x32_bf16 v[200:203], a[152:155], v[48:51], v[200:203]
  s_waitcnt lgkmcnt(5)
  s_add_u32 m0, s36, 24576
  ds_read_b64_tr_b16 a[174:175], v25 offset:33792
  v_mfma_f32_16x16x32_bf16 v[204:207], a[152:155], v[52:55], v[204:207]
  ds_read_b64_tr_b16 a[144:145], v16 offset:36864
  ds_read_b64_tr_b16 a[146:147], v16 offset:37888
  v_mfma_f32_16x16x32_bf16 v[196:199], a[156:159], v[52:55], v[196:199]
  buffer_load_dwordx4 v33, s[12:15], s60 offen lds
  v_mfma_f32_16x16x32_bf16 v[192:195], a[156:159], v[48:51], v[192:195]
  ds_read_b64_tr_b16 a[148:149], v19 offset:36864
  v_rcp_f32 v39, v39
  v_mfma_f32_16x16x32_bf16 v[216:219], a[160:163], v[56:59], v[216:219]
  s_waitcnt lgkmcnt(5)
  s_add_u32 m0, s36, 28672
  ds_read_b64_tr_b16 a[150:151], v19 offset:37888
  v_mfma_f32_16x16x32_bf16 v[220:223], a[160:163], v[60:63], v[220:223]
  ds_read_b64_tr_b16 a[152:153], v22 offset:36864
  ds_read_b64_tr_b16 a[154:155], v22 offset:37888
  v_mfma_f32_16x16x32_bf16 v[212:215], a[164:167], v[60:63], v[212:215]
  buffer_load_dwordx4 v33, s[12:15], s61 offen lds
  v_mfma_f32_16x16x32_bf16 v[208:211], a[164:167], v[56:59], v[208:211]
  ds_read_b64_tr_b16 a[156:157], v25 offset:36864
  v_mfma_f32_16x16x32_bf16 v[200:203], a[168:171], v[56:59], v[200:203]
  s_waitcnt lgkmcnt(5)
  s_add_u32 m0, s36, 32768
  ds_read_b64_tr_b16 a[158:159], v25 offset:37888
  v_mfma_f32_16x16x32_bf16 v[204:207], a[168:171], v[60:63], v[204:207]
  ds_read_b64_tr_b16 a[160:161], v16 offset:40960
  ds_read_b64_tr_b16 a[162:163], v16 offset:41984
  v_mfma_f32_16x16x32_bf16 v[196:199], a[172:175], v[60:63], v[196:199]
  buffer_load_dwordx4 v33, s[12:15], s62 offen lds
  v_mfma_f32_16x16x32_bf16 v[192:195], a[172:175], v[56:59], v[192:195]
  ds_read_b64_tr_b16 a[164:165], v19 offset:40960
  v_exp_f32 v36, v124
  v_mfma_f32_16x16x32_bf16 v[216:219], a[144:147], v[64:67], v[216:219]
  s_waitcnt lgkmcnt(5)
  s_add_u32 m0, s36, 36864
  ds_read_b64_tr_b16 a[166:167], v19 offset:41984
  v_mfma_f32_16x16x32_bf16 v[220:223], a[144:147], v[68:71], v[220:223]
  ds_read_b64_tr_b16 a[168:169], v22 offset:40960
  ds_read_b64_tr_b16 a[170:171], v22 offset:41984
  v_mfma_f32_16x16x32_bf16 v[212:215], a[148:151], v[68:71], v[212:215]
  buffer_load_dwordx4 v33, s[12:15], s63 offen lds
  v_mfma_f32_16x16x32_bf16 v[208:211], a[148:151], v[64:67], v[208:211]
  ds_read_b64_tr_b16 a[172:173], v25 offset:40960
  v_add_f32 v34, 1.0, v34
  v_add_f32 v35, 1.0, v35
  v_mfma_f32_16x16x32_bf16 v[200:203], a[152:155], v[64:67], v[200:203]
  s_waitcnt vmcnt(12)
  s_waitcnt vmcnt(6)
  s_barrier
  ds_read_b64_tr_b16 a[174:175], v25 offset:41984
  s_add_u32 s93, s83, 0
  s_cmp_eq_u32 s28, 0
  s_cselect_b32 s93, s93, 1073741824
  v_mov_b32 v0, s34
  buffer_store_dword v0, off, s[16:19], s93 sc1
  v_mfma_f32_16x16x32_bf16 v[204:207], a[152:155], v[68:71], v[204:207]
  s_waitcnt lgkmcnt(6)
  s_add_u32 m0, s36, 40960
  ds_read_b64_tr_b16 a[144:145], v16 offset:45056
  v_mfma_f32_16x16x32_bf16 v[196:199], a[156:159], v[68:71], v[196:199]
  ds_read_b64_tr_b16 a[146:147], v16 offset:46080
  ds_read_b64_tr_b16 a[148:149], v19 offset:45056
  v_mfma_f32_16x16x32_bf16 v[192:195], a[156:159], v[64:67], v[192:195]
  s_waitcnt lgkmcnt(5)
  buffer_load_dwordx4 v33, s[12:15], s64 offen lds
  v_mfma_f32_16x16x32_bf16 v[216:219], a[160:163], v[72:75], v[216:219]
  ds_read_b64_tr_b16 a[150:151], v19 offset:46080
  v_exp_f32 v37, v125
  v_mfma_f32_16x16x32_bf16 v[220:223], a[160:163], v[76:79], v[220:223]
  ds_read_b64_tr_b16 a[152:153], v22 offset:45056
  v_mul_f32 v120, v120, v38
  v_mul_f32 v121, v121, v39
  v_mfma_f32_16x16x32_bf16 v[212:215], a[164:167], v[76:79], v[212:215]
  ds_read_b64_tr_b16 a[154:155], v22 offset:46080
  v_cvt_pk_bf16_f32 v107, v118, v119
  v_cvt_pk_bf16_f32 v108, v120, v121
  v_mfma_f32_16x16x32_bf16 v[208:211], a[164:167], v[72:75], v[208:211]
  s_waitcnt lgkmcnt(6)
  ds_read_b64_tr_b16 a[156:157], v25 offset:45056
  v_mfma_f32_16x16x32_bf16 v[200:203], a[168:171], v[72:75], v[200:203]
  ds_read_b64_tr_b16 a[158:159], v25 offset:46080
  v_rcp_f32 v34, v34
  v_mfma_f32_16x16x32_bf16 v[204:207], a[168:171], v[76:79], v[204:207]
  ds_read_b64_tr_b16 a[160:161], v17 offset:0
  v_rcp_f32 v35, v35
  v_mfma_f32_16x16x32_bf16 v[196:199], a[172:175], v[76:79], v[196:199]
  ds_read_b64_tr_b16 a[162:163], v17 offset:1024
  v_exp_f32 v38, v126
  v_mfma_f32_16x16x32_bf16 v[192:195], a[172:175], v[72:75], v[192:195]
  s_waitcnt lgkmcnt(6)
  ds_read_b64_tr_b16 a[164:165], v20 offset:0
  v_add_f32 v36, 1.0, v36
  v_add_f32 v37, 1.0, v37
  v_mfma_f32_16x16x32_bf16 v[216:219], a[144:147], v[80:83], v[216:219]
  ds_read_b64_tr_b16 a[166:167], v20 offset:1024
  v_exp_f32 v39, v127
  v_mfma_f32_16x16x32_bf16 v[220:223], a[144:147], v[84:87], v[220:223]
  ds_read_b64_tr_b16 a[168:169], v23 offset:0
  v_mul_f32 v122, v122, v34
  v_mul_f32 v123, v123, v35
  v_mfma_f32_16x16x32_bf16 v[212:215], a[148:151], v[84:87], v[212:215]
  s_waitcnt lgkmcnt(5)
  ds_read_b64_tr_b16 a[170:171], v23 offset:1024
  v_mfma_f32_16x16x32_bf16 v[208:211], a[148:151], v[80:83], v[208:211]
  ds_read_b64_tr_b16 a[172:173], v26 offset:0
  v_rcp_f32 v36, v36
  v_mfma_f32_16x16x32_bf16 v[200:203], a[152:155], v[80:83], v[200:203]
  ds_read_b64_tr_b16 a[174:175], v26 offset:1024
  v_rcp_f32 v37, v37
  v_mfma_f32_16x16x32_bf16 v[204:207], a[152:155], v[84:87], v[204:207]
  ds_read_b64_tr_b16 a[144:145], v17 offset:12288
  v_add_f32 v38, 1.0, v38
  v_add_f32 v39, 1.0, v39
  v_mfma_f32_16x16x32_bf16 v[196:199], a[156:159], v[84:87], v[196:199]
  ds_read_b64_tr_b16 a[146:147], v17 offset:13312
  v_mul_f32 v124, v124, v36
  v_mul_f32 v125, v125, v37
  v_mfma_f32_16x16x32_bf16 v[192:195], a[156:159], v[80:83], v[192:195]
  s_waitcnt lgkmcnt(6)
  ds_read_b64_tr_b16 a[148:149], v20 offset:12288
  v_cvt_pk_bf16_f32 v109, v122, v123
  v_cvt_pk_bf16_f32 v110, v124, v125
  v_mfma_f32_16x16x32_bf16 v[216:219], a[160:163], v[88:91], v[216:219]
  ds_read_b64_tr_b16 a[150:151], v20 offset:13312
  v_rcp_f32 v38, v38
  v_mfma_f32_16x16x32_bf16 v[220:223], a[160:163], v[92:95], v[220:223]
  s_waitcnt lgkmcnt(6)
  ds_read_b64_tr_b16 a[152:153], v23 offset:12288
  v_mfma_f32_16x16x32_bf16 v[212:215], a[164:167], v[92:95], v[212:215]
  ds_read_b64_tr_b16 a[154:155], v23 offset:13312
  v_rcp_f32 v39, v39
  v_mfma_f32_16x16x32_bf16 v[208:211], a[164:167], v[88:91], v[208:211]
  ds_read_b64_tr_b16 a[156:157], v26 offset:12288
  v_mul_f32 v126, v126, v38
  v_mul_f32 v127, v127, v39
  v_mfma_f32_16x16x32_bf16 v[200:203], a[168:171], v[88:91], v[200:203]
  ds_read_b64_tr_b16 a[158:159], v26 offset:13312
  v_cvt_pk_bf16_f32 v111, v126, v127
  s_mov_b32 s20, s2
  v_mfma_f32_16x16x32_bf16 v[204:207], a[168:171], v[92:95], v[204:207]
  s_waitcnt lgkmcnt(6)
  ds_read_b64_tr_b16 a[160:161], v17 offset:16384
  v_permlane16_swap_b32 v104, v108
  v_permlane16_swap_b32 v105, v109
  v_mfma_f32_16x16x32_bf16 v[196:199], a[172:175], v[92:95], v[196:199]
  ds_read_b64_tr_b16 a[162:163], v17 offset:17408
  v_permlane16_swap_b32 v106, v110
  v_permlane16_swap_b32 v107, v111
  v_mfma_f32_16x16x32_bf16 v[192:195], a[172:175], v[88:91], v[192:195]
  s_add_u32 m0, s36, 53248
  ds_read_b64_tr_b16 a[164:165], v20 offset:16384
  v_mfma_f32_16x16x32_bf16 v[184:187], a[144:147], v[40:43], 0
  ds_read_b64_tr_b16 a[166:167], v20 offset:17408
  ds_read_b64_tr_b16 a[168:169], v23 offset:16384
  v_mfma_f32_16x16x32_bf16 v[188:191], a[144:147], v[44:47], 0
  s_waitcnt lgkmcnt(7)
  buffer_load_dwordx4 v6, s[12:15], s65 offen lds
  v_mfma_f32_16x16x32_bf16 v[180:183], a[148:151], v[44:47], 0
  s_mov_b32 s21, s3
  s_mov_b32 s22, 2359296
  ds_read_b64_tr_b16 a[170:171], v23 offset:17408
  v_mfma_f32_16x16x32_bf16 v[176:179], a[148:151], v[40:43], 0
  s_add_u32 s97, s80, 16384
  ds_read_b64_tr_b16 a[172:173], v26 offset:16384
  v_mfma_f32_16x16x32_bf16 v[168:171], a[152:155], v[40:43], 0
  ds_read_b64_tr_b16 a[174:175], v26 offset:17408
  ds_read_b64_tr_b16 a[144:145], v17 offset:20480
  v_mfma_f32_16x16x32_bf16 v[172:175], a[152:155], v[44:47], 0
  s_waitcnt lgkmcnt(7)
  buffer_store_dwordx4 v[104:107], v2, s[16:19], s97 offen sc1
  v_mfma_f32_16x16x32_bf16 v[164:167], a[156:159], v[44:47], 0
  ds_read_b64_tr_b16 a[146:147], v17 offset:21504
  v_mfma_f32_16x16x32_bf16 v[160:163], a[156:159], v[40:43], 0
  s_add_u32 s97, s80, 17408
  ds_read_b64_tr_b16 a[148:149], v20 offset:20480
  v_mfma_f32_16x16x32_bf16 v[184:187], a[160:163], v[48:51], v[184:187]
  ds_read_b64_tr_b16 a[150:151], v20 offset:21504
  ds_read_b64_tr_b16 a[152:153], v23 offset:20480
  v_mfma_f32_16x16x32_bf16 v[188:191], a[160:163], v[52:55], v[188:191]
  s_waitcnt lgkmcnt(7)
  buffer_store_dwordx4 v[108:111], v2, s[16:19], s97 offen sc1
  v_mfma_f32_16x16x32_bf16 v[180:183], a[164:167], v[52:55], v[180:183]
  s_mov_b32 s23, 0x20000
  s_lshl_b32 s46, s29, 1
  ds_read_b64_tr_b16 a[154:155], v23 offset:21504
  v_mfma_f32_16x16x32_bf16 v[176:179], a[164:167], v[48:51], v[176:179]
  s_add_u32 m0, s36, 57344
  ds_read_b64_tr_b16 a[156:157], v26 offset:20480
  v_mfma_f32_16x16x32_bf16 v[168:171], a[168:171], v[48:51], v[168:171]
  ds_read_b64_tr_b16 a[158:159], v26 offset:21504
  ds_read_b64_tr_b16 a[160:161], v17 offset:24576
  v_mfma_f32_16x16x32_bf16 v[172:175], a[168:171], v[52:55], v[172:175]
  s_waitcnt lgkmcnt(7)
  buffer_load_dwordx4 v6, s[12:15], s66 offen lds
  v_mfma_f32_16x16x32_bf16 v[164:167], a[172:175], v[52:55], v[164:167]
  s_add_u32 s46, s46, s32
  s_lshl_b32 s46, s46, 11
  ds_read_b64_tr_b16 a[162:163], v17 offset:25600
  v_mfma_f32_16x16x32_bf16 v[160:163], a[172:175], v[48:51], v[160:163]
  s_add_u32 m0, s36, 61440
  ds_read_b64_tr_b16 a[164:165], v20 offset:24576
  v_mfma_f32_16x16x32_bf16 v[184:187], a[144:147], v[56:59], v[184:187]
  ds_read_b64_tr_b16 a[166:167], v20 offset:25600
  ds_read_b64_tr_b16 a[168:169], v23 offset:24576
  v_mfma_f32_16x16x32_bf16 v[188:191], a[144:147], v[60:63], v[188:191]
  s_waitcnt lgkmcnt(7)
  buffer_load_dwordx4 v4, s[12:15], s65 offen lds
  v_mfma_f32_16x16x32_bf16 v[180:183], a[148:151], v[60:63], v[180:183]
  s_add_u32 s46, s46, 1245184
  s_lshl_b32 s40, s29, 4
  ds_read_b64_tr_b16 a[170:171], v23 offset:25600
  v_mfma_f32_16x16x32_bf16 v[176:179], a[148:151], v[56:59], v[176:179]
  s_add_u32 s40, s40, s32
  s_xor_b32 s40, s40, 1
  ds_read_b64_tr_b16 a[172:173], v26 offset:24576
  v_mfma_f32_16x16x32_bf16 v[168:171], a[152:155], v[56:59], v[168:171]
  s_waitcnt lgkmcnt(5)
  s_add_u32 m0, s36, 65536
  ds_read_b64_tr_b16 a[174:175], v26 offset:25600
  v_mfma_f32_16x16x32_bf16 v[172:175], a[152:155], v[60:63], v[172:175]
  ds_read_b64_tr_b16 a[144:145], v17 offset:28672
  ds_read_b64_tr_b16 a[146:147], v17 offset:29696
  v_mfma_f32_16x16x32_bf16 v[164:167], a[156:159], v[60:63], v[164:167]
  buffer_load_dwordx4 v4, s[12:15], s66 offen lds
  v_mfma_f32_16x16x32_bf16 v[160:163], a[156:159], v[56:59], v[160:163]
  s_lshl_b32 s40, s40, 2
  s_lshr_b32 s94, s31, 1
  ds_read_b64_tr_b16 a[148:149], v20 offset:28672
  v_mfma_f32_16x16x32_bf16 v[184:187], a[160:163], v[64:67], v[184:187]
  s_add_u32 s48, s40, s94
  s_mul_i32 s48, s48, 18432
  ds_read_b64_tr_b16 a[150:151], v20 offset:29696
  v_mfma_f32_16x16x32_bf16 v[188:191], a[160:163], v[68:71], v[188:191]
  s_waitcnt lgkmcnt(6)
  ds_read_b64_tr_b16 a[152:153], v23 offset:28672
  v_mfma_f32_16x16x32_bf16 v[180:183], a[164:167], v[68:71], v[180:183]
  s_add_u32 s40, s40, s28
  s_mul_i32 s40, s40, 18432
  ds_read_b64_tr_b16 a[154:155], v23 offset:29696
  v_mfma_f32_16x16x32_bf16 v[176:179], a[164:167], v[64:67], v[176:179]
  s_lshl_b32 s99, s31, 11
  s_add_u32 s40, s40, s99
  ds_read_b64_tr_b16 a[156:157], v26 offset:28672
  v_mfma_f32_16x16x32_bf16 v[168:171], a[168:171], v[64:67], v[168:171]
  s_waitcnt vmcnt(6)
  s_barrier
  ds_read_b64_tr_b16 a[158:159], v26 offset:29696
  s_lshr_b32 s92, 5, s31
  s_bitcmp1_b32 s92, 0
  s_cselect_b32 s95, 47, 31
  v_min_u32 v8, s95, v1
  v_lshlrev_b32 v8, 2, v8
  v_lshrrev_b32 v10, 4, v1
  v_and_b32 v11, 15, v1
  v_lshlrev_b32 v11, 3, v11
  v_lshl_add_u32 v10, v10, 13, v11
  v_add_u32 v11, 0x8000, v10
  v_mfma_f32_16x16x32_bf16 v[172:175], a[168:171], v[68:71], v[172:175]
  s_waitcnt lgkmcnt(6)
  s_add_u32 m0, s36, 90112
  ds_read_b64_tr_b16 a[160:161], v17 offset:32768
  v_mfma_f32_16x16x32_bf16 v[164:167], a[172:175], v[68:71], v[164:167]
  ds_read_b64_tr_b16 a[162:163], v17 offset:33792
  ds_read_b64_tr_b16 a[164:165], v20 offset:32768
  v_mfma_f32_16x16x32_bf16 v[160:163], a[172:175], v[64:67], v[160:163]
  s_waitcnt lgkmcnt(7)
  buffer_load_dwordx4 v7, s[12:15], s58 offen lds
  v_mfma_f32_16x16x32_bf16 v[184:187], a[144:147], v[72:75], v[184:187]
  s_add_u32 s40, s40, 8388608
  s_lshl2_add_u32 s44, s29, s94
  ds_read_b64_tr_b16 a[166:167], v20 offset:33792
  v_mfma_f32_16x16x32_bf16 v[188:191], a[144:147], v[76:79], v[188:191]
  s_lshl_b32 s95, s77, 6
  s_add_u32 s95, s95, 8192
  ds_read_b64_tr_b16 a[168:169], v23 offset:32768
  v_mfma_f32_16x16x32_bf16 v[180:183], a[148:151], v[76:79], v[180:183]
  ds_read_b64_tr_b16 a[170:171], v23 offset:33792
  ds_read_b64_tr_b16 a[172:173], v26 offset:32768
  v_mfma_f32_16x16x32_bf16 v[176:179], a[148:151], v[72:75], v[176:179]
  s_waitcnt lgkmcnt(7)
  buffer_load_dword v9, v8, s[16:19], s95 offen sc1
  v_mfma_f32_16x16x32_bf16 v[168:171], a[152:155], v[72:75], v[168:171]
  s_add_u32 m0, s36, 94208
  ds_read_b64_tr_b16 a[174:175], v26 offset:33792
  v_mfma_f32_16x16x32_bf16 v[172:175], a[152:155], v[76:79], v[172:175]
  ds_read_b64_tr_b16 a[144:145], v17 offset:36864
  ds_read_b64_tr_b16 a[146:147], v17 offset:37888
  v_mfma_f32_16x16x32_bf16 v[164:167], a[156:159], v[76:79], v[164:167]
  s_waitcnt lgkmcnt(6)
  buffer_load_dwordx4 v7, s[12:15], s60 offen lds
  v_mfma_f32_16x16x32_bf16 v[160:163], a[156:159], v[72:75], v[160:163]
  s_mul_i32 s44, s44, 1152
  s_and_b32 s94, s31, 1
  ds_read_b64_tr_b16 a[148:149], v20 offset:36864
  v_mfma_f32_16x16x32_bf16 v[184:187], a[160:163], v[80:83], v[184:187]
  s_add_u32 m0, s36, 98304
  ds_read_b64_tr_b16 a[150:151], v20 offset:37888
  v_mfma_f32_16x16x32_bf16 v[188:191], a[160:163], v[84:87], v[188:191]
  ds_read_b64_tr_b16 a[152:153], v23 offset:36864
  ds_read_b64_tr_b16 a[154:155], v23 offset:37888
  v_mfma_f32_16x16x32_bf16 v[180:183], a[164:167], v[84:87], v[180:183]
  s_waitcnt lgkmcnt(6)
  buffer_load_dwordx4 v7, s[12:15], s62 offen lds
  v_mfma_f32_16x16x32_bf16 v[176:179], a[164:167], v[80:83], v[176:179]
  s_mul_i32 s99, s94, 1179648
  s_add_u32 s44, s44, s99
  ds_read_b64_tr_b16 a[156:157], v26 offset:36864
  v_mfma_f32_16x16x32_bf16 v[168:171], a[168:171], v[80:83], v[168:171]
  s_add_u32 m0, s36, 102400
  ds_read_b64_tr_b16 a[158:159], v26 offset:37888
  v_mfma_f32_16x16x32_bf16 v[172:175], a[168:171], v[84:87], v[172:175]
  ds_read_b64_tr_b16 a[160:161], v15 offset:0
  ds_read_b64_tr_b16 a[162:163], v15 offset:1024
  v_mfma_f32_16x16x32_bf16 v[164:167], a[172:175], v[84:87], v[164:167]
  buffer_load_dwordx4 v7, s[12:15], s64 offen lds
  v_mfma_f32_16x16x32_bf16 v[160:163], a[172:175], v[80:83], v[160:163]
  s_waitcnt lgkmcnt(4)
  ds_read_b64_tr_b16 a[164:165], v18 offset:0
  v_mfma_f32_16x16x32_bf16 v[184:187], a[144:147], v[88:91], v[184:187]
  s_cmp_ge_u32 s28, 2
  s_cselect_b32 s97, s64, s66
  s_add_u32 m0, s82, 90112
  ds_read_b64_tr_b16 a[166:167], v18 offset:1024
  v_mfma_f32_16x16x32_bf16 v[188:191], a[144:147], v[92:95], v[188:191]
  ds_read_b64_tr_b16 a[168:169], v21 offset:0
  ds_read_b64_tr_b16 a[170:171], v21 offset:1024
  v_mfma_f32_16x16x32_bf16 v[180:183], a[148:151], v[92:95], v[180:183]
  buffer_load_dwordx4 v7, s[12:15], s97 offen lds
  v_mfma_f32_16x16x32_bf16 v[176:179], a[148:151], v[88:91], v[176:179]
  s_lshl3_add_u32 s99, s32, s28
  s_lshl3_add_u32 s44, s99, s44
  ds_read_b64_tr_b16 a[172:173], v24 offset:0
  v_mfma_f32_16x16x32_bf16 v[168:171], a[152:155], v[88:91], v[168:171]
  s_waitcnt lgkmcnt(5)
  s_add_u32 m0, s36, 69632
  ds_read_b64_tr_b16 a[174:175], v24 offset:1024
  v_mfma_f32_16x16x32_bf16 v[172:175], a[152:155], v[92:95], v[172:175]
  ds_read_b64_tr_b16 a[144:145], v15 offset:4096
  ds_read_b64_tr_b16 a[146:147], v15 offset:5120
  v_mfma_f32_16x16x32_bf16 v[164:167], a[156:159], v[92:95], v[164:167]
  buffer_load_dwordx4 v5, s[12:15], s65 offen lds
  v_mfma_f32_16x16x32_bf16 v[160:163], a[156:159], v[88:91], v[160:163]
  s_add_u32 s44, s44, 512
  s_lshl2_add_u32 s99, s94, s28
  ds_read_b64_tr_b16 a[148:149], v18 offset:4096
  v_mfma_f32_16x16x32_bf16 v[152:155], a[160:163], v[40:43], 0
  s_waitcnt lgkmcnt(5)
  s_add_u32 m0, s36, 73728
  ds_read_b64_tr_b16 a[150:151], v18 offset:5120
  v_mfma_f32_16x16x32_bf16 v[156:159], a[160:163], v[44:47], 0
  ds_read_b64_tr_b16 a[152:153], v21 offset:4096
  ds_read_b64_tr_b16 a[154:155], v21 offset:5120
  v_mfma_f32_16x16x32_bf16 v[148:151], a[164:167], v[44:47], 0
  buffer_load_dwordx4 v5, s[12:15], s66 offen lds
  v_mfma_f32_16x16x32_bf16 v[144:147], a[164:167], v[40:43], 0
  s_lshl_b32 s99, s99, 8
  s_add_u32 s48, s48, s99
  ds_read_b64_tr_b16 a[156:157], v24 offset:4096
  v_mfma_f32_16x16x32_bf16 v[136:139], a[168:171], v[40:43], 0
  s_waitcnt lgkmcnt(5)
  s_add_u32 m0, s36, 77824
  ds_read_b64_tr_b16 a[158:159], v24 offset:5120
  v_mfma_f32_16x16x32_bf16 v[140:143], a[168:171], v[44:47], 0
  ds_read_b64_tr_b16 a[160:161], v15 offset:8192
  ds_read_b64_tr_b16 a[162:163], v15 offset:9216
  v_mfma_f32_16x16x32_bf16 v[132:135], a[172:175], v[44:47], 0
  buffer_load_dwordx4 v33, s[12:15], s65 offen lds
  v_mfma_f32_16x16x32_bf16 v[128:131], a[172:175], v[40:43], 0
  s_add_u32 s48, s48, 8404992
  s_mul_i32 s42, s33, 1152
  ds_read_b64_tr_b16 a[164:165], v18 offset:8192
  v_mfma_f32_16x16x32_bf16 v[152:155], a[144:147], v[48:51], v[152:155]
  s_waitcnt lgkmcnt(5)
  s_add_u32 m0, s36, 81920
  ds_read_b64_tr_b16 a[166:167], v18 offset:9216
  v_mfma_f32_16x16x32_bf16 v[156:159], a[144:147], v[52:55], v[156:159]
  ds_read_b64_tr_b16 a[168:169], v21 offset:8192
  ds_read_b64_tr_b16 a[170:171], v21 offset:9216
  v_mfma_f32_16x16x32_bf16 v[148:151], a[148:151], v[52:55], v[148:151]
  buffer_load_dwordx4 v33, s[12:15], s66 offen lds
  v_mfma_f32_16x16x32_bf16 v[144:147], a[148:151], v[48:51], v[144:147]
  s_mul_i32 s99, s32, 640
  s_add_u32 s42, s42, s99
  ds_read_b64_tr_b16 a[172:173], v24 offset:8192
  v_mfma_f32_16x16x32_bf16 v[136:139], a[152:155], v[48:51], v[136:139]
  s_lshl_b32 s99, s31, 6
  s_add_u32 s42, s42, s99
  ds_read_b64_tr_b16 a[174:175], v24 offset:9216
  v_mfma_f32_16x16x32_bf16 v[140:143], a[152:155], v[52:55], v[140:143]
  s_waitcnt lgkmcnt(6)
  ds_read_b64_tr_b16 a[144:145], v15 offset:12288
  v_mfma_f32_16x16x32_bf16 v[132:135], a[156:159], v[52:55], v[132:135]
  s_add_u32 s94, s31, 6
  s_and_b32 s94, s94, 6
  ds_read_b64_tr_b16 a[146:147], v15 offset:13312
  v_mfma_f32_16x16x32_bf16 v[128:131], a[156:159], v[48:51], v[128:131]
  s_mul_i32 s94, s94, 147456
  s_add_u32 s50, s94, s40
  ds_read_b64_tr_b16 a[148:149], v18 offset:12288
  v_mfma_f32_16x16x32_bf16 v[152:155], a[160:163], v[56:59], v[152:155]
  s_add_u32 s94, s31, 4
  s_and_b32 s94, s94, 6
  ds_read_b64_tr_b16 a[150:151], v18 offset:13312
  v_mfma_f32_16x16x32_bf16 v[156:159], a[160:163], v[60:63], v[156:159]
  s_waitcnt lgkmcnt(6)
  s_lshl_b32 s99, 3, s94
  s_mul_i32 s94, s94, 147456
  ds_read_b64_tr_b16 a[152:153], v21 offset:12288
  v_mfma_f32_16x16x32_bf16 v[148:151], a[164:167], v[60:63], v[148:151]
  ds_read_b64_tr_b16 a[154:155], v21 offset:13312
  ds_read_b64_tr_b16 a[156:157], v24 offset:12288
  s_lshl_b32 s95, s77, 6
  s_add_u32 s95, s95, 8192
  s_waitcnt vmcnt(8)
  v_cmp_ne_u32 vcc, s34, v9
  s_cbranch_vccz L_f2_ok
  s_mov_b32 s98, 0
L_f2_spin:
  s_sleep 1
  buffer_load_dword v9, v8, s[16:19], s95 offen sc1
  s_waitcnt vmcnt(0)
  v_cmp_ne_u32 vcc, s34, v9
  s_cbranch_vccz L_f2_ok
  s_add_u32 s98, s98, 1
  s_cmp_lt_u32 s98, 0x8000
  s_cbranch_scc1 L_f2_spin
L_f2_ok:
  s_nop 1
  s_lshl_b32 s91, s77, 10
  s_add_u32 s91, s91, s33
  s_lshl_b32 s91, s91, 7
  s_add_u32 s91, s91, 2097152
  s_lshr_b32 s92, 5, s31
  s_bitcmp1_b32 s92, 0
  s_cbranch_scc0 L_t2c
  s_add_u32 s86, s91, 262144
  buffer_load_dwordx2 a[88:89], v10, s[16:19], s86 offen sc1
  buffer_load_dwordx2 a[90:91], v11, s[16:19], s86 offen sc1
  s_add_u32 s86, s91, 327680
  buffer_load_dwordx2 a[92:93], v10, s[16:19], s86 offen sc1
  buffer_load_dwordx2 a[94:95], v11, s[16:19], s86 offen sc1
L_t2c:
  v_mfma_f32_16x16x32_bf16 v[144:147], a[164:167], v[56:59], v[144:147]
  buffer_load_dword v39, off, s[16:19], s43 offset:0 sc1
  v_mfma_f32_16x16x32_bf16 v[136:139], a[168:171], v[56:59], v[136:139]
  s_waitcnt lgkmcnt(5)
  s_add_u32 s86, s91, 0
  ds_read_b64_tr_b16 a[158:159], v24 offset:13312
  v_mfma_f32_16x16x32_bf16 v[140:143], a[168:171], v[60:63], v[140:143]
  ds_read_b64_tr_b16 a[160:161], v15 offset:16384
  ds_read_b64_tr_b16 a[162:163], v15 offset:17408
  v_mfma_f32_16x16x32_bf16 v[132:135], a[172:175], v[60:63], v[132:135]
  buffer_load_dwordx2 a[72:73], v10, s[16:19], s86 offen sc1
  v_mfma_f32_16x16x32_bf16 v[128:131], a[172:175], v[56:59], v[128:131]
  ds_read_b64_tr_b16 a[164:165], v18 offset:16384
  ds_read_b64_tr_b16 a[166:167], v18 offset:17408
  v_mfma_f32_16x16x32_bf16 v[152:155], a[144:147], v[64:67], v[152:155]
  buffer_load_dwordx2 a[74:75], v11, s[16:19], s86 offen sc1
  v_mfma_f32_16x16x32_bf16 v[156:159], a[144:147], v[68:71], v[156:159]
  s_waitcnt lgkmcnt(6)
  s_add_u32 s86, s91, 65536
  ds_read_b64_tr_b16 a[168:169], v21 offset:16384
  v_mfma_f32_16x16x32_bf16 v[148:151], a[148:151], v[68:71], v[148:151]
  ds_read_b64_tr_b16 a[170:171], v21 offset:17408
  ds_read_b64_tr_b16 a[172:173], v24 offset:16384
  v_mfma_f32_16x16x32_bf16 v[144:147], a[148:151], v[64:67], v[144:147]
  s_waitcnt lgkmcnt(5)
  buffer_load_dwordx2 a[76:77], v10, s[16:19], s86 offen sc1
  v_mfma_f32_16x16x32_bf16 v[136:139], a[152:155], v[64:67], v[136:139]
  s_waitcnt vmcnt(8)
  s_barrier
  ds_read_b64_tr_b16 a[174:175], v24 offset:17408
  s_add_u32 s93, s83, 8
  s_cmp_eq_u32 s28, 0
  s_cselect_b32 s93, s93, 1073741824
  v_mov_b32 v0, s34
  buffer_store_dword v0, off, s[16:19], s93 sc1
  v_mfma_f32_16x16x32_bf16 v[140:143], a[152:155], v[68:71], v[140:143]
  ds_read_b64_tr_b16 a[144:145], v15 offset:20480
  ds_read_b64_tr_b16 a[146:147], v15 offset:21504
  s_lshr_b32 s92, 5, s31
  s_bitcmp1_b32 s92, 0
  s_cbranch_scc0 L_gd3d
  s_add_u32 m0, s36, 108544
  s_add_u32 s87, s41, 36864
  buffer_load_dwordx4 v2, s[16:19], s87 offen sc1 lds
  s_add_u32 m0, s36, 112640
  s_add_u32 s87, s41, 40960
  buffer_load_dwordx4 v2, s[16:19], s87 offen sc1 lds
  s_add_u32 m0, s36, 116736
  s_add_u32 s87, s41, 45056
  buffer_load_dwordx4 v2, s[16:19], s87 offen sc1 lds
  s_add_u32 m0, s36, 120832
  s_add_u32 s87, s41, 49152
  buffer_load_dwordx4 v2, s[16:19], s87 offen sc1 lds
  s_add_u32 m0, s82, 108544
  s_sub_u32 s87, s82, s36
  s_add_u32 s87, s87, s41
  s_add_u32 s87, s87, 36864
  buffer_load_dwordx4 v2, s[16:19], s87 offen sc1 lds
L_gd3d:
  v_mfma_f32_16x16x32_bf16 v[132:135], a[156:159], v[68:71], v[132:135]
  buffer_load_dwordx2 a[78:79], v11, s[16:19], s86 offen sc1
  v_mfma_f32_16x16x32_bf16 v[128:131], a[156:159], v[64:67], v[128:131]
  s_add_u32 s86, s91, 131072
  ds_read_b64_tr_b16 a[148:149], v18 offset:20480
  v_mfma_f32_16x16x32_bf16 v[152:155], a[160:163], v[72:75], v[152:155]
  ds_read_b64_tr_b16 a[150:151], v18 offset:21504
  ds_read_b64_tr_b16 a[152:153], v21 offset:20480
  v_mfma_f32_16x16x32_bf16 v[156:159], a[160:163], v[76:79], v[156:159]
  s_waitcnt lgkmcnt(7)
  buffer_load_dwordx2 a[80:81], v10, s[16:19], s86 offen sc1
  v_mfma_f32_16x16x32_bf16 v[148:151], a[164:167], v[76:79], v[148:151]
  ds_read_b64_tr_b16 a[154:155], v21 offset:21504
  ds_read_b64_tr_b16 a[156:157], v24 offset:20480
  v_mfma_f32_16x16x32_bf16 v[144:147], a[164:167], v[72:75], v[144:147]
  buffer_load_dwordx2 a[82:83], v11, s[16:19], s86 offen sc1
  v_mfma_f32_16x16x32_bf16 v[136:139], a[168:171], v[72:75], v[136:139]
  s_waitcnt lgkmcnt(5)
  s_add_u32 s86, s91, 196608
  ds_read_b64_tr_b16 a[158:159], v24 offset:21504
  v_mfma_f32_16x16x32_bf16 v[140:143], a[168:171], v[76:79], v[140:143]
  ds_read_b64_tr_b16 a[160:161], v15 offset:24576
  ds_read_b64_tr_b16 a[162:163], v15 offset:25600
  v_mfma_f32_16x16x32_bf16 v[132:135], a[172:175], v[76:79], v[132:135]
  buffer_load_dwordx2 a[84:85], v10, s[16:19], s86 offen sc1
  v_mfma_f32_16x16x32_bf16 v[128:131], a[172:175], v[72:75], v[128:131]
  ds_read_b64_tr_b16 a[164:165], v18 offset:24576
  ds_read_b64_tr_b16 a[166:167], v18 offset:25600
  v_mfma_f32_16x16x32_bf16 v[152:155], a[144:147], v[80:83], v[152:155]
  s_waitcnt lgkmcnt(6)
  buffer_load_dwordx2 a[86:87], v11, s[16:19], s86 offen sc1
  v_mfma_f32_16x16x32_bf16 v[156:159], a[144:147], v[84:87], v[156:159]
  s_add_u32 m0, s36, 126976
  s_add_u32 s97, s41, 0
  ds_read_b64_tr_b16 a[168:169], v21 offset:24576
  v_mfma_f32_16x16x32_bf16 v[148:151], a[148:151], v[84:87], v[148:151]
  ds_read_b64_tr_b16 a[170:171], v21 offset:25600
  ds_read_b64_tr_b16 a[172:173], v24 offset:24576
  v_mfma_f32_16x16x32_bf16 v[144:147], a[148:151], v[80:83], v[144:147]
  s_waitcnt lgkmcnt(5)
  buffer_load_dwordx4 v2, s[16:19], s97 offen sc1 lds
  v_mfma_f32_16x16x32_bf16 v[136:139], a[152:155], v[80:83], v[136:139]
  s_add_u32 s52, s94, s40
  s_add_u32 s94, s31, 2
  ds_read_b64_tr_b16 a[174:175], v24 offset:25600
  v_mfma_f32_16x16x32_bf16 v[140:143], a[152:155], v[84:87], v[140:143]
  s_add_u32 m0, s36, 131072
  s_add_u32 s97, s41, 4096
  ds_read_b64_tr_b16 a[144:145], v28 offset:24576
  v_mfma_f32_16x16x32_bf16 v[132:135], a[156:159], v[84:87], v[132:135]
  ds_read_b64_tr_b16 a[146:147], v28 offset:25088
  ds_read_b64_tr_b16 a[148:149], v30 offset:24576
  v_mfma_f32_16x16x32_bf16 v[128:131], a[156:159], v[80:83], v[128:131]
  buffer_load_dwordx4 v2, s[16:19], s97 offen sc1 lds
  v_mfma_f32_16x16x32_bf16 v[152:155], a[160:163], v[88:91], v[152:155]
  s_waitcnt lgkmcnt(5)
  ds_read_b64_tr_b16 a[150:151], v30 offset:25088
  v_mfma_f32_16x16x32_bf16 v[156:159], a[160:163], v[92:95], v[156:159]
  s_add_u32 m0, s36, 135168
  s_add_u32 s97, s41, 8192
  ds_read_b64_tr_b16 a[152:153], v28 offset:26624
  v_mfma_f32_16x16x32_bf16 v[148:151], a[164:167], v[92:95], v[148:151]
  ds_read_b64_tr_b16 a[154:155], v28 offset:27136
  ds_read_b64_tr_b16 a[156:157], v30 offset:26624
  v_mfma_f32_16x16x32_bf16 v[144:147], a[164:167], v[88:91], v[144:147]
  buffer_load_dwordx4 v2, s[16:19], s97 offen sc1 lds
  v_mfma_f32_16x16x32_bf16 v[136:139], a[168:171], v[88:91], v[136:139]
  s_and_b32 s94, s94, 6
  s_lshl_b32 s57, 3, s94
  ds_read_b64_tr_b16 a[158:159], v30 offset:27136
  v_mfma_f32_16x16x32_bf16 v[140:143], a[168:171], v[92:95], v[140:143]
  s_waitcnt lgkmcnt(6)
  ds_read_b64_tr_b16 a[160:161], v28 offset:28672
  v_mfma_f32_16x16x32_bf16 v[132:135], a[172:175], v[92:95], v[132:135]
  ds_read_b64_tr_b16 a[162:163], v28 offset:29184
  ds_read_b64_tr_b16 a[164:165], v30 offset:28672
  s_waitcnt vmcnt(12)
  v_cmp_ne_u32 vcc, s34, v39
  s_cbranch_vccz L_fh_ok
  s_mov_b32 s98, 0
L_fh_spin:
  s_sleep 1
  buffer_load_dword v39, off, s[16:19], s43 offset:0 sc1
  s_waitcnt vmcnt(0)
  v_cmp_ne_u32 vcc, s34, v39
  s_cbranch_vccz L_fh_ok
  s_add_u32 s98, s98, 1
  s_cmp_lt_u32 s98, 0x8000
  s_cbranch_scc1 L_fh_spin
L_fh_ok:
  s_nop 1
  v_mfma_f32_16x16x32_bf16 v[128:131], a[172:175], v[88:91], v[128:131]
  s_add_u32 m0, s36, 139264
  s_add_u32 s97, s41, 12288
  buffer_load_dwordx4 v2, s[16:19], s97 offen sc1 lds
  v_mfma_f32_16x16x32_bf16 v[120:123], a[144:147], v[40:43], 0
  s_mul_i32 s94, s94, 147456
  s_add_u32 s54, s94, s40
  ds_read_b64_tr_b16 a[166:167], v30 offset:29184
  v_mfma_f32_16x16x32_bf16 v[124:127], a[144:147], v[44:47], 0
  s_waitcnt lgkmcnt(6)
  s_add_u32 m0, s36, 143360
  s_add_u32 s97, s41, 16384
  ds_read_b64_tr_b16 a[168:169], v28 offset:30720
  v_mfma_f32_16x16x32_bf16 v[116:119], a[148:151], v[44:47], 0
  ds_read_b64_tr_b16 a[170:171], v28 offset:31232
  ds_read_b64_tr_b16 a[172:173], v30 offset:30720
  v_mfma_f32_16x16x32_bf16 v[112:115], a[148:151], v[40:43], 0
  s_waitcnt lgkmcnt(7)
  buffer_load_dwordx4 v2, s[16:19], s97 offen sc1 lds
  v_mfma_f32_16x16x32_bf16 v[120:123], a[152:155], v[48:51], v[120:123]
  s_or_b32 s57, s57, s99
  s_xor_b32 s94, s31, 1
  ds_read_b64_tr_b16 a[174:175], v30 offset:31232
  v_mfma_f32_16x16x32_bf16 v[124:127], a[152:155], v[52:55], v[124:127]
  s_add_u32 m0, s36, 147456
  s_add_u32 s97, s41, 20480
  ds_read_b64_tr_b16 a[144:145], v28 offset:32768
  v_mfma_f32_16x16x32_bf16 v[116:119], a[156:159], v[52:55], v[116:119]
  ds_read_b64_tr_b16 a[146:147], v28 offset:33280
  ds_read_b64_tr_b16 a[148:149], v30 offset:32768
  v_mfma_f32_16x16x32_bf16 v[112:115], a[156:159], v[48:51], v[112:115]
  s_waitcnt lgkmcnt(7)
  buffer_load_dwordx4 v2, s[16:19], s97 offen sc1 lds
  v_mfma_f32_16x16x32_bf16 v[120:123], a[160:163], v[56:59], v[120:123]
  s_barrier
  ds_read_b64_tr_b16 a[150:151], v30 offset:33280
  v_mfma_f32_16x16x32_bf16 v[124:127], a[160:163], v[60:63], v[124:127]
  s_add_u32 m0, s36, 151552
  s_add_u32 s97, s41, 24576
  ds_read_b64_tr_b16 a[152:153], v28 offset:34816
  v_mfma_f32_16x16x32_bf16 v[116:119], a[164:167], v[60:63], v[116:119]
  ds_read_b64_tr_b16 a[154:155], v28 offset:35328
  ds_read_b64_tr_b16 a[156:157], v30 offset:34816
  v_mfma_f32_16x16x32_bf16 v[112:115], a[164:167], v[56:59], v[112:115]
  s_waitcnt lgkmcnt(7)
  buffer_load_dwordx4 v2, s[16:19], s97 offen sc1 lds
  v_mfma_f32_16x16x32_bf16 v[120:123], a[168:171], v[64:67], v[120:123]
  s_lshl_b32 s99, 1, s94
  s_or_b32 s57, s57, s99
  ds_read_b64_tr_b16 a[158:159], v30 offset:35328
  v_mfma_f32_16x16x32_bf16 v[124:127], a[168:171], v[68:71], v[124:127]
  s_add_u32 m0, s36, 155648
  s_add_u32 s97, s41, 28672
  ds_read_b64_tr_b16 a[160:161], v28 offset:36864
  v_mfma_f32_16x16x32_bf16 v[116:119], a[172:175], v[68:71], v[116:119]
  ds_read_b64_tr_b16 a[162:163], v28 offset:37376
  ds_read_b64_tr_b16 a[164:165], v30 offset:36864
  v_mfma_f32_16x16x32_bf16 v[112:115], a[172:175], v[64:67], v[112:115]
  s_waitcnt lgkmcnt(7)
  buffer_load_dwordx4 v2, s[16:19], s97 offen sc1 lds
  v_mfma_f32_16x16x32_bf16 v[120:123], a[144:147], v[72:75], v[120:123]
  s_mul_i32 s94, s94, 147456
  s_add_u32 s56, s94, s40
  ds_read_b64_tr_b16 a[166:167], v30 offset:37376
  v_mfma_f32_16x16x32_bf16 v[124:127], a[144:147], v[76:79], v[124:127]
  s_add_u32 m0, s36, 159744
  s_add_u32 s97, s41, 32768
  ds_read_b64_tr_b16 a[168:169], v15 offset:36864
  v_mfma_f32_16x16x32_bf16 v[116:119], a[148:151], v[76:79], v[116:119]
  ds_read_b64_tr_b16 a[170:171], v15 offset:37888
  ds_read_b64_tr_b16 a[172:173], v18 offset:36864
  v_mfma_f32_16x16x32_bf16 v[112:115], a[148:151], v[72:75], v[112:115]
  s_waitcnt lgkmcnt(7)
  buffer_load_dwordx4 v2, s[16:19], s97 offen sc1 lds
  v_mfma_f32_16x16x32_bf16 v[120:123], a[152:155], v[80:83], v[120:123]
  ds_read_b64_tr_b16 a[174:175], v18 offset:37888
  v_mfma_f32_16x16x32_bf16 v[124:127], a[152:155], v[84:87], v[124:127]
  s_add_u32 m0, s36, 16384
  ds_read_b64_tr_b16 a[144:145], v21 offset:36864
  v_mfma_f32_16x16x32_bf16 v[116:119], a[156:159], v[84:87], v[116:119]
  ds_read_b64_tr_b16 a[146:147], v21 offset:37888
  ds_read_b64_tr_b16 a[148:149], v24 offset:36864
  v_mfma_f32_16x16x32_bf16 v[112:115], a[156:159], v[80:83], v[112:115]
  s_waitcnt lgkmcnt(7)
  buffer_load_dwordx4 v6, s[12:15], s67 offen lds
  v_mfma_f32_16x16x32_bf16 v[120:123], a[160:163], v[88:91], v[120:123]
  ds_read_b64_tr_b16 a[150:151], v24 offset:37888
  v_and_b32 v34, 15, v1
  v_mfma_f32_16x16x32_bf16 v[124:127], a[160:163], v[92:95], v[124:127]
  s_add_u32 m0, s36, 20480
  ds_read_b64_tr_b16 a[152:153], v15 offset:45056
  v_mfma_f32_16x16x32_bf16 v[116:119], a[164:167], v[92:95], v[116:119]
  ds_read_b64_tr_b16 a[154:155], v15 offset:46080
  ds_read_b64_tr_b16 a[156:157], v18 offset:45056
  v_mfma_f32_16x16x32_bf16 v[112:115], a[164:167], v[88:91], v[112:115]
  s_waitcnt lgkmcnt(7)
  buffer_load_dwordx4 v6, s[12:15], s68 offen lds
  v_mfma_f32_16x16x32_bf16 v[248:251], a[168:171], v[96:99], v[248:251]
  ds_read_b64_tr_b16 a[158:159], v18 offset:46080
  v_mul_u32_u24 v34, 73728, v34
  v_mfma_f32_16x16x32_bf16 v[252:255], a[168:171], v[100:103], v[252:255]
  s_waitcnt lgkmcnt(6)
  ds_read_b64_tr_b16 a[160:161], v21 offset:45056
  s_waitcnt vmcnt(18)
  v_mfma_f32_16x16x32_bf16 v[56:59], a[72:75], a[240:243], 0
  v_mfma_f32_16x16x32_bf16 v[244:247], a[172:175], v[100:103], v[244:247]
  ds_read_b64_tr_b16 a[162:163], v21 offset:46080
  ds_read_b64_tr_b16 a[164:165], v24 offset:45056
  v_mfma_f32_16x16x32_bf16 v[60:63], a[72:75], a[248:251], 0
  v_mfma_f32_16x16x32_bf16 v[240:243], a[172:175], v[96:99], v[240:243]
  s_add_u32 m0, s36, 24576
  s_nop 0
  buffer_load_dwordx4 v6, s[12:15], s69 offen lds
  v_mfma_f32_16x16x32_bf16 v[64:67], a[72:75], a[244:247], 0
  v_mfma_f32_16x16x32_bf16 v[232:235], a[144:147], v[96:99], v[232:235]
  ds_read_b64_tr_b16 a[166:167], v24 offset:46080
  v_lshrrev_b32 v35, 4, v1
  v_mfma_f32_16x16x32_bf16 v[68:71], a[72:75], a[252:255], 0
  v_mfma_f32_16x16x32_bf16 v[236:239], a[144:147], v[100:103], v[236:239]
  s_waitcnt lgkmcnt(6)
  ds_read_b64_tr_b16 a[168:169], v16 offset:4096
  v_mfma_f32_16x16x32_bf16 v[228:231], a[148:151], v[100:103], v[228:231]
  ds_read_b64_tr_b16 a[170:171], v16 offset:5120
  ds_read_b64_tr_b16 a[172:173], v19 offset:4096
  s_waitcnt vmcnt(16)
  v_mfma_f32_16x16x32_bf16 v[72:75], a[76:79], a[240:243], 0
  v_mfma_f32_16x16x32_bf16 v[224:227], a[148:151], v[96:99], v[224:227]
  s_add_u32 s96, s81, 0
  buffer_load_dwordx4 a[0:3], v2, s[16:19], s96 offen offset:0 sc1
  v_mfma_f32_16x16x32_bf16 v[76:79], a[76:79], a[248:251], 0
  v_mfma_f32_16x16x32_bf16 v[216:219], a[152:155], v[96:99], v[216:219]
  ds_read_b64_tr_b16 a[174:175], v19 offset:5120
  v_sub_f32 v56, v56, v61
  v_add_f32 v57, v57, v60
  v_mfma_f32_16x16x32_bf16 v[80:83], a[76:79], a[244:247], 0
  v_mfma_f32_16x16x32_bf16 v[220:223], a[152:155], v[100:103], v[220:223]
  s_waitcnt lgkmcnt(6)
  ds_read_b64_tr_b16 a[144:145], v22 offset:4096
  v_sub_f32 v58, v58, v63
  v_add_f32 v59, v59, v62
  v_mfma_f32_16x16x32_bf16 v[84:87], a[76:79], a[252:255], 0
  v_mfma_f32_16x16x32_bf16 v[212:215], a[156:159], v[100:103], v[212:215]
  ds_read_b64_tr_b16 a[146:147], v22 offset:5120
  v_cvt_pk_bf16_f32 v40, v56, v57
  v_cvt_pk_bf16_f32 v41, v58, v59
  v_mfma_f32_16x16x32_bf16 v[208:211], a[156:159], v[96:99], v[208:211]
  s_waitcnt lgkmcnt(6)
  ds_read_b64_tr_b16 a[148:149], v25 offset:4096
  v_mfma_f32_16x16x32_bf16 v[200:203], a[160:163], v[96:99], v[200:203]
  ds_read_b64_tr_b16 a[150:151], v25 offset:5120
  v_sub_f32 v64, v64, v69
  v_add_f32 v65, v65, v68
  v_mfma_f32_16x16x32_bf16 v[204:207], a[160:163], v[100:103], v[204:207]
  ds_read_b64_tr_b16 a[152:153], v16 offset:12288
  v_sub_f32 v66, v66, v71
  v_add_f32 v67, v67, v70
  v_mfma_f32_16x16x32_bf16 v[196:199], a[164:167], v[100:103], v[196:199]
  ds_read_b64_tr_b16 a[154:155], v16 offset:13312
  v_cvt_pk_bf16_f32 v44, v64, v65
  v_cvt_pk_bf16_f32 v45, v66, v67
  v_mfma_f32_16x16x32_bf16 v[192:195], a[164:167], v[96:99], v[192:195]
  s_waitcnt lgkmcnt(6)
  ds_read_b64_tr_b16 a[156:157], v19 offset:12288
  v_sub_f32 v72, v72, v77
  v_add_f32 v73, v73, v76
  s_waitcnt vmcnt(15)
  v_mfma_f32_16x16x32_bf16 v[56:59], a[80:83], a[240:243], 0
  v_mfma_f32_16x16x32_bf16 v[184:187], a[168:171], v[96:99], v[184:187]
  ds_read_b64_tr_b16 a[158:159], v19 offset:13312
  v_sub_f32 v74, v74, v79
  v_add_f32 v75, v75, v78
  v_mfma_f32_16x16x32_bf16 v[60:63], a[80:83], a[248:251], 0
  v_mfma_f32_16x16x32_bf16 v[188:191], a[168:171], v[100:103], v[188:191]
  ds_read_b64_tr_b16 a[160:161], v22 offset:12288
  v_cvt_pk_bf16_f32 v42, v72, v73
  v_cvt_pk_bf16_f32 v43, v74, v75
  v_mfma_f32_16x16x32_bf16 v[64:67], a[80:83], a[244:247], 0
  v_mfma_f32_16x16x32_bf16 v[180:183], a[172:175], v[100:103], v[180:183]
  s_waitcnt lgkmcnt(5)
  ds_read_b64_tr_b16 a[162:163], v22 offset:13312
  v_mfma_f32_16x16x32_bf16 v[68:71], a[80:83], a[252:255], 0
  v_mfma_f32_16x16x32_bf16 v[176:179], a[172:175], v[96:99], v[176:179]
  ds_read_b64_tr_b16 a[164:165], v25 offset:12288
  ds_read_b64_tr_b16 a[166:167], v25 offset:13312
  v_mfma_f32_16x16x32_bf16 v[168:171], a[144:147], v[96:99], v[168:171]
  s_add_u32 m0, s36, 28672
  s_nop 0
  buffer_load_dwordx4 v6, s[12:15], s70 offen lds
  v_mfma_f32_16x16x32_bf16 v[172:175], a[144:147], v[100:103], v[172:175]
  ds_read_b64_tr_b16 a[168:169], v28 offset:38912
  v_mfma_f32_16x16x32_bf16 v[164:167], a[148:151], v[100:103], v[164:167]
  s_waitcnt lgkmcnt(5)
  s_add_u32 m0, s36, 32768
  ds_read_b64_tr_b16 a[170:171], v28 offset:39424
  v_mfma_f32_16x16x32_bf16 v[160:163], a[148:151], v[96:99], v[160:163]
  ds_read_b64_tr_b16 a[172:173], v30 offset:38912
  ds_read_b64_tr_b16 a[174:175], v30 offset:39424
  v_mfma_f32_16x16x32_bf16 v[152:155], a[152:155], v[96:99], v[152:155]
  buffer_load_dwordx4 v6, s[12:15], s71 offen lds
  v_mfma_f32_16x16x32_bf16 v[156:159], a[152:155], v[100:103], v[156:159]
  ds_read_b64_tr_b16 a[144:145], v15 offset:40960
  v_sub_f32 v80, v80, v85
  v_add_f32 v81, v81, v84
  v_mfma_f32_16x16x32_bf16 v[148:151], a[156:159], v[100:103], v[148:151]
  s_waitcnt lgkmcnt(5)
  s_add_u32 m0, s36, 36864
  ds_read_b64_tr_b16 a[146:147], v15 offset:41984
  v_mfma_f32_16x16x32_bf16 v[144:147], a[156:159], v[96:99], v[144:147]
  ds_read_b64_tr_b16 a[148:149], v18 offset:40960
  ds_read_b64_tr_b16 a[150:151], v18 offset:41984
  v_mfma_f32_16x16x32_bf16 v[136:139], a[160:163], v[96:99], v[136:139]
  buffer_load_dwordx4 v6, s[12:15], s72 offen lds
  v_mfma_f32_16x16x32_bf16 v[140:143], a[160:163], v[100:103], v[140:143]
  ds_read_b64_tr_b16 a[152:153], v21 offset:40960
  v_sub_f32 v82, v82, v87
  v_add_f32 v83, v83, v86
  v_mfma_f32_16x16x32_bf16 v[132:135], a[164:167], v[100:103], v[132:135]
  s_waitcnt lgkmcnt(5)
  s_add_u32 m0, s36, 40960
  ds_read_b64_tr_b16 a[154:155], v21 offset:41984
  v_mfma_f32_16x16x32_bf16 v[128:131], a[164:167], v[96:99], v[128:131]
  ds_read_b64_tr_b16 a[156:157], v24 offset:40960
  ds_read_b64_tr_b16 a[158:159], v24 offset:41984
  v_mfma_f32_16x16x32_bf16 v[120:123], a[168:171], v[96:99], v[120:123]
  s_waitcnt lgkmcnt(6)
  buffer_load_dwordx4 v6, s[12:15], s73 offen lds
  v_mfma_f32_16x16x32_bf16 v[124:127], a[168:171], v[100:103], v[124:127]
  ds_read_b64_tr_b16 a[160:161], v16 offset:0
  v_cvt_pk_bf16_f32 v46, v80, v81
  v_cvt_pk_bf16_f32 v47, v82, v83
  v_mfma_f32_16x16x32_bf16 v[116:119], a[172:175], v[100:103], v[116:119]
  ds_read_b64_tr_b16 a[162:163], v16 offset:1024
  v_sub_f32 v56, v56, v61
  v_add_f32 v57, v57, v60
  s_waitcnt vmcnt(17)
  v_mfma_f32_16x16x32_bf16 v[72:75], a[84:87], a[240:243], 0
  v_mfma_f32_16x16x32_bf16 v[112:115], a[172:175], v[96:99], v[112:115]
  ds_read_b64_tr_b16 a[164:165], v19 offset:0
  v_sub_f32 v58, v58, v63
  v_add_f32 v59, v59, v62
  v_mfma_f32_16x16x32_bf16 v[76:79], a[84:87], a[248:251], 0
  v_mfma_f32_16x16x32_bf16 v[248:251], a[144:147], v[104:107], v[248:251]
  s_waitcnt vmcnt(8)
  s_barrier
  ds_read_b64_tr_b16 a[166:167], v19 offset:1024
  v_mfma_f32_16x16x32_bf16 v[80:83], a[84:87], a[244:247], 0
  v_mfma_f32_16x16x32_bf16 v[252:255], a[144:147], v[108:111], v[252:255]
  s_waitcnt lgkmcnt(4)
  ds_read_b64_tr_b16 a[168:169], v22 offset:0
  v_mfma_f32_16x16x32_bf16 v[84:87], a[84:87], a[252:255], 0
  v_mfma_f32_16x16x32_bf16 v[244:247], a[148:151], v[108:111], v[244:247]
  ds_read_b64_tr_b16 a[170:171], v22 offset:1024
  ds_read_b64_tr_b16 a[172:173], v25 offset:0
  v_mfma_f32_16x16x32_bf16 v[240:243], a[148:151], v[104:107], v[240:243]
  s_add_u32 m0, s36, 45056
  s_nop 0
  buffer_load_dwordx4 v6, s[12:15], s74 offen lds
  v_mfma_f32_16x16x32_bf16 v[232:235], a[152:155], v[104:107], v[232:235]
  ds_read_b64_tr_b16 a[174:175], v25 offset:1024
  v_mfma_f32_16x16x32_bf16 v[236:239], a[152:155], v[108:111], v[236:239]
  s_add_u32 m0, s36, 49152
  ds_read_b64_tr_b16 a[144:145], v16 offset:8192
  v_mfma_f32_16x16x32_bf16 v[228:231], a[156:159], v[108:111], v[228:231]
  ds_read_b64_tr_b16 a[146:147], v16 offset:9216
  ds_read_b64_tr_b16 a[148:149], v19 offset:8192
  v_mfma_f32_16x16x32_bf16 v[224:227], a[156:159], v[104:107], v[224:227]
  s_waitcnt lgkmcnt(7)
  buffer_load_dwordx4 v6, s[12:15], s75 offen lds
  v_mfma_f32_16x16x32_bf16 v[216:219], a[160:163], v[104:107], v[216:219]
  ds_read_b64_tr_b16 a[150:151], v19 offset:9216
  v_cvt_pk_bf16_f32 v48, v56, v57
  v_cvt_pk_bf16_f32 v49, v58, v59
  v_mfma_f32_16x16x32_bf16 v[220:223], a[160:163], v[108:111], v[220:223]
  ds_read_b64_tr_b16 a[152:153], v22 offset:8192
  v_sub_f32 v64, v64, v69
  v_add_f32 v65, v65, v68
  v_mfma_f32_16x16x32_bf16 v[212:215], a[164:167], v[108:111], v[212:215]
  ds_read_b64_tr_b16 a[154:155], v22 offset:9216
  v_sub_f32 v66, v66, v71
  v_add_f32 v67, v67, v70
  v_mfma_f32_16x16x32_bf16 v[208:211], a[164:167], v[104:107], v[208:211]
  s_waitcnt lgkmcnt(6)
  ds_read_b64_tr_b16 a[156:157], v25 offset:8192
  v_cvt_pk_bf16_f32 v52, v64, v65
  v_cvt_pk_bf16_f32 v53, v66, v67
  v_mfma_f32_16x16x32_bf16 v[200:203], a[168:171], v[104:107], v[200:203]
  ds_read_b64_tr_b16 a[158:159], v25 offset:9216
  v_sub_f32 v72, v72, v77
  v_add_f32 v73, v73, v76
  v_mfma_f32_16x16x32_bf16 v[204:207], a[168:171], v[108:111], v[204:207]
  ds_read_b64_tr_b16 a[160:161], v16 offset:16384
  v_sub_f32 v74, v74, v79
  v_add_f32 v75, v75, v78
  v_mfma_f32_16x16x32_bf16 v[196:199], a[172:175], v[108:111], v[196:199]
  s_waitcnt lgkmcnt(5)
  ds_read_b64_tr_b16 a[162:163], v16 offset:17408
  v_mfma_f32_16x16x32_bf16 v[192:195], a[172:175], v[104:107], v[192:195]
  ds_read_b64_tr_b16 a[164:165], v19 offset:16384
  v_cvt_pk_bf16_f32 v50, v72, v73
  v_cvt_pk_bf16_f32 v51, v74, v75
  v_mfma_f32_16x16x32_bf16 v[184:187], a[144:147], v[104:107], v[184:187]
  ds_read_b64_tr_b16 a[166:167], v19 offset:17408
  v_sub_f32 v80, v80, v85
  v_add_f32 v81, v81, v84
  v_mfma_f32_16x16x32_bf16 v[188:191], a[144:147], v[108:111], v[188:191]
  ds_read_b64_tr_b16 a[168:169], v22 offset:16384
  v_sub_f32 v82, v82, v87
  v_add_f32 v83, v83, v86
  v_mfma_f32_16x16x32_bf16 v[180:183], a[148:151], v[108:111], v[180:183]
  ds_read_b64_tr_b16 a[170:171], v22 offset:17408
  v_cvt_pk_bf16_f32 v54, v80, v81
  v_cvt_pk_bf16_f32 v55, v82, v83
  v_mfma_f32_16x16x32_bf16 v[176:179], a[148:151], v[104:107], v[176:179]
  s_waitcnt lgkmcnt(6)
  ds_read_b64_tr_b16 a[172:173], v25 offset:16384
  ds_read_b64_tr_b16 a[174:175], v25 offset:17408
  v_mfma_f32_16x16x32_bf16 v[168:171], a[152:155], v[104:107], v[168:171]
  s_waitcnt lgkmcnt(6)
  buffer_load_dwordx4 a[4:7], v2, s[16:19], s96 offen offset:1024 sc1
  v_mfma_f32_16x16x32_bf16 v[172:175], a[152:155], v[108:111], v[172:175]
  ds_read_b64_tr_b16 a[144:145], v28 offset:40960
  v_lshl_add_u32 v34, v35, 4, v34
  v_mfma_f32_16x16x32_bf16 v[164:167], a[156:159], v[108:111], v[164:167]
  ds_read_b64_tr_b16 a[146:147], v28 offset:41472
  v_add_u32 v38, 1179648, v34
  v_mfma_f32_16x16x32_bf16 v[160:163], a[156:159], v[104:107], v[160:163]
  ds_read_b64_tr_b16 a[148:149], v30 offset:40960
  ds_read_b64_tr_b16 a[150:151], v30 offset:41472
  v_mfma_f32_16x16x32_bf16 v[152:155], a[160:163], v[104:107], v[152:155]
  buffer_load_dwordx4 a[8:11], v2, s[16:19], s96 offen offset:2048 sc1
  v_mfma_f32_16x16x32_bf16 v[156:159], a[160:163], v[108:111], v[156:159]
  s_waitcnt lgkmcnt(4)
  ds_read_b128 a[152:155], v31 offset:12288
  v_mfma_f32_16x16x32_bf16 v[148:151], a[164:167], v[108:111], v[148:151]
  ds_read_b128 a[156:159], v31 offset:13312
  v_lshrrev_b32 v35, 2, v1
  v_mfma_f32_16x16x32_bf16 v[144:147], a[164:167], v[104:107], v[144:147]
  ds_read_b128 a[160:163], v31 offset:14336
  v_mfma_f32_16x16x32_bf16 v[136:139], a[168:171], v[104:107], v[136:139]
  buffer_load_dwordx4 a[12:15], v2, s[16:19], s96 offen offset:3072 sc1
  v_mfma_f32_16x16x32_bf16 v[140:143], a[168:171], v[108:111], v[140:143]
  v_mul_u32_u24 v35, 73728, v35
  v_mfma_f32_16x16x32_bf16 v[132:135], a[172:175], v[108:111], v[132:135]
  s_add_u32 s96, s81, 4096
  ds_read_b128 a[164:167], v31 offset:15360
  v_mfma_f32_16x16x32_bf16 v[128:131], a[172:175], v[104:107], v[128:131]
  s_waitcnt lgkmcnt(3)
  ds_read_b128 a[168:171], v31 offset:16384
  v_mfma_f32_16x16x32_bf16 v[120:123], a[144:147], v[104:107], v[120:123]
  buffer_load_dwordx4 a[16:19], v2, s[16:19], s96 offen offset:0 sc1
  v_mfma_f32_16x16x32_bf16 v[124:127], a[144:147], v[108:111], v[124:127]
  v_bfe_u32 v36, v1, 1, 1
  v_mfma_f32_16x16x32_bf16 v[116:119], a[148:151], v[108:111], v[116:119]
  ds_read_b128 a[172:175], v31 offset:17408
  v_lshl_add_u32 v35, v36, 5, v35
  v_mfma_f32_16x16x32_bf16 v[112:115], a[148:151], v[104:107], v[112:115]
  ds_read_b128 a[144:147], v31 offset:18432
  s_lshr_b32 s92, 5, s31
  s_bitcmp1_b32 s92, 0
  s_cbranch_scc0 L_gd3
  v_mfma_f32_16x16x32_bf16 v[64:67], a[88:91], a[240:243], 0
  ds_read_b128 a[96:99], v32 offset:43008
  v_mfma_f32_16x16x32_bf16 v[68:71], a[88:91], a[248:251], 0
  ds_read_b128 a[100:103], v32 offset:44032
  v_mfma_f32_16x16x32_bf16 v[72:75], a[88:91], a[244:247], 0
  ds_read_b128 a[104:107], v32 offset:45056
  v_mfma_f32_16x16x32_bf16 v[76:79], a[88:91], a[252:255], 0
  ds_read_b128 a[108:111], v32 offset:46080
  v_mfma_f32_16x16x32_bf16 v[80:83], a[92:95], a[240:243], 0
  ds_read_b128 a[112:115], v32 offset:47104
  v_mfma_f32_16x16x32_bf16 v[84:87], a[92:95], a[248:251], 0
  ds_read_b128 a[116:119], v32 offset:48128
  v_mfma_f32_16x16x32_bf16 v[88:91], a[92:95], a[244:247], 0
  ds_read_b128 a[120:123], v32 offset:49152
  v_sub_f32 v64, v64, v69
  v_add_f32 v65, v65, v68
  v_sub_f32 v66, v66, v71
  v_mfma_f32_16x16x32_bf16 v[92:95], a[92:95], a[252:255], 0
  ds_read_b128 a[124:127], v32 offset:50176
  v_add_f32 v67, v67, v70
  v_sub_f32 v72, v72, v77
  v_add_f32 v73, v73, v76
  v_sub_f32 v74, v74, v79
  v_add_f32 v75, v75, v78
  v_cvt_pk_bf16_f32 v56, v64, v65
  v_cvt_pk_bf16_f32 v57, v66, v67
  v_cvt_pk_bf16_f32 v60, v72, v73
  v_cvt_pk_bf16_f32 v61, v74, v75
  v_sub_f32 v80, v80, v85
  v_add_f32 v81, v81, v84
  v_sub_f32 v82, v82, v87
  v_add_f32 v83, v83, v86
  v_sub_f32 v88, v88, v93
  v_add_f32 v89, v89, v92
  v_sub_f32 v90, v90, v95
  v_add_f32 v91, v91, v94
  v_cvt_pk_bf16_f32 v58, v80, v81
  v_cvt_pk_bf16_f32 v59, v82, v83
  v_cvt_pk_bf16_f32 v62, v88, v89
  v_cvt_pk_bf16_f32 v63, v90, v91
  s_waitcnt lgkmcnt(0)
  v_mfma_f32_16x16x32_bf16 v[248:251], a[96:99], v[56:59], v[248:251]
  ds_read_b128 a[128:131], v32 offset:51200
  v_mfma_f32_16x16x32_bf16 v[252:255], a[96:99], v[60:63], v[252:255]
  v_mfma_f32_16x16x32_bf16 v[244:247], a[100:103], v[60:63], v[244:247]
  ds_read_b128 a[132:135], v32 offset:52224
  v_mfma_f32_16x16x32_bf16 v[240:243], a[100:103], v[56:59], v[240:243]
  v_mfma_f32_16x16x32_bf16 v[232:235], a[104:107], v[56:59], v[232:235]
  ds_read_b128 a[136:139], v32 offset:53248
  v_mfma_f32_16x16x32_bf16 v[236:239], a[104:107], v[60:63], v[236:239]
  v_mfma_f32_16x16x32_bf16 v[228:231], a[108:111], v[60:63], v[228:231]
  ds_read_b128 a[140:143], v32 offset:54272
  v_mfma_f32_16x16x32_bf16 v[224:227], a[108:111], v[56:59], v[224:227]
  v_mfma_f32_16x16x32_bf16 v[216:219], a[112:115], v[56:59], v[216:219]
  ds_read_b128 a[96:99], v32 offset:55296
  v_mfma_f32_16x16x32_bf16 v[220:223], a[112:115], v[60:63], v[220:223]
  v_mfma_f32_16x16x32_bf16 v[212:215], a[116:119], v[60:63], v[212:215]
  ds_read_b128 a[100:103], v32 offset:56320
  v_mfma_f32_16x16x32_bf16 v[208:211], a[116:119], v[56:59], v[208:211]
  v_mfma_f32_16x16x32_bf16 v[200:203], a[120:123], v[56:59], v[200:203]
  ds_read_b128 a[104:107], v32 offset:57344
  v_mfma_f32_16x16x32_bf16 v[204:207], a[120:123], v[60:63], v[204:207]
  v_mfma_f32_16x16x32_bf16 v[196:199], a[124:127], v[60:63], v[196:199]
  ds_read_b128 a[108:111], v32 offset:58368
  v_mfma_f32_16x16x32_bf16 v[192:195], a[124:127], v[56:59], v[192:195]
  s_waitcnt lgkmcnt(3)
  v_mfma_f32_16x16x32_bf16 v[184:187], a[128:131], v[56:59], v[184:187]
  ds_read_b128 a[112:115], v32 offset:59392
  v_mfma_f32_16x16x32_bf16 v[188:191], a[128:131], v[60:63], v[188:191]
  v_mfma_f32_16x16x32_bf16 v[180:183], a[132:135], v[60:63], v[180:183]
  ds_read_b128 a[116:119], v32 offset:60416
  v_mfma_f32_16x16x32_bf16 v[176:179], a[132:135], v[56:59], v[176:179]
  v_mfma_f32_16x16x32_bf16 v[168:171], a[136:139], v[56:59], v[168:171]
  v_mfma_f32_16x16x32_bf16 v[172:175], a[136:139], v[60:63], v[172:175]
  v_mfma_f32_16x16x32_bf16 v[164:167], a[140:143], v[60:63], v[164:167]
  v_mfma_f32_16x16x32_bf16 v[160:163], a[140:143], v[56:59], v[160:163]
  v_mfma_f32_16x16x32_bf16 v[152:155], a[96:99], v[56:59], v[152:155]
  v_mfma_f32_16x16x32_bf16 v[156:159], a[96:99], v[60:63], v[156:159]
  s_waitcnt lgkmcnt(0)
  v_mfma_f32_16x16x32_bf16 v[148:151], a[100:103], v[60:63], v[148:151]
  v_mfma_f32_16x16x32_bf16 v[144:147], a[100:103], v[56:59], v[144:147]
  v_mfma_f32_16x16x32_bf16 v[136:139], a[104:107], v[56:59], v[136:139]
  v_mfma_f32_16x16x32_bf16 v[140:143], a[104:107], v[60:63], v[140:143]
  v_mfma_f32_16x16x32_bf16 v[132:135], a[108:111], v[60:63], v[132:135]
  v_mfma_f32_16x16x32_bf16 v[128:131], a[108:111], v[56:59], v[128:131]
  v_mfma_f32_16x16x32_bf16 v[120:123], a[112:115], v[56:59], v[120:123]
  v_mfma_f32_16x16x32_bf16 v[124:127], a[112:115], v[60:63], v[124:127]
  v_mfma_f32_16x16x32_bf16 v[116:119], a[116:119], v[60:63], v[116:119]
  v_mfma_f32_16x16x32_bf16 v[112:115], a[116:119], v[56:59], v[112:115]
L_gd3:
  v_mfma_f32_16x16x32_bf16 v[248:251], a[152:155], v[40:43], v[248:251]
  s_waitcnt lgkmcnt(3)
  buffer_load_dwordx4 a[20:23], v2, s[16:19], s96 offen offset:1024 sc1
  v_mfma_f32_16x16x32_bf16 v[252:255], a[152:155], v[44:47], v[252:255]
  v_and_b32 v36, 1, v1
  v_mfma_f32_16x16x32_bf16 v[244:247], a[156:159], v[44:47], v[244:247]
  ds_read_b128 a[148:151], v31 offset:19456
  v_lshl_add_u32 v35, v36, 2, v35
  v_mfma_f32_16x16x32_bf16 v[240:243], a[156:159], v[40:43], v[240:243]
  v_mfma_f32_16x16x32_bf16 v[232:235], a[160:163], v[40:43], v[232:235]
  s_barrier
  ds_read_b128 a[152:155], v31 offset:20480
  v_mfma_f32_16x16x32_bf16 v[236:239], a[160:163], v[44:47], v[236:239]
  ds_read_b128 a[156:159], v31 offset:21504
  v_mfma_f32_16x16x32_bf16 v[228:231], a[164:167], v[44:47], v[228:231]
  s_waitcnt lgkmcnt(3)
  buffer_load_dwordx4 a[24:27], v2, s[16:19], s96 offen offset:2048 sc1
  v_mfma_f32_16x16x32_bf16 v[224:227], a[164:167], v[40:43], v[224:227]
  v_and_b32 v36, 7, v1
  v_mfma_f32_16x16x32_bf16 v[216:219], a[168:171], v[40:43], v[216:219]
  s_add_u32 m0, s36, 53248
  ds_read_b128 a[160:163], v31 offset:22528
  v_mfma_f32_16x16x32_bf16 v[220:223], a[168:171], v[44:47], v[220:223]
  ds_read_b128 a[164:167], v31 offset:23552
  v_mfma_f32_16x16x32_bf16 v[212:215], a[172:175], v[44:47], v[212:215]
  buffer_load_dwordx4 v7, s[12:15], s67 offen lds
  v_mfma_f32_16x16x32_bf16 v[208:211], a[172:175], v[40:43], v[208:211]
  v_lshlrev_b32 v36, 2, v36
  v_mfma_f32_16x16x32_bf16 v[200:203], a[144:147], v[40:43], v[200:203]
  ds_read_b128 a[168:171], v31 offset:24576
  v_lshlrev_b32 v37, 2, v1
  v_mfma_f32_16x16x32_bf16 v[204:207], a[144:147], v[44:47], v[204:207]
  s_waitcnt lgkmcnt(3)
  ds_read_b128 a[172:175], v31 offset:25600
  v_mfma_f32_16x16x32_bf16 v[196:199], a[148:151], v[44:47], v[196:199]
  buffer_load_dwordx4 a[28:31], v2, s[16:19], s96 offen offset:3072 sc1
  v_mfma_f32_16x16x32_bf16 v[192:195], a[148:151], v[40:43], v[192:195]
  v_mfma_f32_16x16x32_bf16 v[184:187], a[152:155], v[40:43], v[184:187]
  s_add_u32 m0, s36, 57344
  ds_read_b128 a[144:147], v31 offset:26624
  v_mfma_f32_16x16x32_bf16 v[188:191], a[152:155], v[44:47], v[188:191]
  ds_read_b128 a[148:151], v31 offset:27648
  v_mfma_f32_16x16x32_bf16 v[180:183], a[156:159], v[44:47], v[180:183]
  buffer_load_dwordx4 v7, s[12:15], s69 offen lds
  v_mfma_f32_16x16x32_bf16 v[176:179], a[156:159], v[40:43], v[176:179]
  s_waitcnt lgkmcnt(2)
  v_mfma_f32_16x16x32_bf16 v[168:171], a[160:163], v[40:43], v[168:171]
  s_add_u32 s96, s81, 8192
  ds_read_b128 a[152:155], v31 offset:28672
  v_mfma_f32_16x16x32_bf16 v[172:175], a[160:163], v[44:47], v[172:175]
  ds_read_b128 a[156:159], v31 offset:29696
  v_mfma_f32_16x16x32_bf16 v[164:167], a[164:167], v[44:47], v[164:167]
  buffer_load_dwordx4 a[32:35], v2, s[16:19], s96 offen offset:0 sc1
  v_mfma_f32_16x16x32_bf16 v[160:163], a[164:167], v[40:43], v[160:163]
  v_mfma_f32_16x16x32_bf16 v[152:155], a[168:171], v[40:43], v[152:155]
  ds_read_b128 a[160:163], v31 offset:30720
  v_mfma_f32_16x16x32_bf16 v[156:159], a[168:171], v[44:47], v[156:159]
  s_add_u32 m0, s36, 61440
  v_mfma_f32_16x16x32_bf16 v[148:151], a[172:175], v[44:47], v[148:151]
  ds_read_b128 a[164:167], v31 offset:31744
  v_mfma_f32_16x16x32_bf16 v[144:147], a[172:175], v[40:43], v[144:147]
  s_waitcnt lgkmcnt(2)
  buffer_load_dwordx4 v7, s[12:15], s71 offen lds
  v_mfma_f32_16x16x32_bf16 v[136:139], a[144:147], v[40:43], v[136:139]
  ds_read_b128 a[168:171], v31 offset:32768
  v_mfma_f32_16x16x32_bf16 v[140:143], a[144:147], v[44:47], v[140:143]
  v_mfma_f32_16x16x32_bf16 v[132:135], a[148:151], v[44:47], v[132:135]
  ds_read_b128 a[172:175], v31 offset:33792
  v_mfma_f32_16x16x32_bf16 v[128:131], a[148:151], v[40:43], v[128:131]
  buffer_load_dwordx4 a[36:39], v2, s[16:19], s96 offen offset:1024 sc1
  v_mfma_f32_16x16x32_bf16 v[120:123], a[152:155], v[40:43], v[120:123]
  ds_read_b128 a[144:147], v31 offset:34816
  v_mfma_f32_16x16x32_bf16 v[124:127], a[152:155], v[44:47], v[124:127]
  v_mfma_f32_16x16x32_bf16 v[116:119], a[156:159], v[44:47], v[116:119]
  ds_read_b128 a[148:151], v31 offset:35840
  v_mfma_f32_16x16x32_bf16 v[112:115], a[156:159], v[40:43], v[112:115]
  s_waitcnt lgkmcnt(3)
  buffer_load_dwordx4 a[40:43], v2, s[16:19], s96 offen offset:2048 sc1
  v_mfma_f32_16x16x32_bf16 v[248:251], a[160:163], v[48:51], v[248:251]
  s_waitcnt vmcnt(13)
  s_barrier
  ds_read_b128 a[152:155], v31 offset:36864
  v_mfma_f32_16x16x32_bf16 v[252:255], a[160:163], v[52:55], v[252:255]
  s_add_u32 m0, s36, 65536
  v_mfma_f32_16x16x32_bf16 v[244:247], a[164:167], v[52:55], v[244:247]
  ds_read_b128 a[156:159], v31 offset:37888
  v_mfma_f32_16x16x32_bf16 v[240:243], a[164:167], v[48:51], v[240:243]
  buffer_load_dwordx4 v7, s[12:15], s73 offen lds
  v_mfma_f32_16x16x32_bf16 v[232:235], a[168:171], v[48:51], v[232:235]
  ds_read_b128 a[160:163], v31 offset:38912
  v_mfma_f32_16x16x32_bf16 v[236:239], a[168:171], v[52:55], v[236:239]
  s_waitcnt lgkmcnt(3)
  v_mfma_f32_16x16x32_bf16 v[228:231], a[172:175], v[52:55], v[228:231]
  ds_read_b128 a[164:167], v31 offset:39936
  v_mfma_f32_16x16x32_bf16 v[224:227], a[172:175], v[48:51], v[224:227]
  buffer_load_dwordx4 a[44:47], v2, s[16:19], s96 offen offset:3072 sc1
  v_mfma_f32_16x16x32_bf16 v[216:219], a[144:147], v[48:51], v[216:219]
  ds_read_b128 a[168:171], v31 offset:40960
  v_mfma_f32_16x16x32_bf16 v[220:223], a[144:147], v[52:55], v[220:223]
  s_cmp_ge_u32 s28, 2
  s_cselect_b32 s97, s73, s75
  s_add_u32 m0, s82, 53248
  v_mfma_f32_16x16x32_bf16 v[212:215], a[148:151], v[52:55], v[212:215]
  ds_read_b128 a[172:175], v31 offset:41984
  v_mfma_f32_16x16x32_bf16 v[208:211], a[148:151], v[48:51], v[208:211]
  s_waitcnt lgkmcnt(3)
  buffer_load_dwordx4 v7, s[12:15], s97 offen lds
  v_mfma_f32_16x16x32_bf16 v[200:203], a[152:155], v[48:51], v[200:203]
  ds_read_b128 a[144:147], v31 offset:43008
  v_mfma_f32_16x16x32_bf16 v[204:207], a[152:155], v[52:55], v[204:207]
  s_add_u32 s96, s81, 12288
  v_mfma_f32_16x16x32_bf16 v[196:199], a[156:159], v[52:55], v[196:199]
  ds_read_b128 a[148:151], v31 offset:44032
  v_mfma_f32_16x16x32_bf16 v[192:195], a[156:159], v[48:51], v[192:195]
  buffer_load_dwordx4 a[48:51], v2, s[16:19], s96 offen offset:0 sc1
  v_mfma_f32_16x16x32_bf16 v[184:187], a[160:163], v[48:51], v[184:187]
  ds_read_b128 a[152:155], v31 offset:45056
  v_mfma_f32_16x16x32_bf16 v[188:191], a[160:163], v[52:55], v[188:191]
  s_waitcnt lgkmcnt(3)
  v_mfma_f32_16x16x32_bf16 v[180:183], a[164:167], v[52:55], v[180:183]
  ds_read_b128 a[156:159], v31 offset:46080
  v_mfma_f32_16x16x32_bf16 v[176:179], a[164:167], v[48:51], v[176:179]
  buffer_load_dword v39, off, s[16:19], s43 offset:8 sc1
  v_mfma_f32_16x16x32_bf16 v[168:171], a[168:171], v[48:51], v[168:171]
  ds_read_b128 a[160:163], v31 offset:47104
  v_mfma_f32_16x16x32_bf16 v[172:175], a[168:171], v[52:55], v[172:175]
  buffer_load_dwordx4 a[52:55], v2, s[16:19], s96 offen offset:1024 sc1
  v_mfma_f32_16x16x32_bf16 v[164:167], a[172:175], v[52:55], v[164:167]
  ds_read_b128 a[164:167], v31 offset:48128
  v_mfma_f32_16x16x32_bf16 v[160:163], a[172:175], v[48:51], v[160:163]
  s_waitcnt lgkmcnt(3)
  v_mfma_f32_16x16x32_bf16 v[152:155], a[144:147], v[48:51], v[152:155]
  ds_read_b64_tr_b16 a[168:169], v15 offset:0
  ds_read_b64_tr_b16 a[170:171], v15 offset:1024
  v_mfma_f32_16x16x32_bf16 v[156:159], a[144:147], v[52:55], v[156:159]
  buffer_load_dwordx4 a[56:59], v2, s[16:19], s96 offen offset:2048 sc1
  v_mfma_f32_16x16x32_bf16 v[148:151], a[148:151], v[52:55], v[148:151]
  ds_read_b64_tr_b16 a[172:173], v18 offset:0
  v_mfma_f32_16x16x32_bf16 v[144:147], a[148:151], v[48:51], v[144:147]
  ds_read_b64_tr_b16 a[174:175], v18 offset:1024
  v_mfma_f32_16x16x32_bf16 v[136:139], a[152:155], v[48:51], v[136:139]
  ds_read_b64_tr_b16 a[144:145], v21 offset:0
  ds_read_b64_tr_b16 a[146:147], v21 offset:1024
  v_mfma_f32_16x16x32_bf16 v[140:143], a[152:155], v[52:55], v[140:143]
  s_waitcnt lgkmcnt(6)
  buffer_load_dwordx4 a[60:63], v2, s[16:19], s96 offen offset:3072 sc1
  v_mfma_f32_16x16x32_bf16 v[132:135], a[156:159], v[52:55], v[132:135]
  ds_read_b64_tr_b16 a[148:149], v24 offset:0
  v_mfma_f32_16x16x32_bf16 v[128:131], a[156:159], v[48:51], v[128:131]
  s_add_u32 m0, s36, 90112
  ds_read_b64_tr_b16 a[150:151], v24 offset:1024
  v_mfma_f32_16x16x32_bf16 v[120:123], a[160:163], v[48:51], v[120:123]
  ds_read_b64_tr_b16 a[152:153], v15 offset:4096
  ds_read_b64_tr_b16 a[154:155], v15 offset:5120
  v_mfma_f32_16x16x32_bf16 v[124:127], a[160:163], v[52:55], v[124:127]
  buffer_load_dwordx4 v4, s[12:15], s67 offen lds
  v_mfma_f32_16x16x32_bf16 v[116:119], a[164:167], v[52:55], v[116:119]
  ds_read_b64_tr_b16 a[156:157], v18 offset:4096
  v_mfma_f32_16x16x32_bf16 v[112:115], a[164:167], v[48:51], v[112:115]
  s_waitcnt lgkmcnt(5)
  s_add_u32 m0, s36, 94208
  ds_read_b64_tr_b16 a[158:159], v18 offset:5120
  v_mfma_f32_16x16x32_bf16 v[248:251], a[168:171], a[0:3], v[248:251]
  ds_read_b64_tr_b16 a[160:161], v21 offset:4096
  ds_read_b64_tr_b16 a[162:163], v21 offset:5120
  s_waitcnt vmcnt(21)
  v_mfma_f32_16x16x32_bf16 v[252:255], a[168:171], a[4:7], v[252:255]
  buffer_load_dwordx4 v4, s[12:15], s68 offen lds
  v_mfma_f32_16x16x32_bf16 v[244:247], a[172:175], a[4:7], v[244:247]
  ds_read_b64_tr_b16 a[164:165], v24 offset:4096
  v_mfma_f32_16x16x32_bf16 v[240:243], a[172:175], a[0:3], v[240:243]
  s_add_u32 m0, s36, 98304
  ds_read_b64_tr_b16 a[166:167], v24 offset:5120
  v_mfma_f32_16x16x32_bf16 v[232:235], a[144:147], a[0:3], v[232:235]
  ds_read_b64_tr_b16 a[168:169], v15 offset:8192
  ds_read_b64_tr_b16 a[170:171], v15 offset:9216
  v_mfma_f32_16x16x32_bf16 v[236:239], a[144:147], a[4:7], v[236:239]
  s_waitcnt lgkmcnt(6)
  buffer_load_dwordx4 v4, s[12:15], s69 offen lds
  v_mfma_f32_16x16x32_bf16 v[228:231], a[148:151], a[4:7], v[228:231]
  ds_read_b64_tr_b16 a[172:173], v18 offset:8192
  v_mfma_f32_16x16x32_bf16 v[224:227], a[148:151], a[0:3], v[224:227]
  s_add_u32 m0, s36, 102400
  ds_read_b64_tr_b16 a[174:175], v18 offset:9216
  s_waitcnt vmcnt(22)
  v_mfma_f32_16x16x32_bf16 v[248:251], a[152:155], a[8:11], v[248:251]
  ds_read_b64_tr_b16 a[144:145], v21 offset:8192
  ds_read_b64_tr_b16 a[146:147], v21 offset:9216
  s_waitcnt vmcnt(21)
  v_mfma_f32_16x16x32_bf16 v[252:255], a[152:155], a[12:15], v[252:255]
  buffer_load_dwordx4 v4, s[12:15], s70 offen lds
  v_mfma_f32_16x16x32_bf16 v[244:247], a[156:159], a[12:15], v[244:247]
  ds_read_b64_tr_b16 a[148:149], v24 offset:8192
  v_mfma_f32_16x16x32_bf16 v[240:243], a[156:159], a[8:11], v[240:243]
  s_waitcnt lgkmcnt(5)
  s_add_u32 m0, s36, 106496
  ds_read_b64_tr_b16 a[150:151], v24 offset:9216
  v_mfma_f32_16x16x32_bf16 v[232:235], a[160:163], a[8:11], v[232:235]
  ds_read_b64_tr_b16 a[152:153], v15 offset:12288
  ds_read_b64_tr_b16 a[154:155], v15 offset:13312
  v_mfma_f32_16x16x32_bf16 v[236:239], a[160:163], a[12:15], v[236:239]
  buffer_load_dwordx4 v4, s[12:15], s71 offen lds
  v_mfma_f32_16x16x32_bf16 v[228:231], a[164:167], a[12:15], v[228:231]
  ds_read_b64_tr_b16 a[156:157], v18 offset:12288
  s_waitcnt vmcnt(8)
  v_cmp_ne_u32 vcc, s34, v39
  s_cbranch_vccz L_fi_ok
  s_mov_b32 s98, 0
L_fi_spin:
  s_sleep 1
  buffer_load_dword v39, off, s[16:19], s43 offset:8 sc1
  s_waitcnt vmcnt(0)
  v_cmp_ne_u32 vcc, s34, v39
  s_cbranch_vccz L_fi_ok
  s_add_u32 s98, s98, 1
  s_cmp_lt_u32 s98, 0x8000
  s_cbranch_scc1 L_fi_spin
L_fi_ok:
  s_nop 1
  v_mfma_f32_16x16x32_bf16 v[224:227], a[164:167], a[8:11], v[224:227]
  s_add_u32 s96, s81, 16384
  ds_read_b64_tr_b16 a[158:159], v18 offset:13312
  v_mfma_f32_16x16x32_bf16 v[248:251], a[168:171], a[16:19], v[248:251]
  ds_read_b64_tr_b16 a[160:161], v21 offset:12288
  ds_read_b64_tr_b16 a[162:163], v21 offset:13312
  v_mfma_f32_16x16x32_bf16 v[252:255], a[168:171], a[20:23], v[252:255]
  s_waitcnt lgkmcnt(6)
  buffer_load_dwordx4 a[64:67], v2, s[16:19], s96 offen offset:0 sc1
  v_mfma_f32_16x16x32_bf16 v[244:247], a[172:175], a[20:23], v[244:247]
  ds_read_b64_tr_b16 a[164:165], v24 offset:12288
  v_mfma_f32_16x16x32_bf16 v[240:243], a[172:175], a[16:19], v[240:243]
  ds_read_b64_tr_b16 a[166:167], v24 offset:13312
  v_mfma_f32_16x16x32_bf16 v[232:235], a[144:147], a[16:19], v[232:235]
  ds_read_b64_tr_b16 a[168:169], v15 offset:16384
  ds_read_b64_tr_b16 a[170:171], v15 offset:17408
  v_mfma_f32_16x16x32_bf16 v[236:239], a[144:147], a[20:23], v[236:239]
  buffer_load_dwordx4 a[68:71], v2, s[16:19], s96 offen offset:1024 sc1
  v_mfma_f32_16x16x32_bf16 v[228:231], a[148:151], a[20:23], v[228:231]
  ds_read_b64_tr_b16 a[172:173], v18 offset:16384
  v_mfma_f32_16x16x32_bf16 v[224:227], a[148:151], a[16:19], v[224:227]
  s_waitcnt lgkmcnt(5)
  s_add_u32 m0, s36, 110592
  ds_read_b64_tr_b16 a[174:175], v18 offset:17408
  v_mfma_f32_16x16x32_bf16 v[248:251], a[152:155], a[24:27], v[248:251]
  ds_read_b64_tr_b16 a[144:145], v21 offset:16384
  ds_read_b64_tr_b16 a[146:147], v21 offset:17408
  v_mfma_f32_16x16x32_bf16 v[252:255], a[152:155], a[28:31], v[252:255]
  buffer_load_dwordx4 v4, s[12:15], s72 offen lds
  v_mfma_f32_16x16x32_bf16 v[244:247], a[156:159], a[28:31], v[244:247]
  ds_read_b64_tr_b16 a[148:149], v24 offset:16384
  v_mfma_f32_16x16x32_bf16 v[240:243], a[156:159], a[24:27], v[240:243]
  s_add_u32 m0, s36, 114688
  ds_read_b64_tr_b16 a[150:151], v24 offset:17408
  v_mfma_f32_16x16x32_bf16 v[232:235], a[160:163], a[24:27], v[232:235]
  ds_read_b64_tr_b16 a[152:153], v15 offset:20480
  ds_read_b64_tr_b16 a[154:155], v15 offset:21504
  v_mfma_f32_16x16x32_bf16 v[236:239], a[160:163], a[28:31], v[236:239]
  s_waitcnt lgkmcnt(6)
  buffer_load_dwordx4 v4, s[12:15], s73 offen lds
  v_mfma_f32_16x16x32_bf16 v[228:231], a[164:167], a[28:31], v[228:231]
  ds_read_b64_tr_b16 a[156:157], v18 offset:20480
  v_mfma_f32_16x16x32_bf16 v[224:227], a[164:167], a[24:27], v[224:227]
  s_add_u32 m0, s36, 118784
  ds_read_b64_tr_b16 a[158:159], v18 offset:21504
  v_mfma_f32_16x16x32_bf16 v[248:251], a[168:171], a[32:35], v[248:251]
  ds_read_b64_tr_b16 a[160:161], v21 offset:20480
  ds_read_b64_tr_b16 a[162:163], v21 offset:21504
  v_mfma_f32_16x16x32_bf16 v[252:255], a[168:171], a[36:39], v[252:255]
  buffer_load_dwordx4 v4, s[12:15], s74 offen lds
  v_mfma_f32_16x16x32_bf16 v[244:247], a[172:175], a[36:39], v[244:247]
  ds_read_b64_tr_b16 a[164:165], v24 offset:20480
  v_mfma_f32_16x16x32_bf16 v[240:243], a[172:175], a[32:35], v[240:243]
  s_waitcnt lgkmcnt(5)
  ds_read_b64_tr_b16 a[166:167], v24 offset:21504
  v_mfma_f32_16x16x32_bf16 v[232:235], a[144:147], a[32:35], v[232:235]
  s_barrier
  ds_read_b64_tr_b16 a[168:169], v15 offset:24576
  v_mfma_f32_16x16x32_bf16 v[236:239], a[144:147], a[36:39], v[236:239]
  s_add_u32 m0, s36, 122880
  ds_read_b64_tr_b16 a[170:171], v15 offset:25600
  v_mfma_f32_16x16x32_bf16 v[228:231], a[148:151], a[36:39], v[228:231]
  ds_read_b64_tr_b16 a[172:173], v18 offset:24576
  ds_read_b64_tr_b16 a[174:175], v18 offset:25600
  v_mfma_f32_16x16x32_bf16 v[224:227], a[148:151], a[32:35], v[224:227]
  buffer_load_dwordx4 v4, s[12:15], s75 offen lds
  v_mfma_f32_16x16x32_bf16 v[248:251], a[152:155], a[40:43], v[248:251]
  ds_read_b64_tr_b16 a[144:145], v21 offset:24576
  v_mfma_f32_16x16x32_bf16 v[252:255], a[152:155], a[44:47], v[252:255]
  s_waitcnt lgkmcnt(5)
  ds_read_b64_tr_b16 a[146:147], v21 offset:25600
  v_mfma_f32_16x16x32_bf16 v[244:247], a[156:159], a[44:47], v[244:247]
  ds_read_b64_tr_b16 a[148:149], v24 offset:24576
  v_mfma_f32_16x16x32_bf16 v[240:243], a[156:159], a[40:43], v[240:243]
  ds_read_b64_tr_b16 a[150:151], v24 offset:25600
  v_mfma_f32_16x16x32_bf16 v[232:235], a[160:163], a[40:43], v[232:235]
  s_add_u32 m0, s36, 126976
  ds_read_b64_tr_b16 a[152:153], v15 offset:28672
  v_mfma_f32_16x16x32_bf16 v[236:239], a[160:163], a[44:47], v[236:239]
  ds_read_b64_tr_b16 a[154:155], v15 offset:29696
  ds_read_b64_tr_b16 a[156:157], v18 offset:28672
  v_mfma_f32_16x16x32_bf16 v[228:231], a[164:167], a[44:47], v[228:231]
  buffer_load_dwordx4 v5, s[12:15], s67 offen lds
  v_mfma_f32_16x16x32_bf16 v[224:227], a[164:167], a[40:43], v[224:227]
  s_waitcnt lgkmcnt(5)
  ds_read_b64_tr_b16 a[158:159], v18 offset:29696
  v_mfma_f32_16x16x32_bf16 v[248:251], a[168:171], a[48:51], v[248:251]
  ds_read_b64_tr_b16 a[160:161], v21 offset:28672
  s_waitcnt vmcnt(14)
  v_mfma_f32_16x16x32_bf16 v[252:255], a[168:171], a[52:55], v[252:255]
  s_add_u32 m0, s36, 131072
  ds_read_b64_tr_b16 a[162:163], v21 offset:29696
  v_mfma_f32_16x16x32_bf16 v[244:247], a[172:175], a[52:55], v[244:247]
  ds_read_b64_tr_b16 a[164:165], v24 offset:28672
  ds_read_b64_tr_b16 a[166:167], v24 offset:29696
  v_mfma_f32_16x16x32_bf16 v[240:243], a[172:175], a[48:51], v[240:243]
  buffer_load_dwordx4 v5, s[12:15], s68 offen lds
  v_mfma_f32_16x16x32_bf16 v[232:235], a[144:147], a[48:51], v[232:235]
  ds_read_b64_tr_b16 a[168:169], v15 offset:32768
  v_mfma_f32_16x16x32_bf16 v[236:239], a[144:147], a[52:55], v[236:239]
  s_waitcnt lgkmcnt(5)
  ds_read_b64_tr_b16 a[170:171], v15 offset:33792
  v_mfma_f32_16x16x32_bf16 v[228:231], a[148:151], a[52:55], v[228:231]
  s_add_u32 m0, s36, 135168
  ds_read_b64_tr_b16 a[172:173], v18 offset:32768
  v_mfma_f32_16x16x32_bf16 v[224:227], a[148:151], a[48:51], v[224:227]
  ds_read_b64_tr_b16 a[174:175], v18 offset:33792
  ds_read_b64_tr_b16 a[144:145], v21 offset:32768
  s_waitcnt vmcnt(14)
  v_mfma_f32_16x16x32_bf16 v[248:251], a[152:155], a[56:59], v[248:251]
  buffer_load_dwordx4 v5, s[12:15], s69 offen lds
  s_waitcnt vmcnt(14)
  v_mfma_f32_16x16x32_bf16 v[252:255], a[152:155], a[60:63], v[252:255]
  ds_read_b64_tr_b16 a[146:147], v21 offset:33792
  v_mfma_f32_16x16x32_bf16 v[244:247], a[156:159], a[60:63], v[244:247]
  ds_read_b64_tr_b16 a[148:149], v24 offset:32768
  v_mfma_f32_16x16x32_bf16 v[240:243], a[156:159], a[56:59], v[240:243]
  s_waitcnt lgkmcnt(5)
  s_add_u32 m0, s36, 139264
  ds_read_b64_tr_b16 a[150:151], v24 offset:33792
  v_mfma_f32_16x16x32_bf16 v[232:235], a[160:163], a[56:59], v[232:235]
  ds_read_b64_tr_b16 a[152:153], v27 offset:36864
  ds_read_b64_tr_b16 a[154:155], v27 offset:37376
  v_mfma_f32_16x16x32_bf16 v[236:239], a[160:163], a[60:63], v[236:239]
  buffer_load_dwordx4 v5, s[12:15], s70 offen lds
  v_mfma_f32_16x16x32_bf16 v[228:231], a[164:167], a[60:63], v[228:231]
  ds_read_b64_tr_b16 a[156:157], v29 offset:36864
  v_mfma_f32_16x16x32_bf16 v[224:227], a[164:167], a[56:59], v[224:227]
  ds_read_b64_tr_b16 a[158:159], v29 offset:37376
  s_waitcnt vmcnt(9)
  v_mfma_f32_16x16x32_bf16 v[248:251], a[168:171], a[64:67], v[248:251]
  s_waitcnt lgkmcnt(6)
  s_add_u32 m0, s36, 143360
  ds_read_b64_tr_b16 a[160:161], v27 offset:38912
  s_waitcnt vmcnt(8)
  v_mfma_f32_16x16x32_bf16 v[252:255], a[168:171], a[68:71], v[252:255]
  ds_read_b64_tr_b16 a[162:163], v27 offset:39424
  ds_read_b64_tr_b16 a[164:165], v29 offset:38912
  v_mfma_f32_16x16x32_bf16 v[244:247], a[172:175], a[68:71], v[244:247]
  buffer_load_dwordx4 v5, s[12:15], s71 offen lds
  v_mfma_f32_16x16x32_bf16 v[240:243], a[172:175], a[64:67], v[240:243]
  ds_read_b64_tr_b16 a[166:167], v29 offset:39424
  v_mfma_f32_16x16x32_bf16 v[232:235], a[144:147], a[64:67], v[232:235]
  ds_read_b64_tr_b16 a[168:169], v27 offset:40960
  v_mfma_f32_16x16x32_bf16 v[236:239], a[144:147], a[68:71], v[236:239]
  s_waitcnt lgkmcnt(5)
  s_add_u32 m0, s36, 147456
  ds_read_b64_tr_b16 a[170:171], v27 offset:41472
  v_mfma_f32_16x16x32_bf16 v[228:231], a[148:151], a[68:71], v[228:231]
  ds_read_b64_tr_b16 a[172:173], v29 offset:40960
  ds_read_b64_tr_b16 a[174:175], v29 offset:41472
  v_mfma_f32_16x16x32_bf16 v[224:227], a[148:151], a[64:67], v[224:227]
  buffer_load_dwordx4 v5, s[12:15], s72 offen lds
  v_mfma_f32_16x16x32_bf16 v[120:123], a[152:155], a[0:3], v[120:123]
  ds_read_b64_tr_b16 a[144:145], v27 offset:43008
  v_mfma_f32_16x16x32_bf16 v[124:127], a[152:155], a[4:7], v[124:127]
  ds_read_b64_tr_b16 a[146:147], v27 offset:43520
  v_mfma_f32_16x16x32_bf16 v[116:119], a[156:159], a[4:7], v[116:119]
  s_waitcnt lgkmcnt(6)
  ds_read_b64_tr_b16 a[148:149], v29 offset:43008
  s_cmp_eq_u32 s37, 0
  s_cbranch_scc0 L_n1
  v_lshrrev_b32 v14, 2, v1
  v_and_b32 v13, 3, v1
  v_lshlrev_b32 v13, 4, v13
  v_lshl_add_u32 v14, v14, 7, v13
  s_movk_i32 s95, 4096
  buffer_load_dwordx4 v[10:13], v14, s[16:19], s95 offen sc1
L_n1:
  v_mfma_f32_16x16x32_bf16 v[112:115], a[156:159], a[0:3], v[112:115]
  ds_read_b64_tr_b16 a[150:151], v29 offset:43520
  ds_read_b64_tr_b16 a[152:153], v27 offset:45056
  v_mfma_f32_16x16x32_bf16 v[120:123], a[160:163], a[8:11], v[120:123]
  s_add_u32 m0, s36, 151552
  s_nop 0
  buffer_load_dwordx4 v5, s[12:15], s73 offen lds
  v_mfma_f32_16x16x32_bf16 v[124:127], a[160:163], a[12:15], v[124:127]
  ds_read_b64_tr_b16 a[154:155], v27 offset:45568
  v_cvt_pk_bf16_f32 v64, v248, v249
  v_mfma_f32_16x16x32_bf16 v[116:119], a[164:167], a[12:15], v[116:119]
  ds_read_b64_tr_b16 a[156:157], v29 offset:45056
  v_cvt_pk_bf16_f32 v65, v250, v251
  v_mfma_f32_16x16x32_bf16 v[112:115], a[164:167], a[8:11], v[112:115]
  s_waitcnt lgkmcnt(5)
  s_add_u32 m0, s36, 155648
  ds_read_b64_tr_b16 a[158:159], v29 offset:45568
  v_mfma_f32_16x16x32_bf16 v[120:123], a[168:171], a[16:19], v[120:123]
  ds_read_b64_tr_b16 a[160:161], v27 offset:47104
  ds_read_b64_tr_b16 a[162:163], v27 offset:47616
  v_mfma_f32_16x16x32_bf16 v[124:127], a[168:171], a[20:23], v[124:127]
  buffer_load_dwordx4 v5, s[12:15], s74 offen lds
  v_mfma_f32_16x16x32_bf16 v[116:119], a[172:175], a[20:23], v[116:119]
  ds_read_b64_tr_b16 a[164:165], v29 offset:47104
  v_mfma_f32_16x16x32_bf16 v[112:115], a[172:175], a[16:19], v[112:115]
  ds_read_b64_tr_b16 a[166:167], v29 offset:47616
  v_cvt_pk_bf16_f32 v66, v240, v241
  v_mfma_f32_16x16x32_bf16 v[120:123], a[144:147], a[24:27], v[120:123]
  s_waitcnt vmcnt(8)
  s_barrier
  ds_read_b64_tr_b16 a[168:169], v28 offset:0
  v_mfma_f32_16x16x32_bf16 v[124:127], a[144:147], a[28:31], v[124:127]
  s_waitcnt lgkmcnt(5)
  s_add_u32 m0, s36, 159744
  ds_read_b64_tr_b16 a[170:171], v28 offset:512
  v_mfma_f32_16x16x32_bf16 v[116:119], a[148:151], a[28:31], v[116:119]
  ds_read_b64_tr_b16 a[172:173], v30 offset:0
  ds_read_b64_tr_b16 a[174:175], v30 offset:512
  v_mfma_f32_16x16x32_bf16 v[112:115], a[148:151], a[24:27], v[112:115]
  buffer_load_dwordx4 v5, s[12:15], s75 offen lds
  v_mfma_f32_16x16x32_bf16 v[120:123], a[152:155], a[32:35], v[120:123]
  ds_read_b64_tr_b16 a[144:145], v28 offset:2048
  v_cvt_pk_bf16_f32 v67, v242, v243
  v_mfma_f32_16x16x32_bf16 v[124:127], a[152:155], a[36:39], v[124:127]
  s_add_u32 s97, s45, s53
  ds_read_b64_tr_b16 a[146:147], v28 offset:2560
  v_mfma_f32_16x16x32_bf16 v[116:119], a[156:159], a[36:39], v[116:119]
  ds_read_b64_tr_b16 a[148:149], v30 offset:2048
  ds_read_b64_tr_b16 a[150:151], v30 offset:2560
  v_mfma_f32_16x16x32_bf16 v[112:115], a[156:159], a[32:35], v[112:115]
  s_waitcnt lgkmcnt(6)
  buffer_store_dwordx4 v[64:67], v2, s[16:19], s97 offen offset:0 sc1
  v_mfma_f32_16x16x32_bf16 v[120:123], a[160:163], a[40:43], v[120:123]
  ds_read_b64_tr_b16 a[152:153], v28 offset:4096
  v_cvt_pk_bf16_f32 v68, v252, v253
  v_mfma_f32_16x16x32_bf16 v[124:127], a[160:163], a[44:47], v[124:127]
  s_add_u32 m0, s36, 16384
  ds_read_b64_tr_b16 a[154:155], v28 offset:4608
  v_mfma_f32_16x16x32_bf16 v[116:119], a[164:167], a[44:47], v[116:119]
  ds_read_b64_tr_b16 a[156:157], v30 offset:4096
  ds_read_b64_tr_b16 a[158:159], v30 offset:4608
  v_mfma_f32_16x16x32_bf16 v[112:115], a[164:167], a[40:43], v[112:115]
  s_waitcnt lgkmcnt(6)
  buffer_load_dwordx4 v33, s[12:15], s67 offen lds
  v_mfma_f32_16x16x32_bf16 v[120:123], a[168:171], a[48:51], v[120:123]
  ds_read_b64_tr_b16 a[160:161], v16 offset:24576
  v_cvt_pk_bf16_f32 v69, v254, v255
  v_mfma_f32_16x16x32_bf16 v[124:127], a[168:171], a[52:55], v[124:127]
  ds_read_b64_tr_b16 a[162:163], v16 offset:25600
  v_cvt_pk_bf16_f32 v70, v244, v245
  v_mfma_f32_16x16x32_bf16 v[116:119], a[172:175], a[52:55], v[116:119]
  s_add_u32 m0, s36, 20480
  ds_read_b64_tr_b16 a[164:165], v19 offset:24576
  v_mfma_f32_16x16x32_bf16 v[112:115], a[172:175], a[48:51], v[112:115]
  ds_read_b64_tr_b16 a[166:167], v19 offset:25600
  ds_read_b64_tr_b16 a[168:169], v22 offset:24576
  v_mfma_f32_16x16x32_bf16 v[120:123], a[144:147], a[56:59], v[120:123]
  buffer_load_dwordx4 v33, s[12:15], s68 offen lds
  v_mfma_f32_16x16x32_bf16 v[124:127], a[144:147], a[60:63], v[124:127]
  s_waitcnt lgkmcnt(5)
  ds_read_b64_tr_b16 a[170:171], v22 offset:25600
  v_mfma_f32_16x16x32_bf16 v[116:119], a[148:151], a[60:63], v[116:119]
  ds_read_b64_tr_b16 a[172:173], v25 offset:24576
  v_cvt_pk_bf16_f32 v71, v246, v247
  v_mfma_f32_16x16x32_bf16 v[112:115], a[148:151], a[56:59], v[112:115]
  s_add_u32 s97, s45, s53
  ds_read_b64_tr_b16 a[174:175], v25 offset:25600
  v_mfma_f32_16x16x32_bf16 v[120:123], a[152:155], a[64:67], v[120:123]
  ds_read_b64_tr_b16 a[144:145], v16 offset:28672
  ds_read_b64_tr_b16 a[146:147], v16 offset:29696
  v_mfma_f32_16x16x32_bf16 v[124:127], a[152:155], a[68:71], v[124:127]
  buffer_store_dwordx4 v[68:71], v2, s[16:19], s97 offen offset:1024 sc1
  v_mfma_f32_16x16x32_bf16 v[116:119], a[156:159], a[68:71], v[116:119]
  ds_read_b64_tr_b16 a[148:149], v19 offset:28672
  v_cvt_pk_bf16_f32 v72, v232, v233
  v_mfma_f32_16x16x32_bf16 v[112:115], a[156:159], a[64:67], v[112:115]
  s_waitcnt lgkmcnt(5)
  s_add_u32 m0, s36, 24576
  ds_read_b64_tr_b16 a[150:151], v19 offset:29696
  v_mfma_f32_16x16x32_bf16 v[216:219], a[160:163], a[0:3], v[216:219]
  ds_read_b64_tr_b16 a[152:153], v22 offset:28672
  ds_read_b64_tr_b16 a[154:155], v22 offset:29696
  v_mfma_f32_16x16x32_bf16 v[220:223], a[160:163], a[4:7], v[220:223]
  buffer_load_dwordx4 v33, s[12:15], s69 offen lds
  v_mfma_f32_16x16x32_bf16 v[212:215], a[164:167], a[4:7], v[212:215]
  ds_read_b64_tr_b16 a[156:157], v25 offset:28672
  v_cvt_pk_bf16_f32 v73, v234, v235
  v_mfma_f32_16x16x32_bf16 v[208:211], a[164:167], a[0:3], v[208:211]
  ds_read_b64_tr_b16 a[158:159], v25 offset:29696
  v_cvt_pk_bf16_f32 v74, v224, v225
  v_mfma_f32_16x16x32_bf16 v[200:203], a[168:171], a[0:3], v[200:203]
  s_waitcnt lgkmcnt(6)
  s_add_u32 m0, s36, 28672
  ds_read_b64_tr_b16 a[160:161], v16 offset:32768
  v_mfma_f32_16x16x32_bf16 v[204:207], a[168:171], a[4:7], v[204:207]
  ds_read_b64_tr_b16 a[162:163], v16 offset:33792
  ds_read_b64_tr_b16 a[164:165], v19 offset:32768
  v_mfma_f32_16x16x32_bf16 v[196:199], a[172:175], a[4:7], v[196:199]
  buffer_load_dwordx4 v33, s[12:15], s70 offen lds
  v_mfma_f32_16x16x32_bf16 v[192:195], a[172:175], a[0:3], v[192:195]
  ds_read_b64_tr_b16 a[166:167], v19 offset:33792
  v_cvt_pk_bf16_f32 v75, v226, v227
  v_mfma_f32_16x16x32_bf16 v[216:219], a[144:147], a[8:11], v[216:219]
  s_waitcnt lgkmcnt(6)
  s_add_u32 s97, s45, s55
  ds_read_b64_tr_b16 a[168:169], v22 offset:32768
  v_mfma_f32_16x16x32_bf16 v[220:223], a[144:147], a[12:15], v[220:223]
  ds_read_b64_tr_b16 a[170:171], v22 offset:33792
  ds_read_b64_tr_b16 a[172:173], v25 offset:32768
  v_mfma_f32_16x16x32_bf16 v[212:215], a[148:151], a[12:15], v[212:215]
  buffer_store_dwordx4 v[72:75], v2, s[16:19], s97 offen offset:0 sc1
  v_mfma_f32_16x16x32_bf16 v[208:211], a[148:151], a[8:11], v[208:211]
  ds_read_b64_tr_b16 a[174:175], v25 offset:33792
  v_cvt_pk_bf16_f32 v76, v236, v237
  v_mfma_f32_16x16x32_bf16 v[200:203], a[152:155], a[8:11], v[200:203]
  s_waitcnt lgkmcnt(6)
  s_add_u32 m0, s36, 32768
  ds_read_b64_tr_b16 a[144:145], v16 offset:36864
  v_mfma_f32_16x16x32_bf16 v[204:207], a[152:155], a[12:15], v[204:207]
  ds_read_b64_tr_b16 a[146:147], v16 offset:37888
  ds_read_b64_tr_b16 a[148:149], v19 offset:36864
  v_mfma_f32_16x16x32_bf16 v[196:199], a[156:159], a[12:15], v[196:199]
  buffer_load_dwordx4 v33, s[12:15], s71 offen lds
  v_mfma_f32_16x16x32_bf16 v[192:195], a[156:159], a[8:11], v[192:195]
  s_waitcnt lgkmcnt(5)
  ds_read_b64_tr_b16 a[150:151], v19 offset:37888
  v_mfma_f32_16x16x32_bf16 v[216:219], a[160:163], a[16:19], v[216:219]
  ds_read_b64_tr_b16 a[152:153], v22 offset:36864
  v_cvt_pk_bf16_f32 v77, v238, v239
  v_mfma_f32_16x16x32_bf16 v[220:223], a[160:163], a[20:23], v[220:223]
  ds_read_b64_tr_b16 a[154:155], v22 offset:37888
  v_cvt_pk_bf16_f32 v78, v228, v229
  v_mfma_f32_16x16x32_bf16 v[212:215], a[164:167], a[20:23], v[212:215]
  s_add_u32 m0, s36, 36864
  ds_read_b64_tr_b16 a[156:157], v25 offset:36864
  v_mfma_f32_16x16x32_bf16 v[208:211], a[164:167], a[16:19], v[208:211]
  ds_read_b64_tr_b16 a[158:159], v25 offset:37888
  ds_read_b64_tr_b16 a[160:161], v16 offset:40960
  v_mfma_f32_16x16x32_bf16 v[200:203], a[168:171], a[16:19], v[200:203]
  s_waitcnt lgkmcnt(7)
  buffer_load_dwordx4 v33, s[12:15], s72 offen lds
  v_mfma_f32_16x16x32_bf16 v[204:207], a[168:171], a[20:23], v[204:207]
  ds_read_b64_tr_b16 a[162:163], v16 offset:41984
  v_cvt_pk_bf16_f32 v79, v230, v231
  v_mfma_f32_16x16x32_bf16 v[196:199], a[172:175], a[20:23], v[196:199]
  s_add_u32 s97, s45, s55
  ds_read_b64_tr_b16 a[164:165], v19 offset:40960
  v_mfma_f32_16x16x32_bf16 v[192:195], a[172:175], a[16:19], v[192:195]
  ds_read_b64_tr_b16 a[166:167], v19 offset:41984
  ds_read_b64_tr_b16 a[168:169], v22 offset:40960
  v_mfma_f32_16x16x32_bf16 v[216:219], a[144:147], a[24:27], v[216:219]
  s_waitcnt lgkmcnt(7)
  buffer_store_dwordx4 v[76:79], v2, s[16:19], s97 offen offset:1024 sc1
  v_mfma_f32_16x16x32_bf16 v[220:223], a[144:147], a[28:31], v[220:223]
  ds_read_b64_tr_b16 a[170:171], v22 offset:41984
  v_cvt_pk_bf16_f32 v80, v120, v121
  v_mfma_f32_16x16x32_bf16 v[212:215], a[148:151], a[28:31], v[212:215]
  s_add_u32 m0, s36, 40960
  ds_read_b64_tr_b16 a[172:173], v25 offset:40960
  v_mfma_f32_16x16x32_bf16 v[208:211], a[148:151], a[24:27], v[208:211]
  ds_read_b64_tr_b16 a[174:175], v25 offset:41984
  ds_read_b64_tr_b16 a[144:145], v16 offset:45056
  v_mfma_f32_16x16x32_bf16 v[200:203], a[152:155], a[24:27], v[200:203]
  s_waitcnt lgkmcnt(7)
  buffer_load_dwordx4 v33, s[12:15], s73 offen lds
  v_mfma_f32_16x16x32_bf16 v[204:207], a[152:155], a[28:31], v[204:207]
  ds_read_b64_tr_b16 a[146:147], v16 offset:46080
  v_cvt_pk_bf16_f32 v81, v122, v123
  v_mfma_f32_16x16x32_bf16 v[196:199], a[156:159], a[28:31], v[196:199]
  ds_read_b64_tr_b16 a[148:149], v19 offset:45056
  v_cvt_pk_bf16_f32 v82, v112, v113
  v_mfma_f32_16x16x32_bf16 v[192:195], a[156:159], a[24:27], v[192:195]
  ds_read_b64_tr_b16 a[150:151], v19 offset:46080
  v_mfma_f32_16x16x32_bf16 v[216:219], a[160:163], a[32:35], v[216:219]
  s_waitcnt lgkmcnt(6)
  s_add_u32 m0, s36, 45056
  ds_read_b64_tr_b16 a[152:153], v22 offset:45056
  v_mfma_f32_16x16x32_bf16 v[220:223], a[160:163], a[36:39], v[220:223]
  ds_read_b64_tr_b16 a[154:155], v22 offset:46080
  ds_read_b64_tr_b16 a[156:157], v25 offset:45056
  v_mfma_f32_16x16x32_bf16 v[212:215], a[164:167], a[36:39], v[212:215]
  buffer_load_dwordx4 v33, s[12:15], s74 offen lds
  v_mfma_f32_16x16x32_bf16 v[208:211], a[164:167], a[32:35], v[208:211]
  ds_read_b64_tr_b16 a[158:159], v25 offset:46080
  v_cvt_pk_bf16_f32 v83, v114, v115
  v_mfma_f32_16x16x32_bf16 v[200:203], a[168:171], a[32:35], v[200:203]
  s_waitcnt vmcnt(12)
  s_barrier
  ds_read_b64_tr_b16 a[160:161], v17 offset:0
  v_mfma_f32_16x16x32_bf16 v[204:207], a[168:171], a[36:39], v[204:207]
  s_waitcnt lgkmcnt(5)
  s_add_u32 s97, s81, 16384
  ds_read_b64_tr_b16 a[162:163], v17 offset:1024
  v_mfma_f32_16x16x32_bf16 v[196:199], a[172:175], a[36:39], v[196:199]
  ds_read_b64_tr_b16 a[164:165], v20 offset:0
  ds_read_b64_tr_b16 a[166:167], v20 offset:1024
  v_mfma_f32_16x16x32_bf16 v[192:195], a[172:175], a[32:35], v[192:195]
  buffer_store_dwordx4 v[80:83], v2, s[16:19], s97 offen offset:0 sc1
  v_mfma_f32_16x16x32_bf16 v[216:219], a[144:147], a[40:43], v[216:219]
  ds_read_b64_tr_b16 a[168:169], v23 offset:0
  v_cvt_pk_bf16_f32 v84, v124, v125
  v_mfma_f32_16x16x32_bf16 v[220:223], a[144:147], a[44:47], v[220:223]
  s_add_u32 m0, s36, 49152
  ds_read_b64_tr_b16 a[170:171], v23 offset:1024
  v_mfma_f32_16x16x32_bf16 v[212:215], a[148:151], a[44:47], v[212:215]
  ds_read_b64_tr_b16 a[172:173], v26 offset:0
  ds_read_b64_tr_b16 a[174:175], v26 offset:1024
  v_mfma_f32_16x16x32_bf16 v[208:211], a[148:151], a[40:43], v[208:211]
  s_waitcnt lgkmcnt(6)
  buffer_load_dwordx4 v33, s[12:15], s75 offen lds
  v_mfma_f32_16x16x32_bf16 v[200:203], a[152:155], a[40:43], v[200:203]
  ds_read_b64_tr_b16 a[144:145], v17 offset:4096
  v_cvt_pk_bf16_f32 v85, v126, v127
  v_mfma_f32_16x16x32_bf16 v[204:207], a[152:155], a[44:47], v[204:207]
  ds_read_b64_tr_b16 a[146:147], v17 offset:5120
  v_cvt_pk_bf16_f32 v86, v116, v117
  v_mfma_f32_16x16x32_bf16 v[196:199], a[156:159], a[44:47], v[196:199]
  ds_read_b64_tr_b16 a[148:149], v20 offset:4096
  v_cvt_pk_bf16_f32 v87, v118, v119
  v_mfma_f32_16x16x32_bf16 v[192:195], a[156:159], a[40:43], v[192:195]
  s_add_u32 s97, s81, 16384
  ds_read_b64_tr_b16 a[150:151], v20 offset:5120
  v_mfma_f32_16x16x32_bf16 v[216:219], a[160:163], a[48:51], v[216:219]
  ds_read_b64_tr_b16 a[152:153], v23 offset:4096
  ds_read_b64_tr_b16 a[154:155], v23 offset:5120
  v_mfma_f32_16x16x32_bf16 v[220:223], a[160:163], a[52:55], v[220:223]
  s_waitcnt lgkmcnt(6)
  buffer_store_dwordx4 v[84:87], v2, s[16:19], s97 offen offset:1024 sc1
  v_mfma_f32_16x16x32_bf16 v[212:215], a[164:167], a[52:55], v[212:215]
  ds_read_b64_tr_b16 a[156:157], v26 offset:4096
  v_mfma_f32_16x16x32_bf16 v[208:211], a[164:167], a[48:51], v[208:211]
  ds_read_b64_tr_b16 a[158:159], v26 offset:5120
  v_mfma_f32_16x16x32_bf16 v[200:203], a[168:171], a[48:51], v[200:203]
  ds_read_b64_tr_b16 a[160:161], v17 offset:8192
  ds_read_b64_tr_b16 a[162:163], v17 offset:9216
  v_mfma_f32_16x16x32_bf16 v[204:207], a[168:171], a[52:55], v[204:207]
  buffer_load_dwordx4 v[40:43], v34, s[4:7], s42 offen
  v_mfma_f32_16x16x32_bf16 v[196:199], a[172:175], a[52:55], v[196:199]
  ds_read_b64_tr_b16 a[164:165], v20 offset:8192
  v_mfma_f32_16x16x32_bf16 v[192:195], a[172:175], a[48:51], v[192:195]
  s_waitcnt lgkmcnt(5)
  ds_read_b64_tr_b16 a[166:167], v20 offset:9216
  v_mfma_f32_16x16x32_bf16 v[216:219], a[144:147], a[56:59], v[216:219]
  ds_read_b64_tr_b16 a[168:169], v23 offset:8192
  v_mfma_f32_16x16x32_bf16 v[220:223], a[144:147], a[60:63], v[220:223]
  ds_read_b64_tr_b16 a[170:171], v23 offset:9216
  v_mfma_f32_16x16x32_bf16 v[212:215], a[148:151], a[60:63], v[212:215]
  ds_read_b64_tr_b16 a[172:173], v26 offset:8192
  v_mfma_f32_16x16x32_bf16 v[208:211], a[148:151], a[56:59], v[208:211]
  ds_read_b64_tr_b16 a[174:175], v26 offset:9216
  v_mfma_f32_16x16x32_bf16 v[200:203], a[152:155], a[56:59], v[200:203]
  ds_read_b64_tr_b16 a[144:145], v17 offset:12288
  v_mfma_f32_16x16x32_bf16 v[204:207], a[152:155], a[60:63], v[204:207]
  s_waitcnt lgkmcnt(5)
  ds_read_b64_tr_b16 a[146:147], v17 offset:13312
  v_mfma_f32_16x16x32_bf16 v[196:199], a[156:159], a[60:63], v[196:199]
  ds_read_b64_tr_b16 a[148:149], v20 offset:12288
  v_mfma_f32_16x16x32_bf16 v[192:195], a[156:159], a[56:59], v[192:195]
  ds_read_b64_tr_b16 a[150:151], v20 offset:13312
  v_mfma_f32_16x16x32_bf16 v[216:219], a[160:163], a[64:67], v[216:219]
  ds_read_b64_tr_b16 a[152:153], v23 offset:12288
  v_mfma_f32_16x16x32_bf16 v[220:223], a[160:163], a[68:71], v[220:223]
  ds_read_b64_tr_b16 a[154:155], v23 offset:13312
  v_mfma_f32_16x16x32_bf16 v[212:215], a[164:167], a[68:71], v[212:215]
  ds_read_b64_tr_b16 a[156:157], v26 offset:12288
  ds_read_b64_tr_b16 a[158:159], v26 offset:13312
  v_mfma_f32_16x16x32_bf16 v[208:211], a[164:167], a[64:67], v[208:211]
  s_waitcnt lgkmcnt(6)
  buffer_load_dwordx4 v[44:47], v38, s[4:7], s42 offen
  v_mfma_f32_16x16x32_bf16 v[200:203], a[168:171], a[64:67], v[200:203]
  ds_read_b64_tr_b16 a[160:161], v17 offset:16384
  v_mfma_f32_16x16x32_bf16 v[204:207], a[168:171], a[68:71], v[204:207]
  ds_read_b64_tr_b16 a[162:163], v17 offset:17408
  v_mfma_f32_16x16x32_bf16 v[196:199], a[172:175], a[68:71], v[196:199]
  ds_read_b64_tr_b16 a[164:165], v20 offset:16384
  v_mfma_f32_16x16x32_bf16 v[192:195], a[172:175], a[64:67], v[192:195]
  ds_read_b64_tr_b16 a[166:167], v20 offset:17408
  v_mfma_f32_16x16x32_bf16 v[184:187], a[144:147], a[0:3], v[184:187]
  ds_read_b64_tr_b16 a[168:169], v23 offset:16384
  v_mfma_f32_16x16x32_bf16 v[188:191], a[144:147], a[4:7], v[188:191]
  s_waitcnt lgkmcnt(5)
  ds_read_b64_tr_b16 a[170:171], v23 offset:17408
  v_mfma_f32_16x16x32_bf16 v[180:183], a[148:151], a[4:7], v[180:183]
  ds_read_b64_tr_b16 a[172:173], v26 offset:16384
  s_cmp_eq_u32 s37, 0
  s_cbranch_scc0 L_n2
  s_movk_i32 s95, 4096
  v_cmp_ne_u32 vcc, s34, v10
v_cmp_ne_u32 s[96:97], s34, v11
s_or_b64 vcc, vcc, s[96:97]
v_cmp_ne_u32 s[96:97], s34, v12
s_or_b64 vcc, vcc, s[96:97]
v_cmp_ne_u32 s[96:97], s34, v13
s_or_b64 vcc, vcc, s[96:97]
  s_cbranch_vccz L_n_ok
  s_mov_b32 s98, 0
L_n_spin:
  s_sleep 1
  buffer_load_dwordx4 v[10:13], v14, s[16:19], s95 offen sc1
  s_waitcnt vmcnt(0)
  v_cmp_ne_u32 vcc, s34, v10
v_cmp_ne_u32 s[96:97], s34, v11
s_or_b64 vcc, vcc, s[96:97]
v_cmp_ne_u32 s[96:97], s34, v12
s_or_b64 vcc, vcc, s[96:97]
v_cmp_ne_u32 s[96:97], s34, v13
s_or_b64 vcc, vcc, s[96:97]
  s_cbranch_vccz L_n_ok
  s_add_u32 s98, s98, 1
  s_cmp_lt_u32 s98, 0x8000
  s_cbranch_scc1 L_n_spin
L_n_ok:
  s_nop 1
  s_mov_b32 s93, 0
  s_cmp_eq_u32 s28, 0
  s_cselect_b32 s93, s93, 1073741824
  v_mov_b32 v0, s34
  buffer_store_dword v0, off, s[16:19], s93 sc1
L_n2:
  v_mfma_f32_16x16x32_bf16 v[176:179], a[148:151], a[0:3], v[176:179]
  ds_read_b64_tr_b16 a[174:175], v26 offset:17408
  v_mfma_f32_16x16x32_bf16 v[168:171], a[152:155], a[0:3], v[168:171]
  ds_read_b64_tr_b16 a[144:145], v17 offset:20480
  v_cvt_pk_bf16_f32 v88, v216, v217
  v_mfma_f32_16x16x32_bf16 v[172:175], a[152:155], a[4:7], v[172:175]
  ds_read_b64_tr_b16 a[146:147], v17 offset:21504
  v_cvt_pk_bf16_f32 v89, v218, v219
  v_mfma_f32_16x16x32_bf16 v[164:167], a[156:159], a[4:7], v[164:167]
  ds_read_b64_tr_b16 a[148:149], v20 offset:20480
  v_cvt_pk_bf16_f32 v90, v208, v209
  v_mfma_f32_16x16x32_bf16 v[160:163], a[156:159], a[0:3], v[160:163]
  s_waitcnt lgkmcnt(5)
  ds_read_b64_tr_b16 a[150:151], v20 offset:21504
  v_cvt_pk_bf16_f32 v91, v210, v211
  v_mfma_f32_16x16x32_bf16 v[184:187], a[160:163], a[8:11], v[184:187]
  s_add_u32 s97, s47, s53
  ds_read_b64_tr_b16 a[152:153], v23 offset:20480
  v_mfma_f32_16x16x32_bf16 v[188:191], a[160:163], a[12:15], v[188:191]
  ds_read_b64_tr_b16 a[154:155], v23 offset:21504
  ds_read_b64_tr_b16 a[156:157], v26 offset:20480
  v_mfma_f32_16x16x32_bf16 v[180:183], a[164:167], a[12:15], v[180:183]
  buffer_store_dwordx4 v[88:91], v2, s[16:19], s97 offen offset:0 sc1
  v_mfma_f32_16x16x32_bf16 v[176:179], a[164:167], a[8:11], v[176:179]
  ds_read_b64_tr_b16 a[158:159], v26 offset:21504
  v_mfma_f32_16x16x32_bf16 v[168:171], a[168:171], a[8:11], v[168:171]
  s_waitcnt lgkmcnt(6)
  ds_read_b64_tr_b16 a[160:161], v17 offset:24576
  v_mfma_f32_16x16x32_bf16 v[172:175], a[168:171], a[12:15], v[172:175]
  ds_read_b64_tr_b16 a[162:163], v17 offset:25600
  ds_read_b64_tr_b16 a[164:165], v20 offset:24576
  v_mfma_f32_16x16x32_bf16 v[164:167], a[172:175], a[12:15], v[164:167]
  buffer_load_dword v48, v35, s[4:7], s44 offen
  v_mfma_f32_16x16x32_bf16 v[160:163], a[172:175], a[8:11], v[160:163]
  s_waitcnt lgkmcnt(5)
  ds_read_b64_tr_b16 a[166:167], v20 offset:25600
  v_mfma_f32_16x16x32_bf16 v[184:187], a[144:147], a[16:19], v[184:187]
  ds_read_b64_tr_b16 a[168:169], v23 offset:24576
  v_cvt_pk_bf16_f32 v92, v220, v221
  v_mfma_f32_16x16x32_bf16 v[188:191], a[144:147], a[20:23], v[188:191]
  ds_read_b64_tr_b16 a[170:171], v23 offset:25600
  v_cvt_pk_bf16_f32 v93, v222, v223
  v_mfma_f32_16x16x32_bf16 v[180:183], a[148:151], a[20:23], v[180:183]
  ds_read_b64_tr_b16 a[172:173], v26 offset:24576
  v_cvt_pk_bf16_f32 v94, v212, v213
  v_mfma_f32_16x16x32_bf16 v[176:179], a[148:151], a[16:19], v[176:179]
  ds_read_b64_tr_b16 a[174:175], v26 offset:25600
  v_cvt_pk_bf16_f32 v95, v214, v215
  v_mfma_f32_16x16x32_bf16 v[168:171], a[152:155], a[16:19], v[168:171]
  s_waitcnt lgkmcnt(6)
  s_add_u32 s97, s47, s53
  ds_read_b64_tr_b16 a[144:145], v17 offset:28672
  v_mfma_f32_16x16x32_bf16 v[172:175], a[152:155], a[20:23], v[172:175]
  ds_read_b64_tr_b16 a[146:147], v17 offset:29696
  ds_read_b64_tr_b16 a[148:149], v20 offset:28672
  v_mfma_f32_16x16x32_bf16 v[164:167], a[156:159], a[20:23], v[164:167]
  buffer_store_dwordx4 v[92:95], v2, s[16:19], s97 offen offset:1024 sc1
  v_mfma_f32_16x16x32_bf16 v[160:163], a[156:159], a[16:19], v[160:163]
  ds_read_b64_tr_b16 a[150:151], v20 offset:29696
  v_mfma_f32_16x16x32_bf16 v[184:187], a[160:163], a[24:27], v[184:187]
  ds_read_b64_tr_b16 a[152:153], v23 offset:28672
  v_mfma_f32_16x16x32_bf16 v[188:191], a[160:163], a[28:31], v[188:191]
  s_waitcnt lgkmcnt(5)
  ds_read_b64_tr_b16 a[154:155], v23 offset:29696
  v_mfma_f32_16x16x32_bf16 v[180:183], a[164:167], a[28:31], v[180:183]
  ds_read_b64_tr_b16 a[156:157], v26 offset:28672
  v_mfma_f32_16x16x32_bf16 v[176:179], a[164:167], a[24:27], v[176:179]
  ds_read_b64_tr_b16 a[158:159], v26 offset:29696
  v_cvt_pk_bf16_f32 v96, v200, v201
  v_mfma_f32_16x16x32_bf16 v[168:171], a[168:171], a[24:27], v[168:171]
  ds_read_b64_tr_b16 a[160:161], v17 offset:32768
  v_cvt_pk_bf16_f32 v97, v202, v203
  v_mfma_f32_16x16x32_bf16 v[172:175], a[168:171], a[28:31], v[172:175]
  ds_read_b64_tr_b16 a[162:163], v17 offset:33792
  v_cvt_pk_bf16_f32 v98, v192, v193
  v_mfma_f32_16x16x32_bf16 v[164:167], a[172:175], a[28:31], v[164:167]
  ds_read_b64_tr_b16 a[164:165], v20 offset:32768
  v_cvt_pk_bf16_f32 v99, v194, v195
  v_mfma_f32_16x16x32_bf16 v[160:163], a[172:175], a[24:27], v[160:163]
  s_waitcnt lgkmcnt(5)
  s_add_u32 s97, s47, s55
  ds_read_b64_tr_b16 a[166:167], v20 offset:33792
  v_mfma_f32_16x16x32_bf16 v[184:187], a[144:147], a[32:35], v[184:187]
  ds_read_b64_tr_b16 a[168:169], v23 offset:32768
  ds_read_b64_tr_b16 a[170:171], v23 offset:33792
  v_mfma_f32_16x16x32_bf16 v[188:191], a[144:147], a[36:39], v[188:191]
  buffer_store_dwordx4 v[96:99], v2, s[16:19], s97 offen offset:0 sc1
  v_mfma_f32_16x16x32_bf16 v[180:183], a[148:151], a[36:39], v[180:183]
  ds_read_b64_tr_b16 a[172:173], v26 offset:32768
  v_mfma_f32_16x16x32_bf16 v[176:179], a[148:151], a[32:35], v[176:179]
  ds_read_b64_tr_b16 a[174:175], v26 offset:33792
  v_mfma_f32_16x16x32_bf16 v[168:171], a[152:155], a[32:35], v[168:171]
  s_waitcnt vmcnt(7)
  s_waitcnt vmcnt(6)
  s_barrier
  ds_read_b64_tr_b16 a[144:145], v17 offset:36864
  s_lshl2_add_u32 s93, s31, s46
  s_cmp_eq_u32 s28, 0
  s_cselect_b32 s93, s93, 1073741824
  v_mov_b32 v0, s34
  buffer_store_dword v0, off, s[16:19], s93 sc1
  v_mfma_f32_16x16x32_bf16 v[172:175], a[152:155], a[36:39], v[172:175]
  s_waitcnt lgkmcnt(5)
  ds_read_b64_tr_b16 a[146:147], v17 offset:37888
  v_mfma_f32_16x16x32_bf16 v[164:167], a[156:159], a[36:39], v[164:167]
  ds_read_b64_tr_b16 a[148:149], v20 offset:36864
  v_mfma_f32_16x16x32_bf16 v[160:163], a[156:159], a[32:35], v[160:163]
  ds_read_b64_tr_b16 a[150:151], v20 offset:37888
  v_cvt_pk_bf16_f32 v100, v204, v205
  v_mfma_f32_16x16x32_bf16 v[184:187], a[160:163], a[40:43], v[184:187]
  ds_read_b64_tr_b16 a[152:153], v23 offset:36864
  v_cvt_pk_bf16_f32 v101, v206, v207
  v_mfma_f32_16x16x32_bf16 v[188:191], a[160:163], a[44:47], v[188:191]
  ds_read_b64_tr_b16 a[154:155], v23 offset:37888
  v_cvt_pk_bf16_f32 v102, v196, v197
  v_mfma_f32_16x16x32_bf16 v[180:183], a[164:167], a[44:47], v[180:183]
  s_waitcnt lgkmcnt(6)
  ds_read_b64_tr_b16 a[156:157], v26 offset:36864
  v_mfma_f32_16x16x32_bf16 v[176:179], a[164:167], a[40:43], v[176:179]
  ds_read_b64_tr_b16 a[158:159], v26 offset:37888
  v_cvt_pk_bf16_f32 v103, v198, v199
  v_mfma_f32_16x16x32_bf16 v[168:171], a[168:171], a[40:43], v[168:171]
  s_add_u32 s97, s47, s55
  ds_read_b64_tr_b16 a[160:161], v17 offset:40960
  v_mfma_f32_16x16x32_bf16 v[172:175], a[168:171], a[44:47], v[172:175]
  ds_read_b64_tr_b16 a[162:163], v17 offset:41984
  ds_read_b64_tr_b16 a[164:165], v20 offset:40960
  v_mfma_f32_16x16x32_bf16 v[164:167], a[172:175], a[44:47], v[164:167]
  buffer_store_dwordx4 v[100:103], v2, s[16:19], s97 offen offset:1024 sc1
  v_mfma_f32_16x16x32_bf16 v[160:163], a[172:175], a[40:43], v[160:163]
  s_waitcnt lgkmcnt(5)
  ds_read_b64_tr_b16 a[166:167], v20 offset:41984
  v_mfma_f32_16x16x32_bf16 v[184:187], a[144:147], a[48:51], v[184:187]
  ds_read_b64_tr_b16 a[168:169], v23 offset:40960
  v_mfma_f32_16x16x32_bf16 v[188:191], a[144:147], a[52:55], v[188:191]
  ds_read_b64_tr_b16 a[170:171], v23 offset:41984
  v_mfma_f32_16x16x32_bf16 v[180:183], a[148:151], a[52:55], v[180:183]
  ds_read_b64_tr_b16 a[172:173], v26 offset:40960
  v_mfma_f32_16x16x32_bf16 v[176:179], a[148:151], a[48:51], v[176:179]
  ds_read_b64_tr_b16 a[174:175], v26 offset:41984
  v_mfma_f32_16x16x32_bf16 v[168:171], a[152:155], a[48:51], v[168:171]
  ds_read_b64_tr_b16 a[144:145], v17 offset:45056
  v_mfma_f32_16x16x32_bf16 v[172:175], a[152:155], a[52:55], v[172:175]
  s_waitcnt lgkmcnt(5)
  ds_read_b64_tr_b16 a[146:147], v17 offset:46080
  v_mfma_f32_16x16x32_bf16 v[164:167], a[156:159], a[52:55], v[164:167]
  ds_read_b64_tr_b16 a[148:149], v20 offset:45056
  v_mfma_f32_16x16x32_bf16 v[160:163], a[156:159], a[48:51], v[160:163]
  ds_read_b64_tr_b16 a[150:151], v20 offset:46080
  v_mfma_f32_16x16x32_bf16 v[184:187], a[160:163], a[56:59], v[184:187]
  ds_read_b64_tr_b16 a[152:153], v23 offset:45056
  v_mfma_f32_16x16x32_bf16 v[188:191], a[160:163], a[60:63], v[188:191]
  ds_read_b64_tr_b16 a[154:155], v23 offset:46080
  v_mfma_f32_16x16x32_bf16 v[180:183], a[164:167], a[60:63], v[180:183]
  ds_read_b64_tr_b16 a[156:157], v26 offset:45056
  v_mfma_f32_16x16x32_bf16 v[176:179], a[164:167], a[56:59], v[176:179]
  s_waitcnt lgkmcnt(5)
  ds_read_b64_tr_b16 a[158:159], v26 offset:46080
  v_mfma_f32_16x16x32_bf16 v[168:171], a[168:171], a[56:59], v[168:171]
  ds_read_b64_tr_b16 a[160:161], v15 offset:0
  v_mfma_f32_16x16x32_bf16 v[172:175], a[168:171], a[60:63], v[172:175]
  ds_read_b64_tr_b16 a[162:163], v15 offset:1024
  v_mfma_f32_16x16x32_bf16 v[164:167], a[172:175], a[60:63], v[164:167]
  ds_read_b64_tr_b16 a[164:165], v18 offset:0
  v_mfma_f32_16x16x32_bf16 v[160:163], a[172:175], a[56:59], v[160:163]
  ds_read_b64_tr_b16 a[166:167], v18 offset:1024
  v_mfma_f32_16x16x32_bf16 v[184:187], a[144:147], a[64:67], v[184:187]
  ds_read_b64_tr_b16 a[168:169], v15 offset:4096
  v_mfma_f32_16x16x32_bf16 v[188:191], a[144:147], a[68:71], v[188:191]
  s_waitcnt lgkmcnt(5)
  ds_read_b64_tr_b16 a[170:171], v15 offset:5120
  v_mfma_f32_16x16x32_bf16 v[180:183], a[148:151], a[68:71], v[180:183]
  ds_read_b64_tr_b16 a[172:173], v18 offset:4096
  v_mfma_f32_16x16x32_bf16 v[176:179], a[148:151], a[64:67], v[176:179]
  ds_read_b64_tr_b16 a[174:175], v18 offset:5120
  v_mfma_f32_16x16x32_bf16 v[168:171], a[152:155], a[64:67], v[168:171]
  ds_read_b64_tr_b16 a[144:145], v15 offset:8192
  v_mfma_f32_16x16x32_bf16 v[172:175], a[152:155], a[68:71], v[172:175]
  ds_read_b64_tr_b16 a[146:147], v15 offset:9216
  v_mfma_f32_16x16x32_bf16 v[164:167], a[156:159], a[68:71], v[164:167]
  ds_read_b64_tr_b16 a[148:149], v18 offset:8192
  v_mfma_f32_16x16x32_bf16 v[160:163], a[156:159], a[64:67], v[160:163]
  s_waitcnt lgkmcnt(5)
  ds_read_b64_tr_b16 a[150:151], v18 offset:9216
  v_mfma_f32_16x16x32_bf16 v[152:155], a[160:163], a[0:3], v[152:155]
  ds_read_b64_tr_b16 a[152:153], v15 offset:12288
  v_mfma_f32_16x16x32_bf16 v[156:159], a[160:163], a[4:7], v[156:159]
  ds_read_b64_tr_b16 a[154:155], v15 offset:13312
  v_mfma_f32_16x16x32_bf16 v[148:151], a[164:167], a[4:7], v[148:151]
  s_waitcnt lgkmcnt(6)
  ds_read_b64_tr_b16 a[156:157], v18 offset:12288
  v_mfma_f32_16x16x32_bf16 v[144:147], a[164:167], a[0:3], v[144:147]
  ds_read_b64_tr_b16 a[158:159], v18 offset:13312
  v_cvt_pk_bf16_f32 v104, v184, v185
  v_mfma_f32_16x16x32_bf16 v[152:155], a[168:171], a[8:11], v[152:155]
  ds_read_b64_tr_b16 a[160:161], v15 offset:16384
  v_cvt_pk_bf16_f32 v105, v186, v187
  v_mfma_f32_16x16x32_bf16 v[156:159], a[168:171], a[12:15], v[156:159]
  ds_read_b64_tr_b16 a[162:163], v15 offset:17408
  v_cvt_pk_bf16_f32 v106, v176, v177
  v_mfma_f32_16x16x32_bf16 v[148:151], a[172:175], a[12:15], v[148:151]
  ds_read_b64_tr_b16 a[164:165], v18 offset:16384
  v_cvt_pk_bf16_f32 v107, v178, v179
  v_mfma_f32_16x16x32_bf16 v[144:147], a[172:175], a[8:11], v[144:147]
  s_waitcnt lgkmcnt(5)
  s_add_u32 s97, s49, s53
  ds_read_b64_tr_b16 a[166:167], v18 offset:17408
  v_mfma_f32_16x16x32_bf16 v[152:155], a[144:147], a[16:19], v[152:155]
  ds_read_b64_tr_b16 a[168:169], v15 offset:20480
  ds_read_b64_tr_b16 a[170:171], v15 offset:21504
  v_mfma_f32_16x16x32_bf16 v[156:159], a[144:147], a[20:23], v[156:159]
  buffer_store_dwordx4 v[104:107], v2, s[16:19], s97 offen offset:0 sc1
  v_mfma_f32_16x16x32_bf16 v[148:151], a[148:151], a[20:23], v[148:151]
  ds_read_b64_tr_b16 a[172:173], v18 offset:20480
  v_cvt_pk_bf16_f32 v108, v188, v189
  v_mfma_f32_16x16x32_bf16 v[144:147], a[148:151], a[16:19], v[144:147]
  s_waitcnt lgkmcnt(5)
  ds_read_b64_tr_b16 a[174:175], v18 offset:21504
  v_mfma_f32_16x16x32_bf16 v[152:155], a[152:155], a[24:27], v[152:155]
  ds_read_b64_tr_b16 a[144:145], v15 offset:24576
  v_cvt_pk_bf16_f32 v109, v190, v191
  v_mfma_f32_16x16x32_bf16 v[156:159], a[152:155], a[28:31], v[156:159]
  ds_read_b64_tr_b16 a[146:147], v15 offset:25600
  v_cvt_pk_bf16_f32 v110, v180, v181
  v_mfma_f32_16x16x32_bf16 v[148:151], a[156:159], a[28:31], v[148:151]
  ds_read_b64_tr_b16 a[148:149], v18 offset:24576
  v_cvt_pk_bf16_f32 v111, v182, v183
  v_mfma_f32_16x16x32_bf16 v[144:147], a[156:159], a[24:27], v[144:147]
  s_add_u32 s97, s49, s53
  ds_read_b64_tr_b16 a[150:151], v18 offset:25600
  v_mfma_f32_16x16x32_bf16 v[152:155], a[160:163], a[32:35], v[152:155]
  ds_read_b64_tr_b16 a[152:153], v15 offset:28672
  ds_read_b64_tr_b16 a[154:155], v15 offset:29696
  v_mfma_f32_16x16x32_bf16 v[156:159], a[160:163], a[36:39], v[156:159]
  s_waitcnt lgkmcnt(6)
  buffer_store_dwordx4 v[108:111], v2, s[16:19], s97 offen offset:1024 sc1
  v_mfma_f32_16x16x32_bf16 v[148:151], a[164:167], a[36:39], v[148:151]
  ds_read_b64_tr_b16 a[156:157], v18 offset:28672
  v_cvt_pk_bf16_f32 v64, v168, v169
  v_mfma_f32_16x16x32_bf16 v[144:147], a[164:167], a[32:35], v[144:147]
  ds_read_b64_tr_b16 a[158:159], v18 offset:29696
  v_cvt_pk_bf16_f32 v65, v170, v171
  v_mfma_f32_16x16x32_bf16 v[152:155], a[168:171], a[40:43], v[152:155]
  ds_read_b64_tr_b16 a[160:161], v15 offset:32768
  v_cvt_pk_bf16_f32 v66, v160, v161
  v_mfma_f32_16x16x32_bf16 v[156:159], a[168:171], a[44:47], v[156:159]
  ds_read_b64_tr_b16 a[162:163], v15 offset:33792
  v_mfma_f32_16x16x32_bf16 v[148:151], a[172:175], a[44:47], v[148:151]
  ds_read_b64_tr_b16 a[164:165], v18 offset:32768
  v_cvt_pk_bf16_f32 v67, v162, v163
  v_mfma_f32_16x16x32_bf16 v[144:147], a[172:175], a[40:43], v[144:147]
  s_waitcnt lgkmcnt(5)
  s_add_u32 s97, s49, s55
  ds_read_b64_tr_b16 a[166:167], v18 offset:33792
  v_mfma_f32_16x16x32_bf16 v[152:155], a[144:147], a[48:51], v[152:155]
  ds_read_b64_tr_b16 a[168:169], v21 offset:0
  ds_read_b64_tr_b16 a[170:171], v21 offset:1024
  v_mfma_f32_16x16x32_bf16 v[156:159], a[144:147], a[52:55], v[156:159]
  buffer_store_dwordx4 v[64:67], v2, s[16:19], s97 offen offset:0 sc1
  v_mfma_f32_16x16x32_bf16 v[148:151], a[148:151], a[52:55], v[148:151]
  ds_read_b64_tr_b16 a[172:173], v24 offset:0
  v_cvt_pk_bf16_f32 v68, v172, v173
  v_mfma_f32_16x16x32_bf16 v[144:147], a[148:151], a[48:51], v[144:147]
  ds_read_b64_tr_b16 a[174:175], v24 offset:1024
  v_cvt_pk_bf16_f32 v69, v174, v175
  v_mfma_f32_16x16x32_bf16 v[152:155], a[152:155], a[56:59], v[152:155]
  ds_read_b64_tr_b16 a[144:145], v21 offset:4096
  v_cvt_pk_bf16_f32 v70, v164, v165
  v_mfma_f32_16x16x32_bf16 v[156:159], a[152:155], a[60:63], v[156:159]
  s_waitcnt lgkmcnt(5)
  ds_read_b64_tr_b16 a[146:147], v21 offset:5120
  v_cvt_pk_bf16_f32 v71, v166, v167
  v_mfma_f32_16x16x32_bf16 v[148:151], a[156:159], a[60:63], v[148:151]
  s_add_u32 s97, s49, s55
  ds_read_b64_tr_b16 a[148:149], v24 offset:4096
  v_mfma_f32_16x16x32_bf16 v[144:147], a[156:159], a[56:59], v[144:147]
  ds_read_b64_tr_b16 a[150:151], v24 offset:5120
  ds_read_b64_tr_b16 a[152:153], v21 offset:8192
  v_mfma_f32_16x16x32_bf16 v[152:155], a[160:163], a[64:67], v[152:155]
  buffer_store_dwordx4 v[68:71], v2, s[16:19], s97 offen offset:1024 sc1
  v_mfma_f32_16x16x32_bf16 v[156:159], a[160:163], a[68:71], v[156:159]
  ds_read_b64_tr_b16 a[154:155], v21 offset:9216
  v_mfma_f32_16x16x32_bf16 v[148:151], a[164:167], a[68:71], v[148:151]
  ds_read_b64_tr_b16 a[156:157], v24 offset:8192
  v_mfma_f32_16x16x32_bf16 v[144:147], a[164:167], a[64:67], v[144:147]
  s_waitcnt lgkmcnt(5)
  ds_read_b64_tr_b16 a[158:159], v24 offset:9216
  v_mfma_f32_16x16x32_bf16 v[136:139], a[168:171], a[0:3], v[136:139]
  ds_read_b64_tr_b16 a[160:161], v21 offset:12288
  v_mfma_f32_16x16x32_bf16 v[140:143], a[168:171], a[4:7], v[140:143]
  ds_read_b64_tr_b16 a[162:163], v21 offset:13312
  v_mfma_f32_16x16x32_bf16 v[132:135], a[172:175], a[4:7], v[132:135]
  ds_read_b64_tr_b16 a[164:165], v24 offset:12288
  v_mfma_f32_16x16x32_bf16 v[128:131], a[172:175], a[0:3], v[128:131]
  ds_read_b64_tr_b16 a[166:167], v24 offset:13312
  v_cvt_pk_bf16_f32 v72, v152, v153
  v_cvt_pk_bf16_f32 v73, v154, v155
  v_mfma_f32_16x16x32_bf16 v[136:139], a[144:147], a[8:11], v[136:139]
  ds_read_b64_tr_b16 a[168:169], v21 offset:16384
  v_cvt_pk_bf16_f32 v74, v144, v145
  v_cvt_pk_bf16_f32 v75, v146, v147
  v_mfma_f32_16x16x32_bf16 v[140:143], a[144:147], a[12:15], v[140:143]
  s_waitcnt lgkmcnt(5)
  ds_read_b64_tr_b16 a[170:171], v21 offset:17408
  v_mfma_f32_16x16x32_bf16 v[132:135], a[148:151], a[12:15], v[132:135]
  s_add_u32 s97, s51, s53
  ds_read_b64_tr_b16 a[172:173], v24 offset:16384
  v_mfma_f32_16x16x32_bf16 v[128:131], a[148:151], a[8:11], v[128:131]
  ds_read_b64_tr_b16 a[174:175], v24 offset:17408
  ds_read_b64_tr_b16 a[144:145], v21 offset:20480
  v_mfma_f32_16x16x32_bf16 v[136:139], a[152:155], a[16:19], v[136:139]
  buffer_store_dwordx4 v[72:75], v2, s[16:19], s97 offen offset:0 sc1
  v_mfma_f32_16x16x32_bf16 v[140:143], a[152:155], a[20:23], v[140:143]
  ds_read_b64_tr_b16 a[146:147], v21 offset:21504
  v_cvt_pk_bf16_f32 v76, v156, v157
  v_cvt_pk_bf16_f32 v77, v158, v159
  v_mfma_f32_16x16x32_bf16 v[132:135], a[156:159], a[20:23], v[132:135]
  ds_read_b64_tr_b16 a[148:149], v24 offset:20480
  v_cvt_pk_bf16_f32 v78, v148, v149
  v_cvt_pk_bf16_f32 v79, v150, v151
  v_mfma_f32_16x16x32_bf16 v[128:131], a[156:159], a[16:19], v[128:131]
  s_waitcnt lgkmcnt(5)
  s_add_u32 s97, s51, s53
  ds_read_b64_tr_b16 a[150:151], v24 offset:21504
  v_mfma_f32_16x16x32_bf16 v[136:139], a[160:163], a[24:27], v[136:139]
  ds_read_b64_tr_b16 a[152:153], v21 offset:24576
  ds_read_b64_tr_b16 a[154:155], v21 offset:25600
  v_mfma_f32_16x16x32_bf16 v[140:143], a[160:163], a[28:31], v[140:143]
  buffer_store_dwordx4 v[76:79], v2, s[16:19], s97 offen offset:1024 sc1
  v_mfma_f32_16x16x32_bf16 v[132:135], a[164:167], a[28:31], v[132:135]
  ds_read_b64_tr_b16 a[156:157], v24 offset:24576
  v_mfma_f32_16x16x32_bf16 v[128:131], a[164:167], a[24:27], v[128:131]
  ds_read_b64_tr_b16 a[158:159], v24 offset:25600
  v_mfma_f32_16x16x32_bf16 v[136:139], a[168:171], a[32:35], v[136:139]
  ds_read_b64_tr_b16 a[160:161], v21 offset:28672
  v_mfma_f32_16x16x32_bf16 v[140:143], a[168:171], a[36:39], v[140:143]
  s_waitcnt lgkmcnt(5)
  ds_read_b64_tr_b16 a[162:163], v21 offset:29696
  v_mfma_f32_16x16x32_bf16 v[132:135], a[172:175], a[36:39], v[132:135]
  ds_read_b64_tr_b16 a[164:165], v24 offset:28672
  v_mfma_f32_16x16x32_bf16 v[128:131], a[172:175], a[32:35], v[128:131]
  ds_read_b64_tr_b16 a[166:167], v24 offset:29696
  v_mfma_f32_16x16x32_bf16 v[136:139], a[144:147], a[40:43], v[136:139]
  ds_read_b64_tr_b16 a[168:169], v21 offset:32768
  v_mfma_f32_16x16x32_bf16 v[140:143], a[144:147], a[44:47], v[140:143]
  ds_read_b64_tr_b16 a[170:171], v21 offset:33792
  v_mfma_f32_16x16x32_bf16 v[132:135], a[148:151], a[44:47], v[132:135]
  ds_read_b64_tr_b16 a[172:173], v24 offset:32768
  v_mfma_f32_16x16x32_bf16 v[128:131], a[148:151], a[40:43], v[128:131]
  s_waitcnt lgkmcnt(5)
  ds_read_b64_tr_b16 a[174:175], v24 offset:33792
  v_mfma_f32_16x16x32_bf16 v[136:139], a[152:155], a[48:51], v[136:139]
  v_mfma_f32_16x16x32_bf16 v[140:143], a[152:155], a[52:55], v[140:143]
  v_mfma_f32_16x16x32_bf16 v[132:135], a[156:159], a[52:55], v[132:135]
  v_mfma_f32_16x16x32_bf16 v[128:131], a[156:159], a[48:51], v[128:131]
  v_mfma_f32_16x16x32_bf16 v[136:139], a[160:163], a[56:59], v[136:139]
  v_mfma_f32_16x16x32_bf16 v[140:143], a[160:163], a[60:63], v[140:143]
  s_waitcnt lgkmcnt(0)
  v_mfma_f32_16x16x32_bf16 v[132:135], a[164:167], a[60:63], v[132:135]
  v_mfma_f32_16x16x32_bf16 v[128:131], a[164:167], a[56:59], v[128:131]
  v_mfma_f32_16x16x32_bf16 v[136:139], a[168:171], a[64:67], v[136:139]
  v_mfma_f32_16x16x32_bf16 v[140:143], a[168:171], a[68:71], v[140:143]
  v_mfma_f32_16x16x32_bf16 v[132:135], a[172:175], a[68:71], v[132:135]
  v_mfma_f32_16x16x32_bf16 v[128:131], a[172:175], a[64:67], v[128:131]
  buffer_load_dword v60, v36, s[16:19], s46 offen offset:0 sc1
  s_movk_i32 s88, 0x3f80
  s_mov_b32 s89, 0x3f800000
  s_mov_b32 s90, 0xffff0000
  s_mov_b32 s91, 0xbf317218
  s_waitcnt vmcnt(1)
  s_barrier
  s_lshl2_add_u32 s93, s31, s46
  s_add_u32 s93, s93, 1024
  s_cmp_eq_u32 s28, 0
  s_cselect_b32 s93, s93, 1073741824
  v_mov_b32 v0, s34
  buffer_store_dword v0, off, s[16:19], s93 sc1
  s_waitcnt vmcnt(1)
  v_cmp_ne_u32 vcc, s34, v60
  s_cbranch_vccz L_fp0_ok
  s_mov_b32 s98, 0
L_fp0_spin:
  s_sleep 1
  buffer_load_dword v60, v36, s[16:19], s46 offen offset:0 sc1
  s_waitcnt vmcnt(0)
  v_cmp_ne_u32 vcc, s34, v60
  s_cbranch_vccz L_fp0_ok
  s_add_u32 s98, s98, 1
  s_cmp_lt_u32 s98, 0x8000
  s_cbranch_scc1 L_fp0_spin
L_fp0_ok:
  s_nop 1
  buffer_load_dwordx4 v[192:195], v2, s[16:19], s50 offen offset:0 sc1
  buffer_load_dwordx4 v[196:199], v2, s[16:19], s50 offen offset:1024 sc1
  s_add_u32 s86, s50, 147456
  buffer_load_dwordx4 v[200:203], v2, s[16:19], s86 offen offset:0 sc1
  buffer_load_dwordx4 v[204:207], v2, s[16:19], s86 offen offset:1024 sc1
  s_add_u32 s87, s48, 0
  buffer_load_dword v160, v37, s[16:19], s87 offen sc1
  s_add_u32 s87, s48, 147456
  buffer_load_dword v161, v37, s[16:19], s87 offen sc1
  s_add_u32 s87, s48, 294912
  buffer_load_dword v162, v37, s[16:19], s87 offen sc1
  s_add_u32 s87, s48, 442368
  buffer_load_dword v163, v37, s[16:19], s87 offen sc1
  s_add_u32 s87, s48, 589824
  buffer_load_dword v164, v37, s[16:19], s87 offen sc1
  s_add_u32 s87, s48, 737280
  buffer_load_dword v165, v37, s[16:19], s87 offen sc1
  s_add_u32 s87, s48, 884736
  buffer_load_dword v166, v37, s[16:19], s87 offen sc1
  s_add_u32 s87, s48, 1032192
  buffer_load_dword v167, v37, s[16:19], s87 offen sc1
  buffer_load_dword v61, v36, s[16:19], s46 offen offset:1024 sc1
  v_lshlrev_b32 v168, 16, v40
  v_and_b32 v169, s90, v40
  v_lshlrev_b32 v170, 16, v41
  v_and_b32 v171, s90, v41
  v_lshlrev_b32 v172, 16, v42
  v_and_b32 v173, s90, v42
  v_lshlrev_b32 v174, 16, v43
  v_and_b32 v175, s90, v43
  v_lshlrev_b32 v176, 16, v44
  v_and_b32 v177, s90, v44
  v_lshlrev_b32 v178, 16, v45
  v_and_b32 v179, s90, v45
  v_lshlrev_b32 v180, 16, v46
  v_and_b32 v181, s90, v46
  v_lshlrev_b32 v182, 16, v47
  v_and_b32 v183, s90, v47
  s_waitcnt vmcnt(12)
  v_dot2c_f32_bf16 v136, s88, v192
  v_dot2c_f32_bf16 v137, s89, v192
  v_dot2c_f32_bf16 v138, s88, v193
  v_dot2c_f32_bf16 v139, s89, v193
  v_dot2c_f32_bf16 v128, s88, v194
  v_dot2c_f32_bf16 v129, s89, v194
  v_dot2c_f32_bf16 v130, s88, v195
  v_dot2c_f32_bf16 v131, s89, v195
  s_waitcnt vmcnt(11)
  v_dot2c_f32_bf16 v140, s88, v196
  v_dot2c_f32_bf16 v141, s89, v196
  v_dot2c_f32_bf16 v142, s88, v197
  v_dot2c_f32_bf16 v143, s89, v197
  v_dot2c_f32_bf16 v132, s88, v198
  v_dot2c_f32_bf16 v133, s89, v198
  v_dot2c_f32_bf16 v134, s88, v199
  v_dot2c_f32_bf16 v135, s89, v199
  s_waitcnt vmcnt(10)
  v_dot2c_f32_bf16 v136, s88, v200
  v_dot2c_f32_bf16 v137, s89, v200
  v_dot2c_f32_bf16 v138, s88, v201
  v_dot2c_f32_bf16 v139, s89, v201
  v_dot2c_f32_bf16 v128, s88, v202
  v_dot2c_f32_bf16 v129, s89, v202
  v_dot2c_f32_bf16 v130, s88, v203
  v_dot2c_f32_bf16 v131, s89, v203
  s_waitcnt vmcnt(9)
  v_dot2c_f32_bf16 v140, s88, v204
  v_dot2c_f32_bf16 v141, s89, v204
  v_dot2c_f32_bf16 v142, s88, v205
  v_dot2c_f32_bf16 v143, s89, v205
  v_dot2c_f32_bf16 v132, s88, v206
  v_dot2c_f32_bf16 v133, s89, v206
  v_dot2c_f32_bf16 v134, s88, v207
  v_dot2c_f32_bf16 v135, s89, v207
  s_waitcnt vmcnt(8)
  v_lshlrev_b32 v62, 16, v160
  v_and_b32 v63, s90, v160
  s_waitcnt vmcnt(7)
  v_dot2c_f32_bf16 v62, s88, v161
  v_dot2c_f32_bf16 v63, s89, v161
  s_waitcnt vmcnt(6)
  v_dot2c_f32_bf16 v62, s88, v162
  v_dot2c_f32_bf16 v63, s89, v162
  s_waitcnt vmcnt(5)
  v_dot2c_f32_bf16 v62, s88, v163
  v_dot2c_f32_bf16 v63, s89, v163
  s_waitcnt vmcnt(4)
  v_dot2c_f32_bf16 v62, s88, v164
  v_dot2c_f32_bf16 v63, s89, v164
  s_waitcnt vmcnt(3)
  v_dot2c_f32_bf16 v62, s88, v165
  v_dot2c_f32_bf16 v63, s89, v165
  s_waitcnt vmcnt(2)
  v_dot2c_f32_bf16 v62, s88, v166
  v_dot2c_f32_bf16 v63, s89, v166
  s_waitcnt vmcnt(1)
  v_dot2c_f32_bf16 v62, s88, v167
  v_dot2c_f32_bf16 v63, s89, v167
  v_lshlrev_b32 v160, 16, v48
  v_and_b32 v161, s90, v48
  s_nop 0
  v_fma_f32 v62, v62, s91, v160
  v_fma_f32 v63, v63, s91, v161
  v_cvt_pk_bf16_f32 v48, v62, v63
  buffer_store_dword v48, v35, s[20:23], s44 offen
  s_waitcnt vmcnt(1)
  v_cmp_ne_u32 vcc, s34, v61
  s_nop 1
  s_and_b32 s97, vcc_lo, s57
  s_cbranch_scc0 L_fp1_ok
  s_mov_b32 s98, 0
L_fp1_spin:
  s_nop 0
  buffer_load_dword v61, v36, s[16:19], s46 offen offset:1024 sc1
  s_waitcnt vmcnt(0)
  v_cmp_ne_u32 vcc, s34, v61
  s_nop 1
  s_and_b32 s97, vcc_lo, s57
  s_cbranch_scc0 L_fp1_ok
  s_add_u32 s98, s98, 1
  s_cmp_lt_u32 s98, 0x8000
  s_cbranch_scc1 L_fp1_spin
L_fp1_ok:
  s_nop 1
  buffer_load_dwordx4 v[208:211], v2, s[16:19], s52 offen offset:0 sc1
  buffer_load_dwordx4 v[212:215], v2, s[16:19], s52 offen offset:1024 sc1
  s_add_u32 s86, s52, 147456
  buffer_load_dwordx4 v[216:219], v2, s[16:19], s86 offen offset:0 sc1
  buffer_load_dwordx4 v[220:223], v2, s[16:19], s86 offen offset:1024 sc1
  buffer_load_dwordx4 v[224:227], v2, s[16:19], s54 offen offset:0 sc1
  buffer_load_dwordx4 v[228:231], v2, s[16:19], s54 offen offset:1024 sc1
  s_add_u32 s86, s54, 147456
  buffer_load_dwordx4 v[232:235], v2, s[16:19], s86 offen offset:0 sc1
  buffer_load_dwordx4 v[236:239], v2, s[16:19], s86 offen offset:1024 sc1
  buffer_load_dwordx4 v[240:243], v2, s[16:19], s56 offen offset:0 sc1
  buffer_load_dwordx4 v[244:247], v2, s[16:19], s56 offen offset:1024 sc1
  s_waitcnt vmcnt(9)
  v_dot2c_f32_bf16 v136, s88, v208
  v_dot2c_f32_bf16 v137, s89, v208
  v_dot2c_f32_bf16 v138, s88, v209
  v_dot2c_f32_bf16 v139, s89, v209
  v_dot2c_f32_bf16 v128, s88, v210
  v_dot2c_f32_bf16 v129, s89, v210
  v_dot2c_f32_bf16 v130, s88, v211
  v_dot2c_f32_bf16 v131, s89, v211
  s_waitcnt vmcnt(8)
  v_dot2c_f32_bf16 v140, s88, v212
  v_dot2c_f32_bf16 v141, s89, v212
  v_dot2c_f32_bf16 v142, s88, v213
  v_dot2c_f32_bf16 v143, s89, v213
  v_dot2c_f32_bf16 v132, s88, v214
  v_dot2c_f32_bf16 v133, s89, v214
  v_dot2c_f32_bf16 v134, s88, v215
  v_dot2c_f32_bf16 v135, s89, v215
  s_waitcnt vmcnt(7)
  v_dot2c_f32_bf16 v136, s88, v216
  v_dot2c_f32_bf16 v137, s89, v216
  v_dot2c_f32_bf16 v138, s88, v217
  v_dot2c_f32_bf16 v139, s89, v217
  v_dot2c_f32_bf16 v128, s88, v218
  v_dot2c_f32_bf16 v129, s89, v218
  v_dot2c_f32_bf16 v130, s88, v219
  v_dot2c_f32_bf16 v131, s89, v219
  s_waitcnt vmcnt(6)
  v_dot2c_f32_bf16 v140, s88, v220
  v_dot2c_f32_bf16 v141, s89, v220
  v_dot2c_f32_bf16 v142, s88, v221
  v_dot2c_f32_bf16 v143, s89, v221
  v_dot2c_f32_bf16 v132, s88, v222
  v_dot2c_f32_bf16 v133, s89, v222
  v_dot2c_f32_bf16 v134, s88, v223
  v_dot2c_f32_bf16 v135, s89, v223
  s_waitcnt vmcnt(5)
  v_dot2c_f32_bf16 v136, s88, v224
  v_dot2c_f32_bf16 v137, s89, v224
  v_dot2c_f32_bf16 v138, s88, v225
  v_dot2c_f32_bf16 v139, s89, v225
  v_dot2c_f32_bf16 v128, s88, v226
  v_dot2c_f32_bf16 v129, s89, v226
  v_dot2c_f32_bf16 v130, s88, v227
  v_dot2c_f32_bf16 v131, s89, v227
  s_waitcnt vmcnt(4)
  v_dot2c_f32_bf16 v140, s88, v228
  v_dot2c_f32_bf16 v141, s89, v228
  v_dot2c_f32_bf16 v142, s88, v229
  v_dot2c_f32_bf16 v143, s89, v229
  v_dot2c_f32_bf16 v132, s88, v230
  v_dot2c_f32_bf16 v133, s89, v230
  v_dot2c_f32_bf16 v134, s88, v231
  v_dot2c_f32_bf16 v135, s89, v231
  s_waitcnt vmcnt(3)
  v_dot2c_f32_bf16 v136, s88, v232
  v_dot2c_f32_bf16 v137, s89, v232
  v_dot2c_f32_bf16 v138, s88, v233
  v_dot2c_f32_bf16 v139, s89, v233
  v_dot2c_f32_bf16 v128, s88, v234
  v_dot2c_f32_bf16 v129, s89, v234
  v_dot2c_f32_bf16 v130, s88, v235
  v_dot2c_f32_bf16 v131, s89, v235
  s_waitcnt vmcnt(2)
  v_dot2c_f32_bf16 v140, s88, v236
  v_dot2c_f32_bf16 v141, s89, v236
  v_dot2c_f32_bf16 v142, s88, v237
  v_dot2c_f32_bf16 v143, s89, v237
  v_dot2c_f32_bf16 v132, s88, v238
  v_dot2c_f32_bf16 v133, s89, v238
  v_dot2c_f32_bf16 v134, s88, v239
  v_dot2c_f32_bf16 v135, s89, v239
  s_waitcnt vmcnt(1)
  v_dot2c_f32_bf16 v136, s88, v240
  v_dot2c_f32_bf16 v137, s89, v240
  v_dot2c_f32_bf16 v138, s88, v241
  v_dot2c_f32_bf16 v139, s89, v241
  v_dot2c_f32_bf16 v128, s88, v242
  v_dot2c_f32_bf16 v129, s89, v242
  v_dot2c_f32_bf16 v130, s88, v243
  v_dot2c_f32_bf16 v131, s89, v243
  s_waitcnt vmcnt(0)
  v_dot2c_f32_bf16 v140, s88, v244
  v_dot2c_f32_bf16 v141, s89, v244
  v_dot2c_f32_bf16 v142, s88, v245
  v_dot2c_f32_bf16 v143, s89, v245
  v_dot2c_f32_bf16 v132, s88, v246
  v_dot2c_f32_bf16 v133, s89, v246
  v_dot2c_f32_bf16 v134, s88, v247
  v_dot2c_f32_bf16 v135, s89, v247
  v_permlane32_swap_b32 v136, v128
  v_permlane32_swap_b32 v137, v129
  v_permlane32_swap_b32 v138, v130
  v_permlane32_swap_b32 v139, v131
  v_permlane32_swap_b32 v140, v132
  v_permlane32_swap_b32 v141, v133
  v_permlane32_swap_b32 v142, v134
  v_permlane32_swap_b32 v143, v135
  v_permlane16_swap_b32 v136, v128
  v_permlane16_swap_b32 v137, v129
  v_permlane16_swap_b32 v138, v130
  v_permlane16_swap_b32 v139, v131
  v_permlane16_swap_b32 v140, v132
  v_permlane16_swap_b32 v141, v133
  v_permlane16_swap_b32 v142, v134
  v_permlane16_swap_b32 v143, v135
  v_fma_f32 v136, v136, s91, v168
  v_fma_f32 v137, v137, s91, v169
  v_fma_f32 v138, v138, s91, v170
  v_fma_f32 v139, v139, s91, v171
  v_fma_f32 v128, v128, s91, v172
  v_fma_f32 v129, v129, s91, v173
  v_fma_f32 v130, v130, s91, v174
  v_fma_f32 v131, v131, s91, v175
  v_cvt_pk_bf16_f32 v40, v136, v137
  v_cvt_pk_bf16_f32 v41, v138, v139
  v_cvt_pk_bf16_f32 v42, v128, v129
  v_cvt_pk_bf16_f32 v43, v130, v131
  buffer_store_dwordx4 v[40:43], v34, s[20:23], s42 offen
  v_fma_f32 v140, v140, s91, v176
  v_fma_f32 v141, v141, s91, v177
  v_fma_f32 v142, v142, s91, v178
  v_fma_f32 v143, v143, s91, v179
  v_fma_f32 v132, v132, s91, v180
  v_fma_f32 v133, v133, s91, v181
  v_fma_f32 v134, v134, s91, v182
  v_fma_f32 v135, v135, s91, v183
  v_cvt_pk_bf16_f32 v44, v140, v141
  v_cvt_pk_bf16_f32 v45, v142, v143
  v_cvt_pk_bf16_f32 v46, v132, v133
  v_cvt_pk_bf16_f32 v47, v134, v135
  buffer_store_dwordx4 v[44:47], v38, s[20:23], s42 offen
  s_waitcnt vmcnt(0)
L_exit:
  s_endpgm
L_end:
.section .rodata,"a"
.p2align 6
.amdhsa_kernel parallel_sum__spectral_gfnet__dense_activation_silu__prompt_kernel
  .amdhsa_next_free_vgpr 512
  .amdhsa_next_free_sgpr 102
  .amdhsa_accum_offset 256
  .amdhsa_group_segment_fixed_size 0
  .amdhsa_kernarg_size 72
  .amdhsa_user_sgpr_count 2
  .amdhsa_user_sgpr_kernarg_segment_ptr 1
  .amdhsa_system_sgpr_workgroup_id_x 1
.end_amdhsa_kernel
```
